```python
import torch

def _softmax(x, axis=-1):
    return torch.softmax(x, dim=axis)
def _gelu(x):
    return torch.nn.functional.gelu(x, approximate="tanh")
def _silu(x):
    return torch.nn.functional.silu(x)
def _sigmoid(x):
    return torch.sigmoid(x)
def _layernorm(x, axis=-1, eps=1e-5):
    m = x.mean(dim=axis, keepdim=True)
    v = x.var(dim=axis, keepdim=True, unbiased=False)
    return (x - m) / torch.sqrt(v + eps)
def _scatter_add(tgt, idx, src, axis=0):
    return tgt.clone().index_add_(axis, idx, src)
def _segment_sum(src, seg, n):
    out = torch.zeros((n,) + src.shape[1:], dtype=src.dtype)
    return out.index_add_(0, seg, src)
def _pad(x, pw):
    flat = tuple(v for pair in reversed(pw) for v in pair)
    return torch.nn.functional.pad(x, flat)

kernel_name = 'sequential_preLN__linear_kernel_hedgehog__mixer_token_mlp__prompt'

def setup_inputs():

    _w = (lambda a: (lambda t: t.to(torch.bfloat16) if t.is_floating_point() else t)(torch.as_tensor(a)))
    def _A_setup():
        B, S, D, H = 1, 2048, 512, 32
        Dh = D // H
        return {
            "x": _w((lambda *s: torch.randn(*s, dtype=torch.bfloat16) * 0.05)(B, S, D)),
            "wqkv": _w((lambda *s: torch.randn(*s, dtype=torch.bfloat16) * 0.2)(D, 3 * D)),
            "w_phi": _w((lambda *s: torch.randn(*s, dtype=torch.bfloat16) * 0.2)(H, Dh, Dh) * (Dh ** -0.5)),
            "wo": _w((lambda *s: torch.randn(*s, dtype=torch.bfloat16) * 0.05)(D, D)),
        }
    _A_in = _A_setup()

    def _B_setup():
        B, S, D, F = 1, 2048, 512, 1792
        return {
            "x": _w((lambda *s: torch.randn(*s, dtype=torch.bfloat16) * 0.05)(B, S, D)),
            "w1": _w((lambda *s: torch.randn(*s, dtype=torch.bfloat16) * 0.4)(S, F) * (S ** -0.5)),
            "b1": _w((lambda *s: torch.randn(*s, dtype=torch.bfloat16) * 12.8)(F) * 0.02),
            "w2": _w((lambda *s: torch.randn(*s, dtype=torch.bfloat16) * 0.2)(F, S) * (F ** -0.5)),
            "b2": _w((lambda *s: torch.randn(*s, dtype=torch.bfloat16) * 3.2)(S) * 0.02),
        }
    _B_in = _B_setup()

    return {
        "A_x": _A_in["x"],
        "A_wqkv": _A_in["wqkv"],
        "A_w_phi": _A_in["w_phi"],
        "A_wo": _A_in["wo"],
        "B_x": _B_in["x"],
        "B_w1": _B_in["w1"],
        "B_b1": _B_in["b1"],
        "B_w2": _B_in["w2"],
        "B_b2": _B_in["b2"],
    }

def reference(A_x, A_wqkv, A_w_phi, A_wo, B_x, B_w1, B_b1, B_w2, B_b2):
    def _A_ref(x, wqkv, w_phi, wo):
        B, S, D = x.shape
        H = 32; Dh = D // H
        qkv = (lambda x, *d: x.permute(*d))((x @ wqkv).reshape(B, S, 3, H, Dh), 2, 0, 3, 1, 4)
        q, k, v = qkv[0], qkv[1], qkv[2]
        pq = torch.einsum("bhsd,hdf->bhsf", q, w_phi)
        pk = torch.einsum("bhsd,hdf->bhsf", k, w_phi)
        phi_q = torch.concatenate([_softmax(pq, axis=-1), _softmax(-pq, axis=-1)], axis=-1)
        phi_k = torch.concatenate([_softmax(pk, axis=-1), _softmax(-pk, axis=-1)], axis=-1)
        kv = torch.einsum("bhsf,bhsd->bhfd", phi_k, v)
        z  = torch.einsum("bhsf->bhf", phi_k)
        num = torch.einsum("bhqf,bhfd->bhqd", phi_q, kv)
        den = torch.einsum("bhqf,bhf->bhq", phi_q, z)[..., None] + 1e-6
        o = num / den
        return (lambda x, *d: x.permute(*d))(o, 0, 2, 1, 3).reshape(B, S, D) @ wo

    def _B_ref(x, w1, b1, w2, b2):
        B, S, D = x.shape
        h = _layernorm(x, axis=-1)
        u = torch.einsum("bsd,sf->bdf", h, w1) + b1
        u = _gelu(u)
        y = torch.einsum("bdf,fs->bds", u, w2) + b2
        return (lambda x, *d: x.permute(*d))(y, 0, 2, 1)

    x = A_x
    h = x + _A_ref(_layernorm(x, axis=-1), A_wqkv, A_w_phi, A_wo)
    h2 = h + _B_ref(_layernorm(h, axis=-1), B_w1, B_b1, B_w2, B_b2)
    return h2
```

```asm
; @launch grid=(256,1,1) block=(256,1,1) lds=163840
.amdgcn_target "amdgcn-amd-amdhsa--gfx950"
.text
.globl sequential_preLN__linear_kernel_hedgehog__mixer_token_mlp__prompt_kernel
.p2align 8
.type sequential_preLN__linear_kernel_hedgehog__mixer_token_mlp__prompt_kernel,@function
sequential_preLN__linear_kernel_hedgehog__mixer_token_mlp__prompt_kernel:
  s_cmp_ge_u32 s2, 256
  s_cbranch_scc1 L_end
  s_load_dwordx16 s[4:19], s[0:1], 0
  s_load_dwordx8 s[20:27], s[0:1], 64
  v_and_b32 v1, 63, v0
  v_lshrrev_b32 v3, 6, v0
  v_lshlrev_b32 v2, 4, v1
  v_readfirstlane_b32 s68, v3
  v_lshrrev_b32 v15, 5, v1
  s_and_b32 s71, s2, 7
  s_lshr_b32 s72, s2, 3
  s_getpc_b64 s[100:101]
  v_and_b32 v145, 3, v1
  s_lshl2_add_u32 s70, s72, s68
  s_lshl_b32 s70, s70, 2
  v_add_u32 v145, s70, v145
  v_lshlrev_b32 v145, 7, v145
  s_and_b32 s100, s100, 0xffffff00
  v_min_u32 v145, CODE_BYTES, v145
  global_load_dword v192, v145, s[100:101]
  s_lshr_b32 s100, s71, 1
  s_and_b32 s101, s72, 7
  s_lshl3_add_u32 s73, s100, s101
  s_lshr_b32 s77, s72, 3
  s_and_b32 s3, s71, 1
  s_lshl2_add_u32 s74, s3, s77
  s_lshl1_add_u32 s75, s77, s101
  s_and_b32 s75, s75, 7
  s_lshl3_add_u32 s76, s71, s101
  s_lshl_b32 s100, s77, 6
  s_lshl_b32 s101, s75, 7
  s_xor_b32 s100, s100, s101
  v_xor_b32 v128, s100, v2
  v_xor_b32 v129, 16, v128
  v_xor_b32 v130, 32, v128
  v_xor_b32 v131, 48, v128
  v_xor_b32_e64 v132, 64, v128
  v_xor_b32 v133, 80, v128
  v_xor_b32 v134, 96, v128
  v_xor_b32 v135, 112, v128
  v_xor_b32 v136, 128, v128
  v_xor_b32 v137, 144, v128
  v_xor_b32 v138, 160, v128
  v_xor_b32 v139, 176, v128
  v_xor_b32 v140, 192, v128
  v_xor_b32 v141, 208, v128
  v_xor_b32 v142, 224, v128
  v_xor_b32 v143, 240, v128
  s_lshl_b32 s3, s73, 16
  s_xor_b32 s100, s77, 0
  s_lshl2_add_u32 s100, s68, s100
  s_lshl_b32 s84, s100, 12
  s_add_u32 s88, s84, s3
  s_xor_b32 s100, s77, 1
  s_lshl2_add_u32 s100, s68, s100
  s_lshl_b32 s85, s100, 12
  s_add_u32 s89, s85, s3
  s_xor_b32 s100, s77, 2
  s_lshl2_add_u32 s100, s68, s100
  s_lshl_b32 s86, s100, 12
  s_add_u32 s90, s86, s3
  s_xor_b32 s100, s77, 3
  s_lshl2_add_u32 s100, s68, s100
  s_lshl_b32 s87, s100, 12
  s_add_u32 s91, s87, s3
  s_lshl_b32 s82, s68, 12
  s_lshl_b32 s83, s68, 11
  v_lshrrev_b32 v252, 3, v1
  v_mul_u32_u24 v11, 3072, v252
  v_bfe_u32 v252, v1, 4, 1
  v_lshlrev_b32 v252, 2, v252
  v_xor_b32 v252, v1, v252
  v_and_b32 v252, 7, v252
  v_lshl_add_u32 v11, v252, 4, v11
  v_add_u32 v12, 23552, v11
  v_add_u32 v13, 1024, v11
  v_add_u32 v14, 23552, v11
  s_mul_i32 s101, s68, 49152
  s_lshl_b32 s100, s74, 7
  s_add_u32 s101, s101, s100
  s_xor_b32 s100, s75, 0
  s_mul_i32 s100, s100, 196608
  s_add_u32 s92, s100, s101
  s_xor_b32 s100, s75, 1
  s_mul_i32 s100, s100, 196608
  s_add_u32 s93, s100, s101
  s_xor_b32 s100, s75, 2
  s_mul_i32 s100, s100, 196608
  s_add_u32 s94, s100, s101
  s_xor_b32 s100, s75, 3
  s_mul_i32 s100, s100, 196608
  s_add_u32 s95, s100, s101
  s_xor_b32 s100, s75, 4
  s_mul_i32 s100, s100, 196608
  s_add_u32 s96, s100, s101
  s_xor_b32 s100, s75, 5
  s_mul_i32 s100, s100, 196608
  s_add_u32 s97, s100, s101
  s_xor_b32 s100, s75, 6
  s_mul_i32 s100, s100, 196608
  s_add_u32 s98, s100, s101
  s_xor_b32 s100, s75, 7
  s_mul_i32 s100, s100, 196608
  s_add_u32 s99, s100, s101
  s_waitcnt lgkmcnt(0)
  s_mov_b32 s28, s4
  s_and_b32 s29, s5, 0xffff
  s_mov_b32 s30, 2097152
  s_mov_b32 s31, 0x20000
  s_mov_b32 m0, s84
  s_nop 0
  buffer_load_dwordx4 v128, s[28:31], s88 offen offset:0 lds
  buffer_load_dwordx4 v129, s[28:31], s88 offen offset:1024 lds
  buffer_load_dwordx4 v130, s[28:31], s88 offen offset:2048 lds
  buffer_load_dwordx4 v131, s[28:31], s88 offen offset:3072 lds
  s_mov_b32 m0, s85
  s_nop 0
  buffer_load_dwordx4 v132, s[28:31], s89 offen offset:0 lds
  buffer_load_dwordx4 v133, s[28:31], s89 offen offset:1024 lds
  buffer_load_dwordx4 v134, s[28:31], s89 offen offset:2048 lds
  buffer_load_dwordx4 v135, s[28:31], s89 offen offset:3072 lds
  s_mov_b32 s32, s6
  s_and_b32 s33, s7, 0xffff
  s_mov_b32 s34, 1572864
  s_mov_b32 s35, 0x20000
  s_load_dword s3, s[26:27], 0
  s_mov_b32 m0, s86
  s_nop 0
  buffer_load_dwordx4 v136, s[28:31], s90 offen offset:0 lds
  buffer_load_dwordx4 v137, s[28:31], s90 offen offset:1024 lds
  buffer_load_dwordx4 v138, s[28:31], s90 offen offset:2048 lds
  buffer_load_dwordx4 v139, s[28:31], s90 offen offset:3072 lds
  s_mov_b32 m0, s87
  s_nop 0
  buffer_load_dwordx4 v140, s[28:31], s91 offen offset:0 lds
  buffer_load_dwordx4 v141, s[28:31], s91 offen offset:1024 lds
  buffer_load_dwordx4 v142, s[28:31], s91 offen offset:2048 lds
  buffer_load_dwordx4 v143, s[28:31], s91 offen offset:3072 lds
  s_add_u32 m0, s82, 65536
  s_nop 0
  buffer_load_dwordx4 v13, s[32:35], s92 offen lds
  buffer_load_dwordx4 v13, s[32:35], s92 offen offset:1024 lds
  buffer_load_dwordx4 v14, s[32:35], s92 offen offset:2048 lds
  buffer_load_dwordx4 v14, s[32:35], s92 offen offset:3072 lds
  v_and_b32 v144, 15, v1
  v_mul_u32_u24 v144, 3072, v144
  buffer_load_dword v192, v144, s[32:35], s92 offen
  s_mov_b32 s36, s8
  s_and_b32 s37, s9, 0xffff
  s_mov_b32 s38, 16384
  s_mov_b32 s39, 0x20000
  s_mov_b32 s40, s10
  s_and_b32 s41, s11, 0xffff
  s_mov_b32 s42, 524288
  s_mov_b32 s43, 0x20000
  s_mov_b32 s44, s14
  s_and_b32 s45, s15, 0xffff
  s_mov_b32 s46, 7340032
  s_mov_b32 s47, 0x20000
  s_mov_b32 s48, s16
  s_and_b32 s49, s17, 0xffff
  s_mov_b32 s50, 3584
  s_mov_b32 s51, 0x20000
  s_mov_b32 s52, s18
  s_and_b32 s53, s19, 0xffff
  s_mov_b32 s54, 7340032
  s_mov_b32 s55, 0x20000
  s_mov_b32 s56, s20
  s_and_b32 s57, s21, 0xffff
  s_mov_b32 s58, 4096
  s_mov_b32 s59, 0x20000
  s_mov_b32 s60, s22
  s_and_b32 s61, s23, 0xffff
  s_mov_b32 s62, 2097152
  s_mov_b32 s63, 0x20000
  s_mov_b32 s64, s26
  s_and_b32 s65, s27, 0xffff
  s_mov_b32 s66, 10485760
  s_mov_b32 s67, 0x20000
  s_lshr_b32 s19, s68, 1
  s_and_b32 s20, s68, 1
  s_lshl_b32 s11, s68, 14
  s_lshl_b32 s100, s68, 10
  s_add_u32 m0, s100, 147456
  s_lshl1_add_u32 s100, s74, s19
  s_lshl_b32 s100, s100, 10
  buffer_load_dwordx4 v2, s[36:39], s100 offen lds
  s_and_b32 s100, s71, 1
  s_and_b32 s101, s72, 3
  s_lshl2_add_u32 s78, s100, s101
  s_lshr_b32 s100, s72, 2
  s_lshr_b32 s101, s71, 1
  s_and_b32 s81, s100, 3
  s_cmp_eq_u32 s81, 3
  s_cselect_b32 s81, 0, 0
  s_xor_b32 s81, s81, s100
  s_lshl3_add_u32 s81, s101, s81
  s_min_u32 s100, s100, 6
  s_mul_i32 s101, s101, 7
  s_add_u32 s79, s101, s100
  s_mov_b32 s24, 0xffff0000
  s_mov_b32 s25, 0xffff0000
  s_mov_b32 s10, 0x40000
  s_mov_b32 s12, 0x3f803f80
  s_lshl2_add_u32 s100, s77, s68
  s_lshl4_add_u32 s13, s76, s100
  s_lshl_b32 s13, s13, 11
  s_add_u32 s13, s13, 4194304
  s_lshl1_add_u32 s100, s78, s20
  s_mul_i32 s14, s100, 112
  s_lshl2_add_u32 s14, s79, s14
  s_lshl1_add_u32 s14, s19, s14
  s_lshl_b32 s14, s14, 10
  s_add_u32 s14, s14, 6291456
  s_mul_i32 s15, s68, 1835008
  s_lshl_b32 s100, s79, 7
  s_add_u32 s15, s15, s100
  s_mul_i32 s16, s68, 1835008
  s_lshl_b32 s100, s81, 7
  s_add_u32 s16, s16, s100
  v_and_b32 v4, 31, v1
  s_lshl_b32 s100, s20, 15
  v_lshl_add_u32 v5, v4, 10, s100
  v_xor_b32 v6, v15, v1
  v_and_b32 v6, 15, v6
  v_lshl_add_u32 v196, v6, 4, v5
  v_xor_b32 v197, 32, v196
  v_xor_b32 v198, 64, v196
  v_xor_b32 v199, 96, v196
  v_xor_b32 v200, 128, v196
  v_xor_b32 v201, 160, v196
  v_xor_b32 v202, 192, v196
  v_xor_b32 v203, 224, v196
  s_lshl_b32 s100, s19, 6
  v_mul_u32_u24 v4, 2048, v15
  v_bfe_u32 v252, v1, 2, 2
  v_lshl_add_u32 v4, v252, 7, v4
  v_bfe_u32 v252, v1, 3, 1
  v_lshlrev_b32 v252, 6, v252
  v_bfe_u32 v253, v1, 4, 1
  v_lshl_or_b32 v252, v253, 5, v252
  v_and_b32 v253, 3, v1
  v_lshl_or_b32 v252, v253, 3, v252
  v_xor_b32 v252, s100, v252
  v_add_u32 v4, v4, v252
  v_add_u32 v5, 0x10000, v4
  v_add_u32 v6, 0x20000, v4
  v_lshlrev_b32 v7, 10, v15
  v_sub_u32 v10, v4, v7
  v_add_u32 v7, 0x10000, v10
  v_and_b32 v225, 1, v1
  v_lshlrev_b32_e64 v225, 9, v225
  v_lshl_add_u32 v225, v15, 7, v225
  v_bfe_u32 v252, v1, 2, 2
  v_lshl_add_u32 v225, v252, 5, v225
  v_bfe_u32 v252, v1, 4, 1
  v_lshl_add_u32 v225, v252, 4, v225
  v_bfe_u32 v252, v1, 1, 1
  v_lshl_add_u32 v225, v252, 3, v225
  s_lshl_b32 s100, s68, 10
  s_add_u32 s100, s100, 147456
  v_add_u32 v225, s100, v225
  s_waitcnt lgkmcnt(0)
  s_cmp_eq_u32 s20, 0
  s_cselect_b32 s26, s24, 0xffff
  s_mov_b32 s27, s26
  v_and_b32 v252, 15, v1
  v_lshrrev_b32 v253, 3, v252
  v_mul_u32_u24 v253, 8704, v253
  v_and_b32 v254, 7, v1
  v_lshl_add_u32 v254, v254, 1, v15
  v_lshl_add_u32 v253, v254, 4, v253
  v_mul_u32_u24 v254, 8704, v15
  s_lshl_b32 s101, s73, 8
  v_add_u32 v253, s101, v253
  s_lshl_b32 s101, s73, 4
  s_add_u32 s101, s101, 8192
  v_add_u32 v254, s101, v254
  v_mov_b32 v255, 0x7f000000
  v_cmp_eq_u32 vcc, 0, v252
  s_nop 1
  v_cndmask_b32 v254, v255, v254, vcc
  v_cndmask_b32 v226, v253, v254, s[26:27]
  s_lshl_b32 s100, s68, 12
  s_add_u32 s100, s100, 131072
  v_and_b32 v252, 31, v1
  v_lshlrev_b32 v228, 6, v252
  v_lshl_add_u32 v228, v15, 11, v228
  v_bfe_u32 v252, v1, 1, 2
  v_lshl_add_u32 v228, v252, 4, v228
  v_add_u32 v228, s100, v228
  v_bfe_u32 v252, v1, 2, 2
  v_lshl_add_u32 v229, v15, 2, v252
  v_lshrrev_b32 v253, 1, v229
  v_bfe_u32 v254, v1, 4, 1
  v_bfe_u32 v255, v1, 1, 1
  v_lshl_add_u32 v254, v254, 1, v255
  v_xor_b32 v253, v253, v254
  v_lshlrev_b32 v229, 6, v229
  v_lshl_add_u32 v229, v253, 4, v229
  v_and_b32 v255, 1, v1
  v_lshl_add_u32 v229, v255, 3, v229
  v_add_u32 v229, s100, v229
  s_lshl_b32 s101, s20, 11
  v_add_u32 v229, s101, v229
  v_xor_b32 v227, 0x1000, v229
  s_mul_i32 s100, s19, 12288
  s_lshl_b32 s101, s20, 11
  s_add_u32 s100, s100, s101
  s_add_u32 s100, s100, 147456
  v_add_u32 v8, s100, v2
  v_xor_b32 v195, 0x800, v8
  v_lshrrev_b32 v252, 3, v1
  v_mul_u32_u24 v212, 1024, v252
  v_bfe_u32 v252, v1, 4, 1
  v_lshlrev_b32 v252, 2, v252
  v_xor_b32 v252, v1, v252
  v_and_b32 v252, 7, v252
  v_lshl_add_u32 v212, v252, 4, v212
  v_add_u32 v213, 7168, v212
  v_add_u32 v214, 14336, v212
  v_add_u32 v215, 21504, v212
  s_lshl_b32 s8, s68, 17
  s_lshl_b32 s100, s77, 8
  s_add_u32 s8, s8, s100
  s_lshl_b32 s100, s19, 7
  s_add_u32 s8, s8, s100
  s_xor_b32 s9, s8, 128
  s_lshl_b32 s100, s68, 8
  v_lshl_add_u32 v230, v1, 2, s100
  v_add_u32 v230, 153600, v230
  s_and_b32 s101, s100, 0x200
  s_add_u32 s101, s101, 155648
  v_lshl_add_u32 v231, v15, 4, s101
  s_add_u32 s101, s101, 256
  v_and_b32 v252, 31, v1
  v_lshl_add_u32 v235, v252, 2, s101
  s_add_u32 s100, s100, 154624
  v_lshl_add_u32 v223, v15, 4, s100
  s_lshl_b32 s100, s19, 9
  v_add_u32 v204, s100, v196
  v_add_u32 v205, s100, v197
  v_add_u32 v206, s100, v198
  v_add_u32 v207, s100, v199
  v_add_u32 v208, s100, v200
  v_add_u32 v209, s100, v201
  v_add_u32 v210, s100, v202
  v_add_u32 v211, s100, v203
  v_lshrrev_b32 v252, 3, v1
  v_mul_u32_u24 v248, 3584, v252
  v_bfe_u32 v252, v1, 4, 1
  v_lshlrev_b32 v252, 2, v252
  v_xor_b32 v252, v1, v252
  v_and_b32 v252, 7, v252
  v_lshl_add_u32 v248, v252, 4, v248
  v_add_u32 v249, 27648, v248
  v_add_u32 v250, 55296, v248
  v_add_u32 v251, 82944, v248
  v_and_b32 v224, 31, v1
  v_bfe_u32 v252, v1, 3, 2
  v_mul_u32_u24 v222, 3584, v252
  v_and_b32 v252, 7, v1
  v_min_u32 v252, 6, v252
  v_lshl_add_u32 v222, v252, 7, v222
  v_lshlrev_b32 v224, 7, v224
  v_bfe_u32 v194, v1, 3, 2
  s_lshl_b32 s100, s72, 2
  v_add_u32 v194, s100, v194
  v_and_b32 v252, 7, v1
  v_lshlrev_b32 v252, 7, v252
  v_lshl_add_u32 v194, v194, 12, v252
  s_lshl2_add_u32 s101, s72, s68
  s_lshl_b32 s23, s101, 12
  s_lshl_b32 s21, s68, 7
  s_add_u32 s21, s21, s72
  s_mul_i32 s21, s21, 14336
  s_lshr_b32 s100, s71, 1
  s_mul_i32 s100, s100, 896
  s_add_u32 s21, s21, s100
  v_mov_b32 v236, 0
  v_mov_b32 v216, 0
  v_mov_b32 v237, 0
  v_mov_b32 v217, 0
  v_mov_b32 v238, 0
  v_mov_b32 v218, 0
  v_mov_b32 v239, 0
  v_mov_b32 v219, 0
  s_waitcnt lgkmcnt(0)
  s_mul_i32 s69, s3, 1664525
  s_add_u32 s69, s69, 1013904223
  s_and_b32 s70, s69, 0xfff
  v_mov_b32 v220, 0xfff
  v_mov_b32 v221, s70
  s_waitcnt vmcnt(6)
  s_barrier
  ds_read_b128 v[64:67], v204 offset:0
  ds_read_b128 v[68:71], v205 offset:0
  ds_read_b128 v[72:75], v206 offset:0
  ds_read_b128 v[76:79], v207 offset:0
  s_add_u32 m0, s82, 81920
  s_nop 0
  buffer_load_dwordx4 v13, s[32:35], s93 offen lds
  buffer_load_dwordx4 v13, s[32:35], s93 offen offset:1024 lds
  buffer_load_dwordx4 v14, s[32:35], s93 offen offset:2048 lds
  buffer_load_dwordx4 v14, s[32:35], s93 offen offset:3072 lds
  ds_read_b128 v[80:83], v208 offset:0
  ds_read_b128 v[84:87], v209 offset:0
  ds_read_b128 v[88:91], v210 offset:0
  ds_read_b128 v[92:95], v211 offset:0
  ds_read_b128 v[96:99], v204 offset:256
  ds_read_b128 v[100:103], v205 offset:256
  ds_read_b128 v[104:107], v206 offset:256
  ds_read_b128 v[108:111], v207 offset:256
  ds_read_b128 v[112:115], v208 offset:256
  ds_read_b128 v[116:119], v209 offset:256
  ds_read_b128 v[120:123], v210 offset:256
  ds_read_b128 v[124:127], v211 offset:256
  s_waitcnt lgkmcnt(15)
  v_dot2c_f32_bf16 v216, s12, v64
  v_dot2c_f32_bf16 v218, v64, v64
  v_dot2c_f32_bf16 v217, s12, v65
  v_dot2c_f32_bf16 v219, v65, v65
  v_dot2c_f32_bf16 v216, s12, v66
  v_dot2c_f32_bf16 v218, v66, v66
  v_dot2c_f32_bf16 v217, s12, v67
  v_dot2c_f32_bf16 v219, v67, v67
  s_waitcnt lgkmcnt(14)
  v_dot2c_f32_bf16 v216, s12, v68
  v_dot2c_f32_bf16 v218, v68, v68
  v_dot2c_f32_bf16 v217, s12, v69
  v_dot2c_f32_bf16 v219, v69, v69
  v_dot2c_f32_bf16 v216, s12, v70
  v_dot2c_f32_bf16 v218, v70, v70
  v_dot2c_f32_bf16 v217, s12, v71
  v_dot2c_f32_bf16 v219, v71, v71
  s_waitcnt lgkmcnt(13)
  v_dot2c_f32_bf16 v216, s12, v72
  v_dot2c_f32_bf16 v218, v72, v72
  v_dot2c_f32_bf16 v217, s12, v73
  v_dot2c_f32_bf16 v219, v73, v73
  v_dot2c_f32_bf16 v216, s12, v74
  v_dot2c_f32_bf16 v218, v74, v74
  v_dot2c_f32_bf16 v217, s12, v75
  v_dot2c_f32_bf16 v219, v75, v75
  ds_read_b128 a[0:3], v196 offset:0
  ds_read_b128 a[4:7], v197 offset:0
  s_waitcnt lgkmcnt(14)
  v_dot2c_f32_bf16 v216, s12, v76
  v_dot2c_f32_bf16 v218, v76, v76
  v_dot2c_f32_bf16 v217, s12, v77
  v_dot2c_f32_bf16 v219, v77, v77
  v_dot2c_f32_bf16 v216, s12, v78
  v_dot2c_f32_bf16 v218, v78, v78
  v_dot2c_f32_bf16 v217, s12, v79
  v_dot2c_f32_bf16 v219, v79, v79
  ds_read_b128 a[8:11], v198 offset:0
  ds_read_b128 a[12:15], v199 offset:0
  s_waitcnt lgkmcnt(15)
  v_dot2c_f32_bf16 v216, s12, v80
  v_dot2c_f32_bf16 v218, v80, v80
  v_dot2c_f32_bf16 v217, s12, v81
  v_dot2c_f32_bf16 v219, v81, v81
  v_dot2c_f32_bf16 v216, s12, v82
  v_dot2c_f32_bf16 v218, v82, v82
  v_dot2c_f32_bf16 v217, s12, v83
  v_dot2c_f32_bf16 v219, v83, v83
  ds_read_b128 a[16:19], v200 offset:0
  ds_read_b128 a[20:23], v201 offset:0
  s_waitcnt lgkmcnt(15)
  v_dot2c_f32_bf16 v216, s12, v84
  v_dot2c_f32_bf16 v218, v84, v84
  v_dot2c_f32_bf16 v217, s12, v85
  v_dot2c_f32_bf16 v219, v85, v85
  v_dot2c_f32_bf16 v216, s12, v86
  v_dot2c_f32_bf16 v218, v86, v86
  v_dot2c_f32_bf16 v217, s12, v87
  v_dot2c_f32_bf16 v219, v87, v87
  ds_read_b128 a[24:27], v202 offset:0
  ds_read_b128 a[28:31], v203 offset:0
  s_waitcnt lgkmcnt(15)
  v_dot2c_f32_bf16 v216, s12, v88
  v_dot2c_f32_bf16 v218, v88, v88
  v_dot2c_f32_bf16 v217, s12, v89
  v_dot2c_f32_bf16 v219, v89, v89
  v_dot2c_f32_bf16 v216, s12, v90
  v_dot2c_f32_bf16 v218, v90, v90
  v_dot2c_f32_bf16 v217, s12, v91
  v_dot2c_f32_bf16 v219, v91, v91
  ds_read_b128 a[32:35], v196 offset:256
  ds_read_b128 a[36:39], v197 offset:256
  s_waitcnt lgkmcnt(15)
  v_dot2c_f32_bf16 v216, s12, v92
  v_dot2c_f32_bf16 v218, v92, v92
  v_dot2c_f32_bf16 v217, s12, v93
  v_dot2c_f32_bf16 v219, v93, v93
  v_dot2c_f32_bf16 v216, s12, v94
  v_dot2c_f32_bf16 v218, v94, v94
  v_dot2c_f32_bf16 v217, s12, v95
  v_dot2c_f32_bf16 v219, v95, v95
  ds_read_b128 a[40:43], v198 offset:256
  ds_read_b128 a[44:47], v199 offset:256
  s_waitcnt lgkmcnt(15)
  v_dot2c_f32_bf16 v216, s12, v96
  v_dot2c_f32_bf16 v218, v96, v96
  v_dot2c_f32_bf16 v217, s12, v97
  v_dot2c_f32_bf16 v219, v97, v97
  v_dot2c_f32_bf16 v216, s12, v98
  v_dot2c_f32_bf16 v218, v98, v98
  v_dot2c_f32_bf16 v217, s12, v99
  v_dot2c_f32_bf16 v219, v99, v99
  ds_read_b128 a[48:51], v200 offset:256
  ds_read_b128 a[52:55], v201 offset:256
  s_waitcnt lgkmcnt(15)
  v_dot2c_f32_bf16 v216, s12, v100
  v_dot2c_f32_bf16 v218, v100, v100
  v_dot2c_f32_bf16 v217, s12, v101
  v_dot2c_f32_bf16 v219, v101, v101
  v_dot2c_f32_bf16 v216, s12, v102
  v_dot2c_f32_bf16 v218, v102, v102
  v_dot2c_f32_bf16 v217, s12, v103
  v_dot2c_f32_bf16 v219, v103, v103
  ds_read_b128 a[56:59], v202 offset:256
  ds_read_b128 a[60:63], v203 offset:256
  s_waitcnt lgkmcnt(15)
  v_dot2c_f32_bf16 v216, s12, v104
  v_dot2c_f32_bf16 v218, v104, v104
  v_dot2c_f32_bf16 v217, s12, v105
  v_dot2c_f32_bf16 v219, v105, v105
  v_dot2c_f32_bf16 v216, s12, v106
  v_dot2c_f32_bf16 v218, v106, v106
  v_dot2c_f32_bf16 v217, s12, v107
  v_dot2c_f32_bf16 v219, v107, v107
  ds_read_b128 a[64:67], v196 offset:512
  ds_read_b128 a[68:71], v197 offset:512
  s_waitcnt lgkmcnt(15)
  v_dot2c_f32_bf16 v216, s12, v108
  v_dot2c_f32_bf16 v218, v108, v108
  v_dot2c_f32_bf16 v217, s12, v109
  v_dot2c_f32_bf16 v219, v109, v109
  v_dot2c_f32_bf16 v216, s12, v110
  v_dot2c_f32_bf16 v218, v110, v110
  v_dot2c_f32_bf16 v217, s12, v111
  v_dot2c_f32_bf16 v219, v111, v111
  ds_read_b128 a[72:75], v198 offset:512
  ds_read_b128 a[76:79], v199 offset:512
  s_waitcnt lgkmcnt(15)
  v_dot2c_f32_bf16 v216, s12, v112
  v_dot2c_f32_bf16 v218, v112, v112
  v_dot2c_f32_bf16 v217, s12, v113
  v_dot2c_f32_bf16 v219, v113, v113
  v_dot2c_f32_bf16 v216, s12, v114
  v_dot2c_f32_bf16 v218, v114, v114
  v_dot2c_f32_bf16 v217, s12, v115
  v_dot2c_f32_bf16 v219, v115, v115
  ds_read_b128 a[80:83], v200 offset:512
  ds_read_b128 a[84:87], v201 offset:512
  s_waitcnt lgkmcnt(15)
  v_dot2c_f32_bf16 v216, s12, v116
  v_dot2c_f32_bf16 v218, v116, v116
  v_dot2c_f32_bf16 v217, s12, v117
  v_dot2c_f32_bf16 v219, v117, v117
  v_dot2c_f32_bf16 v216, s12, v118
  v_dot2c_f32_bf16 v218, v118, v118
  v_dot2c_f32_bf16 v217, s12, v119
  v_dot2c_f32_bf16 v219, v119, v119
  ds_read_b128 a[88:91], v202 offset:512
  ds_read_b128 a[92:95], v203 offset:512
  s_waitcnt lgkmcnt(15)
  v_dot2c_f32_bf16 v216, s12, v120
  v_dot2c_f32_bf16 v218, v120, v120
  v_dot2c_f32_bf16 v217, s12, v121
  v_dot2c_f32_bf16 v219, v121, v121
  v_dot2c_f32_bf16 v216, s12, v122
  v_dot2c_f32_bf16 v218, v122, v122
  v_dot2c_f32_bf16 v217, s12, v123
  v_dot2c_f32_bf16 v219, v123, v123
  ds_read_b128 a[96:99], v196 offset:768
  ds_read_b128 a[100:103], v197 offset:768
  s_waitcnt lgkmcnt(15)
  v_dot2c_f32_bf16 v216, s12, v124
  v_dot2c_f32_bf16 v218, v124, v124
  v_dot2c_f32_bf16 v217, s12, v125
  v_dot2c_f32_bf16 v219, v125, v125
  v_dot2c_f32_bf16 v216, s12, v126
  v_dot2c_f32_bf16 v218, v126, v126
  v_dot2c_f32_bf16 v217, s12, v127
  v_dot2c_f32_bf16 v219, v127, v127
  ds_read_b128 a[104:107], v198 offset:768
  ds_read_b128 a[108:111], v199 offset:768
  ds_read_b128 a[112:115], v200 offset:768
  ds_read_b128 a[116:119], v201 offset:768
  ds_read_b128 a[120:123], v202 offset:768
  ds_read_b128 a[124:127], v203 offset:768
  s_add_u32 m0, s82, 98304
  s_nop 0
  buffer_load_dwordx4 v13, s[32:35], s94 offen lds
  buffer_load_dwordx4 v13, s[32:35], s94 offen offset:1024 lds
  buffer_load_dwordx4 v14, s[32:35], s94 offen offset:2048 lds
  buffer_load_dwordx4 v14, s[32:35], s94 offen offset:3072 lds
  v_add_f32 v216, v216, v217
  v_add_f32 v218, v218, v219
  s_cmp_eq_u32 s20, 0
  s_cselect_b64 vcc, -1, 0
  v_permlane32_swap_b32 v216, v218
  v_add_f32 v216, v216, v218
  ds_write_b32 v230, v216
  s_add_u32 m0, s82, 114688
  s_nop 0
  buffer_load_dwordx4 v13, s[32:35], s95 offen lds
  buffer_load_dwordx4 v13, s[32:35], s95 offen offset:1024 lds
  buffer_load_dwordx4 v14, s[32:35], s95 offen offset:2048 lds
  buffer_load_dwordx4 v14, s[32:35], s95 offen offset:3072 lds
  s_waitcnt vmcnt(14) lgkmcnt(0)
  s_barrier
  ds_read_b64_tr_b16 v[64:65], v5 offset:0
  ds_read_b64_tr_b16 v[66:67], v5 offset:512
  ds_read_b64_tr_b16 v[68:69], v5 offset:1024
  ds_read_b64_tr_b16 v[70:71], v5 offset:1536
  ds_read_b64_tr_b16 v[72:73], v5 offset:4096
  ds_read_b64_tr_b16 v[74:75], v5 offset:4608
  ds_read_b64_tr_b16 v[76:77], v5 offset:5120
  ds_read_b64_tr_b16 v[78:79], v5 offset:5632
  ds_read_b64_tr_b16 v[80:81], v5 offset:8192
  ds_read_b64_tr_b16 v[82:83], v5 offset:8704
  ds_read_b64_tr_b16 v[84:85], v5 offset:9216
  ds_read_b64_tr_b16 v[86:87], v5 offset:9728
  ds_read_b64_tr_b16 v[88:89], v5 offset:12288
  ds_read_b64_tr_b16 v[90:91], v5 offset:12800
  ds_read_b64_tr_b16 v[92:93], v5 offset:13312
  ds_read_b64_tr_b16 v[94:95], v5 offset:13824
  s_waitcnt lgkmcnt(12)
  v_mfma_f32_32x32x16_bf16 v[16:31], v[64:67], a[0:3], 0
  s_add_u32 m0, s82, 131072
  s_nop 0
  buffer_load_dwordx4 v13, s[32:35], s96 offen lds
  v_mfma_f32_32x32x16_bf16 v[32:47], a[0:3], v[68:71], 0
  buffer_load_dwordx4 v13, s[32:35], s96 offen offset:1024 lds
  s_waitcnt vmcnt(10)
  s_barrier
  ds_read_b64_tr_b16 v[96:97], v5 offset:16384
  ds_read_b64_tr_b16 v[98:99], v5 offset:16896
  ds_read_b64_tr_b16 v[100:101], v5 offset:17408
  ds_read_b64_tr_b16 v[102:103], v5 offset:17920
  s_waitcnt lgkmcnt(12)
  v_mfma_f32_32x32x16_bf16 v[16:31], v[72:75], a[4:7], v[16:31]
  buffer_load_dwordx4 v14, s[32:35], s96 offen offset:2048 lds
  v_mfma_f32_32x32x16_bf16 v[32:47], a[4:7], v[76:79], v[32:47]
  buffer_load_dwordx4 v14, s[32:35], s96 offen offset:3072 lds
  ds_read_b64_tr_b16 v[104:105], v5 offset:20480
  ds_read_b64_tr_b16 v[106:107], v5 offset:20992
  ds_read_b64_tr_b16 v[108:109], v5 offset:21504
  ds_read_b64_tr_b16 v[110:111], v5 offset:22016
  s_waitcnt lgkmcnt(12)
  v_mfma_f32_32x32x16_bf16 v[16:31], v[80:83], a[8:11], v[16:31]
  s_add_u32 m0, s82, 0
  s_nop 0
  buffer_load_dwordx4 v13, s[32:35], s97 offen lds
  v_mfma_f32_32x32x16_bf16 v[32:47], a[8:11], v[84:87], v[32:47]
  buffer_load_dwordx4 v13, s[32:35], s97 offen offset:1024 lds
  ds_read_b64_tr_b16 v[112:113], v5 offset:24576
  ds_read_b64_tr_b16 v[114:115], v5 offset:25088
  ds_read_b64_tr_b16 v[116:117], v5 offset:25600
  ds_read_b64_tr_b16 v[118:119], v5 offset:26112
  s_waitcnt lgkmcnt(12)
  v_mfma_f32_32x32x16_bf16 v[16:31], v[88:91], a[12:15], v[16:31]
  buffer_load_dwordx4 v14, s[32:35], s97 offen offset:2048 lds
  v_mfma_f32_32x32x16_bf16 v[32:47], a[12:15], v[92:95], v[32:47]
  buffer_load_dwordx4 v14, s[32:35], s97 offen offset:3072 lds
  ds_read_b64_tr_b16 v[120:121], v5 offset:28672
  ds_read_b64_tr_b16 v[122:123], v5 offset:29184
  ds_read_b64_tr_b16 v[124:125], v5 offset:29696
  ds_read_b64_tr_b16 v[126:127], v5 offset:30208
  s_waitcnt lgkmcnt(12)
  v_mfma_f32_32x32x16_bf16 v[16:31], v[96:99], a[16:19], v[16:31]
  s_add_u32 m0, s82, 16384
  s_nop 0
  buffer_load_dwordx4 v13, s[32:35], s98 offen lds
  v_mfma_f32_32x32x16_bf16 v[32:47], a[16:19], v[100:103], v[32:47]
  buffer_load_dwordx4 v13, s[32:35], s98 offen offset:1024 lds
  s_waitcnt vmcnt(10)
  s_barrier
  ds_read_b64_tr_b16 v[128:129], v5 offset:32768
  ds_read_b64_tr_b16 v[130:131], v5 offset:33280
  ds_read_b64_tr_b16 v[132:133], v5 offset:33792
  ds_read_b64_tr_b16 v[134:135], v5 offset:34304
  s_waitcnt lgkmcnt(12)
  v_mfma_f32_32x32x16_bf16 v[16:31], v[104:107], a[20:23], v[16:31]
  buffer_load_dwordx4 v14, s[32:35], s98 offen offset:2048 lds
  v_mfma_f32_32x32x16_bf16 v[32:47], a[20:23], v[108:111], v[32:47]
  buffer_load_dwordx4 v14, s[32:35], s98 offen offset:3072 lds
  ds_read_b64_tr_b16 v[136:137], v5 offset:36864
  ds_read_b64_tr_b16 v[138:139], v5 offset:37376
  ds_read_b64_tr_b16 v[140:141], v5 offset:37888
  ds_read_b64_tr_b16 v[142:143], v5 offset:38400
  s_waitcnt lgkmcnt(12)
  v_mfma_f32_32x32x16_bf16 v[16:31], v[112:115], a[24:27], v[16:31]
  s_add_u32 m0, s82, 32768
  s_nop 0
  buffer_load_dwordx4 v13, s[32:35], s99 offen lds
  v_mfma_f32_32x32x16_bf16 v[32:47], a[24:27], v[116:119], v[32:47]
  buffer_load_dwordx4 v13, s[32:35], s99 offen offset:1024 lds
  ds_read_b64_tr_b16 v[144:145], v5 offset:40960
  ds_read_b64_tr_b16 v[146:147], v5 offset:41472
  ds_read_b64_tr_b16 v[148:149], v5 offset:41984
  ds_read_b64_tr_b16 v[150:151], v5 offset:42496
  s_waitcnt lgkmcnt(12)
  v_mfma_f32_32x32x16_bf16 v[16:31], v[120:123], a[28:31], v[16:31]
  buffer_load_dwordx4 v14, s[32:35], s99 offen offset:2048 lds
  v_mfma_f32_32x32x16_bf16 v[32:47], a[28:31], v[124:127], v[32:47]
  buffer_load_dwordx4 v14, s[32:35], s99 offen offset:3072 lds
  ds_read_b64_tr_b16 v[152:153], v5 offset:45056
  ds_read_b64_tr_b16 v[154:155], v5 offset:45568
  ds_read_b64_tr_b16 v[156:157], v5 offset:46080
  ds_read_b64_tr_b16 v[158:159], v5 offset:46592
  s_waitcnt lgkmcnt(12)
  s_cbranch_vccz L_csv_1
  v_dot2c_f32_bf16 v236, s12, v64
  v_dot2c_f32_bf16 v237, s12, v65
  v_dot2c_f32_bf16 v236, s12, v66
  v_dot2c_f32_bf16 v237, s12, v67
  v_dot2c_f32_bf16 v236, s12, v72
  v_dot2c_f32_bf16 v237, s12, v73
  v_dot2c_f32_bf16 v236, s12, v74
  v_dot2c_f32_bf16 v237, s12, v75
  v_dot2c_f32_bf16 v236, s12, v80
  v_dot2c_f32_bf16 v237, s12, v81
  v_dot2c_f32_bf16 v236, s12, v82
  v_dot2c_f32_bf16 v237, s12, v83
  v_dot2c_f32_bf16 v236, s12, v88
  v_dot2c_f32_bf16 v237, s12, v89
  v_dot2c_f32_bf16 v236, s12, v90
  v_dot2c_f32_bf16 v237, s12, v91
  v_dot2c_f32_bf16 v236, s12, v96
  v_dot2c_f32_bf16 v237, s12, v97
  v_dot2c_f32_bf16 v236, s12, v98
  v_dot2c_f32_bf16 v237, s12, v99
  v_dot2c_f32_bf16 v236, s12, v104
  v_dot2c_f32_bf16 v237, s12, v105
  v_dot2c_f32_bf16 v236, s12, v106
  v_dot2c_f32_bf16 v237, s12, v107
  v_dot2c_f32_bf16 v236, s12, v112
  v_dot2c_f32_bf16 v237, s12, v113
  v_dot2c_f32_bf16 v236, s12, v114
  v_dot2c_f32_bf16 v237, s12, v115
  v_dot2c_f32_bf16 v236, s12, v120
  v_dot2c_f32_bf16 v237, s12, v121
  v_dot2c_f32_bf16 v236, s12, v122
  v_dot2c_f32_bf16 v237, s12, v123
  s_branch L_cse_2
L_csv_1:
  v_dot2c_f32_bf16 v236, s12, v68
  v_dot2c_f32_bf16 v237, s12, v69
  v_dot2c_f32_bf16 v236, s12, v70
  v_dot2c_f32_bf16 v237, s12, v71
  v_dot2c_f32_bf16 v236, s12, v76
  v_dot2c_f32_bf16 v237, s12, v77
  v_dot2c_f32_bf16 v236, s12, v78
  v_dot2c_f32_bf16 v237, s12, v79
  v_dot2c_f32_bf16 v236, s12, v84
  v_dot2c_f32_bf16 v237, s12, v85
  v_dot2c_f32_bf16 v236, s12, v86
  v_dot2c_f32_bf16 v237, s12, v87
  v_dot2c_f32_bf16 v236, s12, v92
  v_dot2c_f32_bf16 v237, s12, v93
  v_dot2c_f32_bf16 v236, s12, v94
  v_dot2c_f32_bf16 v237, s12, v95
  v_dot2c_f32_bf16 v236, s12, v100
  v_dot2c_f32_bf16 v237, s12, v101
  v_dot2c_f32_bf16 v236, s12, v102
  v_dot2c_f32_bf16 v237, s12, v103
  v_dot2c_f32_bf16 v236, s12, v108
  v_dot2c_f32_bf16 v237, s12, v109
  v_dot2c_f32_bf16 v236, s12, v110
  v_dot2c_f32_bf16 v237, s12, v111
  v_dot2c_f32_bf16 v236, s12, v116
  v_dot2c_f32_bf16 v237, s12, v117
  v_dot2c_f32_bf16 v236, s12, v118
  v_dot2c_f32_bf16 v237, s12, v119
  v_dot2c_f32_bf16 v236, s12, v124
  v_dot2c_f32_bf16 v237, s12, v125
  v_dot2c_f32_bf16 v236, s12, v126
  v_dot2c_f32_bf16 v237, s12, v127
L_cse_2:
  v_mfma_f32_32x32x16_bf16 v[16:31], v[128:131], a[32:35], v[16:31]
  s_lshl2_add_u32 s101, s74, s68
  s_mul_i32 s101, s101, 69632
  s_add_u32 s84, s101, 524288
  v_mfma_f32_32x32x16_bf16 v[32:47], a[32:35], v[132:135], v[32:47]
  s_add_u32 s85, s84, 17408
  s_add_u32 s86, s84, 34816
  s_add_u32 s87, s84, 52224
  ds_read_b64_tr_b16 v[160:161], v5 offset:49152
  ds_read_b64_tr_b16 v[162:163], v5 offset:49664
  ds_read_b64_tr_b16 v[164:165], v5 offset:50176
  ds_read_b64_tr_b16 v[166:167], v5 offset:50688
  s_waitcnt lgkmcnt(12)
  v_mfma_f32_32x32x16_bf16 v[16:31], v[136:139], a[36:39], v[16:31]
  s_add_u32 m0, s83, 49152
  s_nop 0
  buffer_load_dwordx4 v11, s[32:35], s98 offen lds
  v_mfma_f32_32x32x16_bf16 v[32:47], a[36:39], v[140:143], v[32:47]
  buffer_load_dwordx4 v12, s[32:35], s98 offen offset:1024 lds
  ds_read_b64_tr_b16 v[168:169], v5 offset:53248
  ds_read_b64_tr_b16 v[170:171], v5 offset:53760
  ds_read_b64_tr_b16 v[172:173], v5 offset:54272
  ds_read_b64_tr_b16 v[174:175], v5 offset:54784
  s_waitcnt lgkmcnt(12)
  v_mfma_f32_32x32x16_bf16 v[16:31], v[144:147], a[40:43], v[16:31]
  s_add_u32 m0, s83, 57344
  s_nop 0
  buffer_load_dwordx4 v11, s[32:35], s99 offen lds
  v_mfma_f32_32x32x16_bf16 v[32:47], a[40:43], v[148:151], v[32:47]
  buffer_load_dwordx4 v12, s[32:35], s99 offen offset:1024 lds
  ds_read_b64_tr_b16 v[176:177], v5 offset:57344
  ds_read_b64_tr_b16 v[178:179], v5 offset:57856
  ds_read_b64_tr_b16 v[180:181], v5 offset:58368
  ds_read_b64_tr_b16 v[182:183], v5 offset:58880
  s_waitcnt lgkmcnt(12)
  v_mfma_f32_32x32x16_bf16 v[16:31], v[152:155], a[44:47], v[16:31]
  s_add_u32 m0, s83, 65536
  s_nop 0
  buffer_load_dwordx4 v11, s[32:35], s92 offen lds
  v_mfma_f32_32x32x16_bf16 v[32:47], a[44:47], v[156:159], v[32:47]
  buffer_load_dwordx4 v12, s[32:35], s92 offen offset:1024 lds
  ds_read_b64_tr_b16 v[184:185], v5 offset:61440
  ds_read_b64_tr_b16 v[186:187], v5 offset:61952
  ds_read_b64_tr_b16 v[188:189], v5 offset:62464
  ds_read_b64_tr_b16 v[190:191], v5 offset:62976
  s_waitcnt lgkmcnt(12)
  v_mfma_f32_32x32x16_bf16 v[16:31], v[160:163], a[48:51], v[16:31]
  s_add_u32 m0, s83, 73728
  s_nop 0
  buffer_load_dwordx4 v11, s[32:35], s93 offen lds
  v_mfma_f32_32x32x16_bf16 v[32:47], a[48:51], v[164:167], v[32:47]
  buffer_load_dwordx4 v12, s[32:35], s93 offen offset:1024 lds
  s_waitcnt vmcnt(16)
  s_barrier
  ds_read_b64_tr_b16 v[64:65], v6 offset:0
  ds_read_b64_tr_b16 v[66:67], v6 offset:512
  ds_read_b64_tr_b16 v[68:69], v6 offset:1024
  ds_read_b64_tr_b16 v[70:71], v6 offset:1536
  s_waitcnt lgkmcnt(12)
  v_mfma_f32_32x32x16_bf16 v[16:31], v[168:171], a[52:55], v[16:31]
  s_add_u32 m0, s83, 81920
  s_nop 0
  buffer_load_dwordx4 v11, s[32:35], s94 offen lds
  v_mfma_f32_32x32x16_bf16 v[32:47], a[52:55], v[172:175], v[32:47]
  buffer_load_dwordx4 v12, s[32:35], s94 offen offset:1024 lds
  ds_read_b64_tr_b16 v[72:73], v6 offset:4096
  ds_read_b64_tr_b16 v[74:75], v6 offset:4608
  ds_read_b64_tr_b16 v[76:77], v6 offset:5120
  ds_read_b64_tr_b16 v[78:79], v6 offset:5632
  s_waitcnt lgkmcnt(12)
  v_mfma_f32_32x32x16_bf16 v[16:31], v[176:179], a[56:59], v[16:31]
  s_add_u32 m0, s83, 90112
  s_nop 0
  buffer_load_dwordx4 v11, s[32:35], s95 offen lds
  v_mfma_f32_32x32x16_bf16 v[32:47], a[56:59], v[180:183], v[32:47]
  buffer_load_dwordx4 v12, s[32:35], s95 offen offset:1024 lds
  ds_read_b64_tr_b16 v[80:81], v6 offset:8192
  ds_read_b64_tr_b16 v[82:83], v6 offset:8704
  ds_read_b64_tr_b16 v[84:85], v6 offset:9216
  ds_read_b64_tr_b16 v[86:87], v6 offset:9728
  s_waitcnt lgkmcnt(12)
  v_mfma_f32_32x32x16_bf16 v[16:31], v[184:187], a[60:63], v[16:31]
  s_add_u32 m0, s83, 98304
  s_nop 0
  buffer_load_dwordx4 v11, s[32:35], s96 offen lds
  v_mfma_f32_32x32x16_bf16 v[32:47], a[60:63], v[188:191], v[32:47]
  buffer_load_dwordx4 v12, s[32:35], s96 offen offset:1024 lds
  ds_read_b64_tr_b16 v[88:89], v6 offset:12288
  ds_read_b64_tr_b16 v[90:91], v6 offset:12800
  ds_read_b64_tr_b16 v[92:93], v6 offset:13312
  ds_read_b64_tr_b16 v[94:95], v6 offset:13824
  s_waitcnt lgkmcnt(12)
  s_cbranch_vccz L_csv_3
  v_dot2c_f32_bf16 v236, s12, v128
  v_dot2c_f32_bf16 v237, s12, v129
  v_dot2c_f32_bf16 v236, s12, v130
  v_dot2c_f32_bf16 v237, s12, v131
  v_dot2c_f32_bf16 v236, s12, v136
  v_dot2c_f32_bf16 v237, s12, v137
  v_dot2c_f32_bf16 v236, s12, v138
  v_dot2c_f32_bf16 v237, s12, v139
  v_dot2c_f32_bf16 v236, s12, v144
  v_dot2c_f32_bf16 v237, s12, v145
  v_dot2c_f32_bf16 v236, s12, v146
  v_dot2c_f32_bf16 v237, s12, v147
  v_dot2c_f32_bf16 v236, s12, v152
  v_dot2c_f32_bf16 v237, s12, v153
  v_dot2c_f32_bf16 v236, s12, v154
  v_dot2c_f32_bf16 v237, s12, v155
  v_dot2c_f32_bf16 v236, s12, v160
  v_dot2c_f32_bf16 v237, s12, v161
  v_dot2c_f32_bf16 v236, s12, v162
  v_dot2c_f32_bf16 v237, s12, v163
  v_dot2c_f32_bf16 v236, s12, v168
  v_dot2c_f32_bf16 v237, s12, v169
  v_dot2c_f32_bf16 v236, s12, v170
  v_dot2c_f32_bf16 v237, s12, v171
  v_dot2c_f32_bf16 v236, s12, v176
  v_dot2c_f32_bf16 v237, s12, v177
  v_dot2c_f32_bf16 v236, s12, v178
  v_dot2c_f32_bf16 v237, s12, v179
  v_dot2c_f32_bf16 v236, s12, v184
  v_dot2c_f32_bf16 v237, s12, v185
  v_dot2c_f32_bf16 v236, s12, v186
  v_dot2c_f32_bf16 v237, s12, v187
  s_branch L_cse_4
L_csv_3:
  v_dot2c_f32_bf16 v236, s12, v132
  v_dot2c_f32_bf16 v237, s12, v133
  v_dot2c_f32_bf16 v236, s12, v134
  v_dot2c_f32_bf16 v237, s12, v135
  v_dot2c_f32_bf16 v236, s12, v140
  v_dot2c_f32_bf16 v237, s12, v141
  v_dot2c_f32_bf16 v236, s12, v142
  v_dot2c_f32_bf16 v237, s12, v143
  v_dot2c_f32_bf16 v236, s12, v148
  v_dot2c_f32_bf16 v237, s12, v149
  v_dot2c_f32_bf16 v236, s12, v150
  v_dot2c_f32_bf16 v237, s12, v151
  v_dot2c_f32_bf16 v236, s12, v156
  v_dot2c_f32_bf16 v237, s12, v157
  v_dot2c_f32_bf16 v236, s12, v158
  v_dot2c_f32_bf16 v237, s12, v159
  v_dot2c_f32_bf16 v236, s12, v164
  v_dot2c_f32_bf16 v237, s12, v165
  v_dot2c_f32_bf16 v236, s12, v166
  v_dot2c_f32_bf16 v237, s12, v167
  v_dot2c_f32_bf16 v236, s12, v172
  v_dot2c_f32_bf16 v237, s12, v173
  v_dot2c_f32_bf16 v236, s12, v174
  v_dot2c_f32_bf16 v237, s12, v175
  v_dot2c_f32_bf16 v236, s12, v180
  v_dot2c_f32_bf16 v237, s12, v181
  v_dot2c_f32_bf16 v236, s12, v182
  v_dot2c_f32_bf16 v237, s12, v183
  v_dot2c_f32_bf16 v236, s12, v188
  v_dot2c_f32_bf16 v237, s12, v189
  v_dot2c_f32_bf16 v236, s12, v190
  v_dot2c_f32_bf16 v237, s12, v191
L_cse_4:
  v_mfma_f32_32x32x16_bf16 v[16:31], v[64:67], a[64:67], v[16:31]
  s_add_u32 m0, s83, 106496
  s_nop 0
  buffer_load_dwordx4 v11, s[32:35], s97 offen lds
  v_mfma_f32_32x32x16_bf16 v[32:47], a[64:67], v[68:71], v[32:47]
  buffer_load_dwordx4 v12, s[32:35], s97 offen offset:1024 lds
  ds_read_b64_tr_b16 v[96:97], v4 offset:0
  ds_read_b64_tr_b16 v[98:99], v4 offset:512
  ds_read_b64_tr_b16 v[100:101], v4 offset:1024
  ds_read_b64_tr_b16 v[102:103], v4 offset:1536
  s_waitcnt lgkmcnt(12)
  v_mfma_f32_32x32x16_bf16 v[16:31], v[72:75], a[68:71], v[16:31]
  s_add_u32 s101, s23, 0
  buffer_load_dword v192, v224, s[40:43], s101 offen
  v_mfma_f32_32x32x16_bf16 v[32:47], a[68:71], v[76:79], v[32:47]
  ds_read_b64_tr_b16 v[104:105], v4 offset:4096
  ds_read_b64_tr_b16 v[106:107], v4 offset:4608
  ds_read_b64_tr_b16 v[108:109], v4 offset:5120
  ds_read_b64_tr_b16 v[110:111], v4 offset:5632
  s_waitcnt lgkmcnt(12)
  v_mfma_f32_32x32x16_bf16 v[16:31], v[80:83], a[72:75], v[16:31]
  v_mfma_f32_32x32x16_bf16 v[32:47], a[72:75], v[84:87], v[32:47]
  ds_read_b64_tr_b16 v[112:113], v4 offset:8192
  ds_read_b64_tr_b16 v[114:115], v4 offset:8704
  ds_read_b64_tr_b16 v[116:117], v4 offset:9216
  ds_read_b64_tr_b16 v[118:119], v4 offset:9728
  s_waitcnt lgkmcnt(12)
  v_mfma_f32_32x32x16_bf16 v[16:31], v[88:91], a[76:79], v[16:31]
  v_mfma_f32_32x32x16_bf16 v[32:47], a[76:79], v[92:95], v[32:47]
  ds_read_b64_tr_b16 v[120:121], v4 offset:12288
  ds_read_b64_tr_b16 v[122:123], v4 offset:12800
  ds_read_b64_tr_b16 v[124:125], v4 offset:13312
  ds_read_b64_tr_b16 v[126:127], v4 offset:13824
  s_waitcnt lgkmcnt(12)
  v_mfma_f32_32x32x16_bf16 v[16:31], v[96:99], a[80:83], v[16:31]
  v_mfma_f32_32x32x16_bf16 v[32:47], a[80:83], v[100:103], v[32:47]
  s_waitcnt vmcnt(17)
  s_barrier
  ds_read_b64_tr_b16 v[128:129], v4 offset:16384
  ds_read_b64_tr_b16 v[130:131], v4 offset:16896
  ds_read_b64_tr_b16 v[132:133], v4 offset:17408
  ds_read_b64_tr_b16 v[134:135], v4 offset:17920
  s_waitcnt lgkmcnt(12)
  v_mfma_f32_32x32x16_bf16 v[16:31], v[104:107], a[84:87], v[16:31]
  s_add_u32 s101, s21, 0
  buffer_load_dword v192, v222, s[44:47], s101 offen
  v_mfma_f32_32x32x16_bf16 v[32:47], a[84:87], v[108:111], v[32:47]
  v_xor_b32 v252, 0x200, v230
  ds_read_b64_tr_b16 v[136:137], v4 offset:20480
  ds_read_b64_tr_b16 v[138:139], v4 offset:20992
  ds_read_b64_tr_b16 v[140:141], v4 offset:21504
  ds_read_b64_tr_b16 v[142:143], v4 offset:22016
  s_waitcnt lgkmcnt(12)
  v_mfma_f32_32x32x16_bf16 v[16:31], v[112:115], a[88:91], v[16:31]
  ds_read_b32 v217, v252
  v_mfma_f32_32x32x16_bf16 v[32:47], a[88:91], v[116:119], v[32:47]
  v_mov_b32 v253, 0x3b000000
  v_mov_b32 v254, 0x3727c5ac
  ds_read_b64_tr_b16 v[144:145], v4 offset:24576
  ds_read_b64_tr_b16 v[146:147], v4 offset:25088
  ds_read_b64_tr_b16 v[148:149], v4 offset:25600
  ds_read_b64_tr_b16 v[150:151], v4 offset:26112
  s_waitcnt lgkmcnt(13)
  v_mfma_f32_32x32x16_bf16 v[16:31], v[120:123], a[92:95], v[16:31]
  s_waitcnt lgkmcnt(4)
  v_add_f32 v216, v216, v217
  v_mov_b32 v217, v216
  v_mfma_f32_32x32x16_bf16 v[32:47], a[92:95], v[124:127], v[32:47]
  s_nop 0
  v_permlane32_swap_b32 v216, v217
  v_mul_f32 v232, -v253, v216
  v_mul_f32 v217, v253, v217
  ds_read_b64_tr_b16 v[152:153], v4 offset:28672
  ds_read_b64_tr_b16 v[154:155], v4 offset:29184
  ds_read_b64_tr_b16 v[156:157], v4 offset:29696
  ds_read_b64_tr_b16 v[158:159], v4 offset:30208
  s_cbranch_vccz L_csv_5
  v_dot2c_f32_bf16 v236, s12, v64
  v_dot2c_f32_bf16 v237, s12, v65
  v_dot2c_f32_bf16 v236, s12, v66
  v_dot2c_f32_bf16 v237, s12, v67
  v_dot2c_f32_bf16 v236, s12, v72
  v_dot2c_f32_bf16 v237, s12, v73
  v_dot2c_f32_bf16 v236, s12, v74
  v_dot2c_f32_bf16 v237, s12, v75
  v_dot2c_f32_bf16 v236, s12, v80
  v_dot2c_f32_bf16 v237, s12, v81
  v_dot2c_f32_bf16 v236, s12, v82
  v_dot2c_f32_bf16 v237, s12, v83
  v_dot2c_f32_bf16 v236, s12, v88
  v_dot2c_f32_bf16 v237, s12, v89
  v_dot2c_f32_bf16 v236, s12, v90
  v_dot2c_f32_bf16 v237, s12, v91
  v_dot2c_f32_bf16 v236, s12, v96
  v_dot2c_f32_bf16 v237, s12, v97
  v_dot2c_f32_bf16 v236, s12, v98
  v_dot2c_f32_bf16 v237, s12, v99
  v_dot2c_f32_bf16 v236, s12, v104
  v_dot2c_f32_bf16 v237, s12, v105
  v_dot2c_f32_bf16 v236, s12, v106
  v_dot2c_f32_bf16 v237, s12, v107
  v_dot2c_f32_bf16 v236, s12, v112
  v_dot2c_f32_bf16 v237, s12, v113
  v_dot2c_f32_bf16 v236, s12, v114
  v_dot2c_f32_bf16 v237, s12, v115
  v_dot2c_f32_bf16 v236, s12, v120
  v_dot2c_f32_bf16 v237, s12, v121
  v_dot2c_f32_bf16 v236, s12, v122
  v_dot2c_f32_bf16 v237, s12, v123
  s_branch L_cse_6
L_csv_5:
  v_dot2c_f32_bf16 v236, s12, v68
  v_dot2c_f32_bf16 v237, s12, v69
  v_dot2c_f32_bf16 v236, s12, v70
  v_dot2c_f32_bf16 v237, s12, v71
  v_dot2c_f32_bf16 v236, s12, v76
  v_dot2c_f32_bf16 v237, s12, v77
  v_dot2c_f32_bf16 v236, s12, v78
  v_dot2c_f32_bf16 v237, s12, v79
  v_dot2c_f32_bf16 v236, s12, v84
  v_dot2c_f32_bf16 v237, s12, v85
  v_dot2c_f32_bf16 v236, s12, v86
  v_dot2c_f32_bf16 v237, s12, v87
  v_dot2c_f32_bf16 v236, s12, v92
  v_dot2c_f32_bf16 v237, s12, v93
  v_dot2c_f32_bf16 v236, s12, v94
  v_dot2c_f32_bf16 v237, s12, v95
  v_dot2c_f32_bf16 v236, s12, v100
  v_dot2c_f32_bf16 v237, s12, v101
  v_dot2c_f32_bf16 v236, s12, v102
  v_dot2c_f32_bf16 v237, s12, v103
  v_dot2c_f32_bf16 v236, s12, v108
  v_dot2c_f32_bf16 v237, s12, v109
  v_dot2c_f32_bf16 v236, s12, v110
  v_dot2c_f32_bf16 v237, s12, v111
  v_dot2c_f32_bf16 v236, s12, v116
  v_dot2c_f32_bf16 v237, s12, v117
  v_dot2c_f32_bf16 v236, s12, v118
  v_dot2c_f32_bf16 v237, s12, v119
  v_dot2c_f32_bf16 v236, s12, v124
  v_dot2c_f32_bf16 v237, s12, v125
  v_dot2c_f32_bf16 v236, s12, v126
  v_dot2c_f32_bf16 v237, s12, v127
L_cse_6:
  v_mfma_f32_32x32x16_bf16 v[16:31], v[128:131], a[96:99], v[16:31]
  v_fma_f32 v217, -v232, v232, v217
  v_max_f32 v217, 0, v217
  v_add_f32 v217, v254, v217
  v_mfma_f32_32x32x16_bf16 v[32:47], a[96:99], v[132:135], v[32:47]
  v_rsq_f32 v217, v217
  s_mov_b32 s90, -1
  s_mov_b32 s91, 0
  ds_read_b64_tr_b16 v[160:161], v4 offset:32768
  ds_read_b64_tr_b16 v[162:163], v4 offset:33280
  ds_read_b64_tr_b16 v[164:165], v4 offset:33792
  ds_read_b64_tr_b16 v[166:167], v4 offset:34304
  v_mfma_f32_32x32x16_bf16 v[16:31], v[136:139], a[100:103], v[16:31]
  v_mul_f32 v234, 0x3fb8aa3b, v217
  v_mul_f32 v216, v232, v217
  v_mfma_f32_32x32x16_bf16 v[32:47], a[100:103], v[140:143], v[32:47]
  v_cndmask_b32 v216, v216, v217, s[90:91]
  ds_write_b32 v230, v216 offset:1024
  ds_read_b64_tr_b16 v[168:169], v4 offset:36864
  ds_read_b64_tr_b16 v[170:171], v4 offset:37376
  ds_read_b64_tr_b16 v[172:173], v4 offset:37888
  ds_read_b64_tr_b16 v[174:175], v4 offset:38400
  s_waitcnt lgkmcnt(13)
  v_mfma_f32_32x32x16_bf16 v[16:31], v[144:147], a[104:107], v[16:31]
  ds_read_b64_tr_b16 v[240:241], v225
  v_mfma_f32_32x32x16_bf16 v[32:47], a[104:107], v[148:151], v[32:47]
  ds_read_b64_tr_b16 v[242:243], v225 offset:256
  ds_read_b64_tr_b16 v[176:177], v4 offset:40960
  ds_read_b64_tr_b16 v[178:179], v4 offset:41472
  ds_read_b64_tr_b16 v[180:181], v4 offset:41984
  ds_read_b64_tr_b16 v[182:183], v4 offset:42496
  s_waitcnt lgkmcnt(15)
  v_mfma_f32_32x32x16_bf16 v[16:31], v[152:155], a[108:111], v[16:31]
  v_bfe_u32 v252, v1, 2, 1
  v_sub_u32 v252, 0, v252
  v_not_b32 v253, v252
  v_mfma_f32_32x32x16_bf16 v[32:47], a[108:111], v[156:159], v[32:47]
  s_waitcnt lgkmcnt(4)
  ds_read_b64_tr_b16 v[184:185], v4 offset:45056
  ds_read_b64_tr_b16 v[186:187], v4 offset:45568
  ds_read_b64_tr_b16 v[188:189], v4 offset:46080
  ds_read_b64_tr_b16 v[190:191], v4 offset:46592
  v_mfma_f32_32x32x16_bf16 v[16:31], v[160:163], a[112:115], v[16:31]
  v_and_b32 v244, v240, v252
  v_and_b32 v245, v241, v252
  v_mfma_f32_32x32x16_bf16 v[32:47], a[112:115], v[164:167], v[32:47]
  v_and_b32 v246, v242, v252
  v_and_b32 v247, v243, v252
  s_waitcnt lgkmcnt(0)
  s_cbranch_vccz L_csv_7
  v_dot2c_f32_bf16 v236, s12, v128
  v_dot2c_f32_bf16 v237, s12, v129
  v_dot2c_f32_bf16 v236, s12, v130
  v_dot2c_f32_bf16 v237, s12, v131
  v_dot2c_f32_bf16 v236, s12, v136
  v_dot2c_f32_bf16 v237, s12, v137
  v_dot2c_f32_bf16 v236, s12, v138
  v_dot2c_f32_bf16 v237, s12, v139
  v_dot2c_f32_bf16 v236, s12, v144
  v_dot2c_f32_bf16 v237, s12, v145
  v_dot2c_f32_bf16 v236, s12, v146
  v_dot2c_f32_bf16 v237, s12, v147
  v_dot2c_f32_bf16 v236, s12, v152
  v_dot2c_f32_bf16 v237, s12, v153
  v_dot2c_f32_bf16 v236, s12, v154
  v_dot2c_f32_bf16 v237, s12, v155
  v_dot2c_f32_bf16 v236, s12, v160
  v_dot2c_f32_bf16 v237, s12, v161
  v_dot2c_f32_bf16 v236, s12, v162
  v_dot2c_f32_bf16 v237, s12, v163
  v_dot2c_f32_bf16 v236, s12, v168
  v_dot2c_f32_bf16 v237, s12, v169
  v_dot2c_f32_bf16 v236, s12, v170
  v_dot2c_f32_bf16 v237, s12, v171
  v_dot2c_f32_bf16 v236, s12, v176
  v_dot2c_f32_bf16 v237, s12, v177
  v_dot2c_f32_bf16 v236, s12, v178
  v_dot2c_f32_bf16 v237, s12, v179
  v_dot2c_f32_bf16 v236, s12, v184
  v_dot2c_f32_bf16 v237, s12, v185
  v_dot2c_f32_bf16 v236, s12, v186
  v_dot2c_f32_bf16 v237, s12, v187
  s_branch L_cse_8
L_csv_7:
  v_dot2c_f32_bf16 v236, s12, v132
  v_dot2c_f32_bf16 v237, s12, v133
  v_dot2c_f32_bf16 v236, s12, v134
  v_dot2c_f32_bf16 v237, s12, v135
  v_dot2c_f32_bf16 v236, s12, v140
  v_dot2c_f32_bf16 v237, s12, v141
  v_dot2c_f32_bf16 v236, s12, v142
  v_dot2c_f32_bf16 v237, s12, v143
  v_dot2c_f32_bf16 v236, s12, v148
  v_dot2c_f32_bf16 v237, s12, v149
  v_dot2c_f32_bf16 v236, s12, v150
  v_dot2c_f32_bf16 v237, s12, v151
  v_dot2c_f32_bf16 v236, s12, v156
  v_dot2c_f32_bf16 v237, s12, v157
  v_dot2c_f32_bf16 v236, s12, v158
  v_dot2c_f32_bf16 v237, s12, v159
  v_dot2c_f32_bf16 v236, s12, v164
  v_dot2c_f32_bf16 v237, s12, v165
  v_dot2c_f32_bf16 v236, s12, v166
  v_dot2c_f32_bf16 v237, s12, v167
  v_dot2c_f32_bf16 v236, s12, v172
  v_dot2c_f32_bf16 v237, s12, v173
  v_dot2c_f32_bf16 v236, s12, v174
  v_dot2c_f32_bf16 v237, s12, v175
  v_dot2c_f32_bf16 v236, s12, v180
  v_dot2c_f32_bf16 v237, s12, v181
  v_dot2c_f32_bf16 v236, s12, v182
  v_dot2c_f32_bf16 v237, s12, v183
  v_dot2c_f32_bf16 v236, s12, v188
  v_dot2c_f32_bf16 v237, s12, v189
  v_dot2c_f32_bf16 v236, s12, v190
  v_dot2c_f32_bf16 v237, s12, v191
L_cse_8:
  s_nop 2
  v_add_f32 v236, v236, v237
  v_mov_b32 v237, v236
  s_nop 1
  v_permlane32_swap_b32 v236, v237
  v_add_f32 v236, v236, v237
  ds_write_b32 v230, v236 offset:2048
  v_mfma_f32_32x32x16_bf16 v[16:31], v[168:171], a[116:119], v[16:31]
  v_and_b32 v240, v240, v253
  v_and_b32 v241, v241, v253
  v_mfma_f32_32x32x16_bf16 v[32:47], a[116:119], v[172:175], v[32:47]
  v_and_b32 v242, v242, v253
  v_and_b32 v243, v243, v253
  s_waitcnt lgkmcnt(0)
  s_barrier
  ds_read_b128 v[196:199], v231 offset:0
  ds_read_b128 v[200:203], v231 offset:32
  ds_read_b128 v[204:207], v231 offset:64
  ds_read_b128 v[208:211], v231 offset:96
  ds_read_b32 v64, v235
  v_mfma_f32_32x32x16_bf16 v[16:31], v[176:179], a[120:123], v[16:31]
  v_mfma_f32_32x32x16_bf16 v[32:47], a[120:123], v[180:183], v[32:47]
  ds_read_b128 v[144:147], v223 offset:128
  ds_read_b128 v[148:151], v223 offset:160
  ds_read_b128 v[152:155], v223 offset:192
  ds_read_b128 v[156:159], v223 offset:224
  ds_read_b128 v[128:131], v223 offset:0
  ds_read_b128 v[132:135], v223 offset:32
  ds_read_b128 v[136:139], v223 offset:64
  ds_read_b128 v[140:143], v223 offset:96
  v_mfma_f32_32x32x16_bf16 v[16:31], v[184:187], a[124:127], v[16:31]
  v_mfma_f32_32x32x16_bf16 v[32:47], a[124:127], v[188:191], v[32:47]
  s_add_u32 s101, s21, 458752
  buffer_load_dword v192, v222, s[44:47], s101 offen
  v_mov_b32 v178, 0x3f803f80
  s_waitcnt lgkmcnt(4)
  v_pk_mul_f32 v[144:145], v[144:145], v[64:65] op_sel_hi:[1,0]
  v_pk_mul_f32 v[146:147], v[146:147], v[64:65] op_sel_hi:[1,0]
  v_pk_mul_f32 v[148:149], v[148:149], v[64:65] op_sel_hi:[1,0]
  v_pk_mul_f32 v[150:151], v[150:151], v[64:65] op_sel_hi:[1,0]
  v_pk_mul_f32 v[152:153], v[152:153], v[64:65] op_sel_hi:[1,0]
  v_pk_mul_f32 v[154:155], v[154:155], v[64:65] op_sel_hi:[1,0]
  v_pk_mul_f32 v[156:157], v[156:157], v[64:65] op_sel_hi:[1,0]
  v_pk_mul_f32 v[158:159], v[158:159], v[64:65] op_sel_hi:[1,0]
  v_pk_fma_f32 v[16:17], v[196:197], v[232:233], v[16:17] op_sel_hi:[1,0,1]
  v_pk_fma_f32 v[18:19], v[198:199], v[232:233], v[18:19] op_sel_hi:[1,0,1]
  v_pk_fma_f32 v[20:21], v[200:201], v[232:233], v[20:21] op_sel_hi:[1,0,1]
  v_pk_fma_f32 v[22:23], v[202:203], v[232:233], v[22:23] op_sel_hi:[1,0,1]
  v_pk_fma_f32 v[24:25], v[204:205], v[232:233], v[24:25] op_sel_hi:[1,0,1]
  v_pk_fma_f32 v[26:27], v[206:207], v[232:233], v[26:27] op_sel_hi:[1,0,1]
  v_pk_fma_f32 v[28:29], v[208:209], v[232:233], v[28:29] op_sel_hi:[1,0,1]
  v_pk_fma_f32 v[30:31], v[210:211], v[232:233], v[30:31] op_sel_hi:[1,0,1]
  v_cvt_pk_bf16_f32 v64, v16, v17
  v_cvt_pk_bf16_f32 v65, v18, v19
  v_cvt_pk_bf16_f32 v66, v20, v21
  v_cvt_pk_bf16_f32 v67, v22, v23
  v_cvt_pk_bf16_f32 v68, v24, v25
  v_cvt_pk_bf16_f32 v69, v26, v27
  v_cvt_pk_bf16_f32 v70, v28, v29
  v_cvt_pk_bf16_f32 v71, v30, v31
  s_waitcnt lgkmcnt(0)
  v_pk_fma_f32 v[32:33], v[32:33], v[128:129], v[144:145]
  v_pk_fma_f32 v[34:35], v[34:35], v[130:131], v[146:147]
  v_pk_fma_f32 v[36:37], v[36:37], v[132:133], v[148:149]
  v_pk_fma_f32 v[38:39], v[38:39], v[134:135], v[150:151]
  v_pk_fma_f32 v[40:41], v[40:41], v[136:137], v[152:153]
  v_pk_fma_f32 v[42:43], v[42:43], v[138:139], v[154:155]
  v_pk_fma_f32 v[44:45], v[44:45], v[140:141], v[156:157]
  v_pk_fma_f32 v[46:47], v[46:47], v[142:143], v[158:159]
  v_mfma_f32_32x32x16_bf16 v[80:95], v[240:243], v[64:67], 0
  v_mfma_f32_32x32x16_bf16 v[80:95], v[244:247], v[68:71], v[80:95]
  v_cvt_pk_bf16_f32 v72, v32, v33
  v_cvt_pk_bf16_f32 v73, v34, v35
  v_cvt_pk_bf16_f32 v74, v36, v37
  v_cvt_pk_bf16_f32 v75, v38, v39
  v_cvt_pk_bf16_f32 v76, v40, v41
  v_cvt_pk_bf16_f32 v77, v42, v43
  v_cvt_pk_bf16_f32 v78, v44, v45
  v_cvt_pk_bf16_f32 v79, v46, v47
  ds_write_b128 v8, v[72:75] offset:0
  ds_write_b128 v8, v[76:79] offset:1024
  v_cndmask_b32 v96, v72, v178, s[26:27]
  v_cndmask_b32 v97, v73, v178, s[26:27]
  v_cndmask_b32 v98, v74, v178, s[26:27]
  v_cndmask_b32 v99, v75, v178, s[26:27]
  v_cndmask_b32 v100, v76, v178, s[26:27]
  v_cndmask_b32 v101, v77, v178, s[26:27]
  v_cndmask_b32 v102, v78, v178, s[26:27]
  v_cndmask_b32 v103, v79, v178, s[26:27]
  v_max3_f32 v160, v80, v81, v82
  v_min3_f32 v162, v80, v81, v82
  v_max3_f32 v160, v160, v83, v84
  v_min3_f32 v162, v162, v83, v84
  v_max3_f32 v160, v160, v85, v86
  v_min3_f32 v162, v162, v85, v86
  v_max3_f32 v160, v160, v87, v88
  v_min3_f32 v162, v162, v87, v88
  v_max3_f32 v160, v160, v89, v90
  v_min3_f32 v162, v162, v89, v90
  v_max3_f32 v160, v160, v91, v92
  v_min3_f32 v162, v162, v91, v92
  v_max3_f32 v160, v160, v93, v94
  v_min3_f32 v162, v162, v93, v94
  v_max_f32 v160, v160, v95
  v_min_f32 v162, v162, v95
  v_mul_f32 v160, v234, v160
  v_mul_f32 v162, v234, v162
  v_pk_fma_f32 v[128:129], v[80:81], v[234:235], v[160:161] op_sel_hi:[1,0,0] neg_lo:[0,0,1] neg_hi:[0,0,1]
  v_pk_fma_f32 v[144:145], v[80:81], v[234:235], v[162:163] op_sel_hi:[1,0,0] neg_lo:[1,0,0] neg_hi:[1,0,0]
  v_pk_fma_f32 v[130:131], v[82:83], v[234:235], v[160:161] op_sel_hi:[1,0,0] neg_lo:[0,0,1] neg_hi:[0,0,1]
  v_pk_fma_f32 v[146:147], v[82:83], v[234:235], v[162:163] op_sel_hi:[1,0,0] neg_lo:[1,0,0] neg_hi:[1,0,0]
  v_pk_fma_f32 v[132:133], v[84:85], v[234:235], v[160:161] op_sel_hi:[1,0,0] neg_lo:[0,0,1] neg_hi:[0,0,1]
  v_pk_fma_f32 v[148:149], v[84:85], v[234:235], v[162:163] op_sel_hi:[1,0,0] neg_lo:[1,0,0] neg_hi:[1,0,0]
  v_pk_fma_f32 v[134:135], v[86:87], v[234:235], v[160:161] op_sel_hi:[1,0,0] neg_lo:[0,0,1] neg_hi:[0,0,1]
  v_pk_fma_f32 v[150:151], v[86:87], v[234:235], v[162:163] op_sel_hi:[1,0,0] neg_lo:[1,0,0] neg_hi:[1,0,0]
  v_pk_fma_f32 v[136:137], v[88:89], v[234:235], v[160:161] op_sel_hi:[1,0,0] neg_lo:[0,0,1] neg_hi:[0,0,1]
  v_pk_fma_f32 v[152:153], v[88:89], v[234:235], v[162:163] op_sel_hi:[1,0,0] neg_lo:[1,0,0] neg_hi:[1,0,0]
  v_pk_fma_f32 v[138:139], v[90:91], v[234:235], v[160:161] op_sel_hi:[1,0,0] neg_lo:[0,0,1] neg_hi:[0,0,1]
  v_pk_fma_f32 v[154:155], v[90:91], v[234:235], v[162:163] op_sel_hi:[1,0,0] neg_lo:[1,0,0] neg_hi:[1,0,0]
  v_pk_fma_f32 v[140:141], v[92:93], v[234:235], v[160:161] op_sel_hi:[1,0,0] neg_lo:[0,0,1] neg_hi:[0,0,1]
  v_pk_fma_f32 v[156:157], v[92:93], v[234:235], v[162:163] op_sel_hi:[1,0,0] neg_lo:[1,0,0] neg_hi:[1,0,0]
  v_pk_fma_f32 v[142:143], v[94:95], v[234:235], v[160:161] op_sel_hi:[1,0,0] neg_lo:[0,0,1] neg_hi:[0,0,1]
  v_pk_fma_f32 v[158:159], v[94:95], v[234:235], v[162:163] op_sel_hi:[1,0,0] neg_lo:[1,0,0] neg_hi:[1,0,0]
  v_exp_f32 v128, v128
  v_exp_f32 v144, v144
  v_exp_f32 v129, v129
  v_exp_f32 v145, v145
  v_exp_f32 v130, v130
  v_exp_f32 v146, v146
  v_exp_f32 v131, v131
  v_exp_f32 v147, v147
  v_exp_f32 v132, v132
  v_exp_f32 v148, v148
  v_exp_f32 v133, v133
  v_exp_f32 v149, v149
  v_exp_f32 v134, v134
  v_exp_f32 v150, v150
  v_exp_f32 v135, v135
  v_exp_f32 v151, v151
  v_exp_f32 v136, v136
  v_exp_f32 v152, v152
  v_exp_f32 v137, v137
  v_exp_f32 v153, v153
  v_exp_f32 v138, v138
  v_exp_f32 v154, v154
  v_exp_f32 v139, v139
  v_exp_f32 v155, v155
  v_exp_f32 v140, v140
  v_exp_f32 v156, v156
  v_exp_f32 v141, v141
  v_exp_f32 v157, v157
  v_exp_f32 v142, v142
  v_exp_f32 v158, v158
  v_exp_f32 v143, v143
  v_exp_f32 v159, v159
  v_pk_add_f32 v[80:81], v[128:129], v[130:131]
  v_pk_add_f32 v[88:89], v[144:145], v[146:147]
  v_pk_add_f32 v[82:83], v[132:133], v[134:135]
  v_pk_add_f32 v[90:91], v[148:149], v[150:151]
  v_pk_add_f32 v[84:85], v[136:137], v[138:139]
  v_pk_add_f32 v[92:93], v[152:153], v[154:155]
  v_pk_add_f32 v[86:87], v[140:141], v[142:143]
  v_pk_add_f32 v[94:95], v[156:157], v[158:159]
  v_pk_add_f32 v[80:81], v[80:81], v[82:83]
  v_pk_add_f32 v[88:89], v[88:89], v[90:91]
  v_pk_add_f32 v[84:85], v[84:85], v[86:87]
  v_pk_add_f32 v[92:93], v[92:93], v[94:95]
  v_pk_add_f32 v[80:81], v[80:81], v[84:85]
  v_pk_add_f32 v[88:89], v[88:89], v[92:93]
  v_add_f32 v80, v80, v81
  v_add_f32 v88, v88, v89
  v_rcp_f32 v80, v80
  v_rcp_f32 v88, v88
  v_pk_mul_f32 v[128:129], v[128:129], v[80:81] op_sel_hi:[1,0]
  v_pk_mul_f32 v[144:145], v[144:145], v[88:89] op_sel_hi:[1,0]
  v_pk_mul_f32 v[130:131], v[130:131], v[80:81] op_sel_hi:[1,0]
  v_pk_mul_f32 v[146:147], v[146:147], v[88:89] op_sel_hi:[1,0]
  v_pk_mul_f32 v[132:133], v[132:133], v[80:81] op_sel_hi:[1,0]
  v_pk_mul_f32 v[148:149], v[148:149], v[88:89] op_sel_hi:[1,0]
  v_pk_mul_f32 v[134:135], v[134:135], v[80:81] op_sel_hi:[1,0]
  v_pk_mul_f32 v[150:151], v[150:151], v[88:89] op_sel_hi:[1,0]
  v_pk_mul_f32 v[136:137], v[136:137], v[80:81] op_sel_hi:[1,0]
  v_pk_mul_f32 v[152:153], v[152:153], v[88:89] op_sel_hi:[1,0]
  v_pk_mul_f32 v[138:139], v[138:139], v[80:81] op_sel_hi:[1,0]
  v_pk_mul_f32 v[154:155], v[154:155], v[88:89] op_sel_hi:[1,0]
  v_pk_mul_f32 v[140:141], v[140:141], v[80:81] op_sel_hi:[1,0]
  v_pk_mul_f32 v[156:157], v[156:157], v[88:89] op_sel_hi:[1,0]
  v_pk_mul_f32 v[142:143], v[142:143], v[80:81] op_sel_hi:[1,0]
  v_pk_mul_f32 v[158:159], v[158:159], v[88:89] op_sel_hi:[1,0]
  v_cvt_pk_bf16_f32 v112, v128, v129
  v_cvt_pk_bf16_f32 v120, v144, v145
  v_cvt_pk_bf16_f32 v113, v130, v131
  v_cvt_pk_bf16_f32 v121, v146, v147
  v_cvt_pk_bf16_f32 v114, v132, v133
  v_cvt_pk_bf16_f32 v122, v148, v149
  v_cvt_pk_bf16_f32 v115, v134, v135
  v_cvt_pk_bf16_f32 v123, v150, v151
  v_cvt_pk_bf16_f32 v116, v136, v137
  v_cvt_pk_bf16_f32 v124, v152, v153
  v_cvt_pk_bf16_f32 v117, v138, v139
  v_cvt_pk_bf16_f32 v125, v154, v155
  v_cvt_pk_bf16_f32 v118, v140, v141
  v_cvt_pk_bf16_f32 v126, v156, v157
  v_cvt_pk_bf16_f32 v119, v142, v143
  v_cvt_pk_bf16_f32 v127, v158, v159
  ds_write_b128 v228, v[112:115]
  v_xor_b32 v180, 16, v228
  ds_write_b128 v180, v[116:119]
  v_xor_b32 v181, 32, v228
  ds_write_b128 v181, v[120:123]
  v_xor_b32 v182, 48, v228
  ds_write_b128 v182, v[124:127]
  ds_read_b64_tr_b16 v[128:129], v229 offset:0
  ds_read_b64_tr_b16 v[130:131], v229 offset:512
  ds_read_b64_tr_b16 v[132:133], v229 offset:1024
  ds_read_b64_tr_b16 v[134:135], v229 offset:1536
  s_waitcnt vmcnt(3) lgkmcnt(4)
  s_barrier
  ds_read_b128 v[72:75], v195 offset:0
  ds_read_b128 v[76:79], v195 offset:1024
  ds_read_b64_tr_b16 v[136:137], v227 offset:0
  ds_read_b64_tr_b16 v[138:139], v227 offset:512
  ds_read_b64_tr_b16 v[140:141], v227 offset:1024
  ds_read_b64_tr_b16 v[142:143], v227 offset:1536
  s_waitcnt lgkmcnt(8)
  v_mfma_f32_32x32x16_bf16 v[144:159], v[128:131], v[96:99], 0
  s_waitcnt lgkmcnt(6)
  v_mfma_f32_32x32x16_bf16 v[144:159], v[132:135], v[100:103], v[144:159]
  s_waitcnt lgkmcnt(4)
  v_cndmask_b32 v104, v72, v178, s[26:27]
  v_cndmask_b32 v105, v73, v178, s[26:27]
  v_cndmask_b32 v106, v74, v178, s[26:27]
  v_cndmask_b32 v107, v75, v178, s[26:27]
  v_cndmask_b32 v108, v76, v178, s[26:27]
  v_cndmask_b32 v109, v77, v178, s[26:27]
  v_cndmask_b32 v110, v78, v178, s[26:27]
  v_cndmask_b32 v111, v79, v178, s[26:27]
  s_waitcnt lgkmcnt(2)
  v_mfma_f32_32x32x16_bf16 v[144:159], v[136:139], v[104:107], v[144:159]
  s_waitcnt lgkmcnt(0)
  v_mfma_f32_32x32x16_bf16 v[144:159], v[140:143], v[108:111], v[144:159]
  ds_read_b64_tr_b16 v[64:65], v7 offset:0
  ds_read_b64_tr_b16 v[66:67], v7 offset:512
  ds_read_b64_tr_b16 v[68:69], v7 offset:2048
  ds_read_b64_tr_b16 v[70:71], v7 offset:2560
  ds_read_b64_tr_b16 v[72:73], v7 offset:4096
  ds_read_b64_tr_b16 v[74:75], v7 offset:4608
  ds_read_b64_tr_b16 v[76:77], v7 offset:6144
  ds_read_b64_tr_b16 v[78:79], v7 offset:6656
  s_nop 3
  v_bfi_b32 v144, v220, v221, v144
  v_bfi_b32 v145, v220, v221, v145
  v_bfi_b32 v146, v220, v221, v146
  v_bfi_b32 v147, v220, v221, v147
  buffer_store_dwordx4 v[144:147], v226, s[64:67], s84 offen sc1
  v_bfi_b32 v148, v220, v221, v148
  v_bfi_b32 v149, v220, v221, v149
  v_bfi_b32 v150, v220, v221, v150
  v_bfi_b32 v151, v220, v221, v151
  buffer_store_dwordx4 v[148:151], v226, s[64:67], s85 offen sc1
  v_bfi_b32 v152, v220, v221, v152
  v_bfi_b32 v153, v220, v221, v153
  v_bfi_b32 v154, v220, v221, v154
  v_bfi_b32 v155, v220, v221, v155
  buffer_store_dwordx4 v[152:155], v226, s[64:67], s86 offen sc1
  v_bfi_b32 v156, v220, v221, v156
  v_bfi_b32 v157, v220, v221, v157
  v_bfi_b32 v158, v220, v221, v158
  v_bfi_b32 v159, v220, v221, v159
  buffer_store_dwordx4 v[156:159], v226, s[64:67], s87 offen sc1
  s_add_u32 s101, s21, 917504
  buffer_load_dword v192, v222, s[44:47], s101 offen
  ds_read_b64_tr_b16 v[80:81], v7 offset:8192
  ds_read_b64_tr_b16 v[82:83], v7 offset:8704
  s_waitcnt lgkmcnt(8)
  v_mfma_f32_32x32x16_bf16 v[48:63], v[64:67], a[0:3], 0
  ds_read_b64_tr_b16 v[84:85], v7 offset:10240
  ds_read_b64_tr_b16 v[86:87], v7 offset:10752
  s_waitcnt lgkmcnt(8)
  v_mfma_f32_32x32x16_bf16 v[48:63], v[68:71], a[4:7], v[48:63]
  ds_read_b64_tr_b16 v[88:89], v7 offset:12288
  ds_read_b64_tr_b16 v[90:91], v7 offset:12800
  s_waitcnt lgkmcnt(8)
  v_mfma_f32_32x32x16_bf16 v[48:63], v[72:75], a[8:11], v[48:63]
  ds_read_b64_tr_b16 v[92:93], v7 offset:14336
  ds_read_b64_tr_b16 v[94:95], v7 offset:14848
  s_waitcnt lgkmcnt(8)
  v_mfma_f32_32x32x16_bf16 v[48:63], v[76:79], a[12:15], v[48:63]
  ds_read_b64_tr_b16 v[96:97], v7 offset:16384
  ds_read_b64_tr_b16 v[98:99], v7 offset:16896
  s_waitcnt lgkmcnt(8)
  v_mfma_f32_32x32x16_bf16 v[48:63], v[80:83], a[16:19], v[48:63]
  ds_read_b64_tr_b16 v[100:101], v7 offset:18432
  ds_read_b64_tr_b16 v[102:103], v7 offset:18944
  s_waitcnt lgkmcnt(8)
  v_mfma_f32_32x32x16_bf16 v[48:63], v[84:87], a[20:23], v[48:63]
  ds_read_b64_tr_b16 v[104:105], v7 offset:20480
  ds_read_b64_tr_b16 v[106:107], v7 offset:20992
  s_waitcnt lgkmcnt(8)
  v_mfma_f32_32x32x16_bf16 v[48:63], v[88:91], a[24:27], v[48:63]
  ds_read_b64_tr_b16 v[108:109], v7 offset:22528
  ds_read_b64_tr_b16 v[110:111], v7 offset:23040
  s_waitcnt lgkmcnt(8)
  v_mfma_f32_32x32x16_bf16 v[48:63], v[92:95], a[28:31], v[48:63]
  ds_read_b64_tr_b16 v[112:113], v7 offset:24576
  ds_read_b64_tr_b16 v[114:115], v7 offset:25088
  s_waitcnt lgkmcnt(8)
  v_mfma_f32_32x32x16_bf16 v[48:63], v[96:99], a[32:35], v[48:63]
  ds_read_b64_tr_b16 v[116:117], v7 offset:26624
  ds_read_b64_tr_b16 v[118:119], v7 offset:27136
  s_waitcnt lgkmcnt(8)
  v_mfma_f32_32x32x16_bf16 v[48:63], v[100:103], a[36:39], v[48:63]
  ds_read_b64_tr_b16 v[120:121], v7 offset:28672
  ds_read_b64_tr_b16 v[122:123], v7 offset:29184
  s_waitcnt lgkmcnt(8)
  v_mfma_f32_32x32x16_bf16 v[48:63], v[104:107], a[40:43], v[48:63]
  ds_read_b64_tr_b16 v[124:125], v7 offset:30720
  ds_read_b64_tr_b16 v[126:127], v7 offset:31232
  s_waitcnt lgkmcnt(8)
  v_mfma_f32_32x32x16_bf16 v[48:63], v[108:111], a[44:47], v[48:63]
  ds_read_b64_tr_b16 v[128:129], v7 offset:32768
  ds_read_b64_tr_b16 v[130:131], v7 offset:33280
  s_waitcnt lgkmcnt(8)
  v_mfma_f32_32x32x16_bf16 v[48:63], v[112:115], a[48:51], v[48:63]
  ds_read_b64_tr_b16 v[132:133], v7 offset:34816
  ds_read_b64_tr_b16 v[134:135], v7 offset:35328
  s_waitcnt lgkmcnt(8)
  v_mfma_f32_32x32x16_bf16 v[48:63], v[116:119], a[52:55], v[48:63]
  ds_read_b64_tr_b16 v[136:137], v7 offset:36864
  ds_read_b64_tr_b16 v[138:139], v7 offset:37376
  s_waitcnt lgkmcnt(8)
  v_mfma_f32_32x32x16_bf16 v[48:63], v[120:123], a[56:59], v[48:63]
  ds_read_b64_tr_b16 v[140:141], v7 offset:38912
  ds_read_b64_tr_b16 v[142:143], v7 offset:39424
  s_waitcnt lgkmcnt(8)
  v_mfma_f32_32x32x16_bf16 v[48:63], v[124:127], a[60:63], v[48:63]
  ds_read_b64_tr_b16 v[196:197], v7 offset:40960
  ds_read_b64_tr_b16 v[198:199], v7 offset:41472
  s_waitcnt lgkmcnt(8)
  v_mfma_f32_32x32x16_bf16 v[48:63], v[128:131], a[64:67], v[48:63]
  ds_read_b64_tr_b16 v[200:201], v7 offset:43008
  ds_read_b64_tr_b16 v[202:203], v7 offset:43520
  s_waitcnt lgkmcnt(8)
  v_mfma_f32_32x32x16_bf16 v[48:63], v[132:135], a[68:71], v[48:63]
  ds_read_b64_tr_b16 v[204:205], v7 offset:45056
  ds_read_b64_tr_b16 v[206:207], v7 offset:45568
  s_waitcnt lgkmcnt(8)
  v_mfma_f32_32x32x16_bf16 v[48:63], v[136:139], a[72:75], v[48:63]
  ds_read_b64_tr_b16 v[208:209], v7 offset:47104
  ds_read_b64_tr_b16 v[210:211], v7 offset:47616
  s_waitcnt lgkmcnt(8)
  v_mfma_f32_32x32x16_bf16 v[48:63], v[140:143], a[76:79], v[48:63]
  ds_read_b64_tr_b16 v[160:161], v10 offset:49152
  ds_read_b64_tr_b16 v[162:163], v10 offset:49664
  s_waitcnt lgkmcnt(8)
  v_mfma_f32_32x32x16_bf16 v[48:63], v[196:199], a[80:83], v[48:63]
  ds_read_b64_tr_b16 v[164:165], v10 offset:51200
  ds_read_b64_tr_b16 v[166:167], v10 offset:51712
  s_waitcnt lgkmcnt(8)
  v_mfma_f32_32x32x16_bf16 v[48:63], v[200:203], a[84:87], v[48:63]
  ds_read_b64_tr_b16 v[168:169], v10 offset:53248
  ds_read_b64_tr_b16 v[170:171], v10 offset:53760
  s_waitcnt lgkmcnt(8)
  v_mfma_f32_32x32x16_bf16 v[48:63], v[204:207], a[88:91], v[48:63]
  ds_read_b64_tr_b16 v[172:173], v10 offset:55296
  ds_read_b64_tr_b16 v[174:175], v10 offset:55808
  s_waitcnt lgkmcnt(8)
  v_mfma_f32_32x32x16_bf16 v[48:63], v[208:211], a[92:95], v[48:63]
  ds_read_b64_tr_b16 v[176:177], v10 offset:57344
  ds_read_b64_tr_b16 v[178:179], v10 offset:57856
  s_waitcnt lgkmcnt(8)
  v_mfma_f32_32x32x16_bf16 v[48:63], v[160:163], a[96:99], v[48:63]
  ds_read_b64_tr_b16 v[180:181], v10 offset:59392
  ds_read_b64_tr_b16 v[182:183], v10 offset:59904
  s_waitcnt lgkmcnt(8)
  v_mfma_f32_32x32x16_bf16 v[48:63], v[164:167], a[100:103], v[48:63]
  ds_read_b64_tr_b16 v[184:185], v10 offset:61440
  ds_read_b64_tr_b16 v[186:187], v10 offset:61952
  s_waitcnt lgkmcnt(8)
  v_mfma_f32_32x32x16_bf16 v[48:63], v[168:171], a[104:107], v[48:63]
  ds_read_b64_tr_b16 v[188:189], v10 offset:63488
  ds_read_b64_tr_b16 v[190:191], v10 offset:64000
  s_waitcnt lgkmcnt(8)
  v_mfma_f32_32x32x16_bf16 v[48:63], v[172:175], a[108:111], v[48:63]
  s_waitcnt lgkmcnt(0)
  s_cbranch_vccz L_cq_9
  v_dot2c_f32_bf16 v238, s12, v64
  v_dot2c_f32_bf16 v239, s12, v65
  v_dot2c_f32_bf16 v238, s12, v66
  v_dot2c_f32_bf16 v239, s12, v67
  v_dot2c_f32_bf16 v238, s12, v68
  v_dot2c_f32_bf16 v239, s12, v69
  v_dot2c_f32_bf16 v238, s12, v70
  v_dot2c_f32_bf16 v239, s12, v71
  v_dot2c_f32_bf16 v238, s12, v72
  v_dot2c_f32_bf16 v239, s12, v73
  v_dot2c_f32_bf16 v238, s12, v74
  v_dot2c_f32_bf16 v239, s12, v75
  v_dot2c_f32_bf16 v238, s12, v76
  v_dot2c_f32_bf16 v239, s12, v77
  v_dot2c_f32_bf16 v238, s12, v78
  v_dot2c_f32_bf16 v239, s12, v79
  v_dot2c_f32_bf16 v238, s12, v80
  v_dot2c_f32_bf16 v239, s12, v81
  v_dot2c_f32_bf16 v238, s12, v82
  v_dot2c_f32_bf16 v239, s12, v83
  v_dot2c_f32_bf16 v238, s12, v84
  v_dot2c_f32_bf16 v239, s12, v85
  v_dot2c_f32_bf16 v238, s12, v86
  v_dot2c_f32_bf16 v239, s12, v87
  v_dot2c_f32_bf16 v238, s12, v88
  v_dot2c_f32_bf16 v239, s12, v89
  v_dot2c_f32_bf16 v238, s12, v90
  v_dot2c_f32_bf16 v239, s12, v91
  v_dot2c_f32_bf16 v238, s12, v92
  v_dot2c_f32_bf16 v239, s12, v93
  v_dot2c_f32_bf16 v238, s12, v94
  v_dot2c_f32_bf16 v239, s12, v95
  v_dot2c_f32_bf16 v238, s12, v96
  v_dot2c_f32_bf16 v239, s12, v97
  v_dot2c_f32_bf16 v238, s12, v98
  v_dot2c_f32_bf16 v239, s12, v99
  v_dot2c_f32_bf16 v238, s12, v100
  v_dot2c_f32_bf16 v239, s12, v101
  v_dot2c_f32_bf16 v238, s12, v102
  v_dot2c_f32_bf16 v239, s12, v103
  v_dot2c_f32_bf16 v238, s12, v104
  v_dot2c_f32_bf16 v239, s12, v105
  v_dot2c_f32_bf16 v238, s12, v106
  v_dot2c_f32_bf16 v239, s12, v107
  v_dot2c_f32_bf16 v238, s12, v108
  v_dot2c_f32_bf16 v239, s12, v109
  v_dot2c_f32_bf16 v238, s12, v110
  v_dot2c_f32_bf16 v239, s12, v111
  v_dot2c_f32_bf16 v238, s12, v112
  v_dot2c_f32_bf16 v239, s12, v113
  v_dot2c_f32_bf16 v238, s12, v114
  v_dot2c_f32_bf16 v239, s12, v115
  v_dot2c_f32_bf16 v238, s12, v116
  v_dot2c_f32_bf16 v239, s12, v117
  v_dot2c_f32_bf16 v238, s12, v118
  v_dot2c_f32_bf16 v239, s12, v119
  v_dot2c_f32_bf16 v238, s12, v120
  v_dot2c_f32_bf16 v239, s12, v121
  v_dot2c_f32_bf16 v238, s12, v122
  v_dot2c_f32_bf16 v239, s12, v123
  v_dot2c_f32_bf16 v238, s12, v124
  v_dot2c_f32_bf16 v239, s12, v125
  v_dot2c_f32_bf16 v238, s12, v126
  v_dot2c_f32_bf16 v239, s12, v127
  s_branch L_cqe_10
L_cq_9:
  v_dot2c_f32_bf16 v238, s12, v128
  v_dot2c_f32_bf16 v239, s12, v129
  v_dot2c_f32_bf16 v238, s12, v130
  v_dot2c_f32_bf16 v239, s12, v131
  v_dot2c_f32_bf16 v238, s12, v132
  v_dot2c_f32_bf16 v239, s12, v133
  v_dot2c_f32_bf16 v238, s12, v134
  v_dot2c_f32_bf16 v239, s12, v135
  v_dot2c_f32_bf16 v238, s12, v136
  v_dot2c_f32_bf16 v239, s12, v137
  v_dot2c_f32_bf16 v238, s12, v138
  v_dot2c_f32_bf16 v239, s12, v139
  v_dot2c_f32_bf16 v238, s12, v140
  v_dot2c_f32_bf16 v239, s12, v141
  v_dot2c_f32_bf16 v238, s12, v142
  v_dot2c_f32_bf16 v239, s12, v143
  v_dot2c_f32_bf16 v238, s12, v196
  v_dot2c_f32_bf16 v239, s12, v197
  v_dot2c_f32_bf16 v238, s12, v198
  v_dot2c_f32_bf16 v239, s12, v199
  v_dot2c_f32_bf16 v238, s12, v200
  v_dot2c_f32_bf16 v239, s12, v201
  v_dot2c_f32_bf16 v238, s12, v202
  v_dot2c_f32_bf16 v239, s12, v203
  v_dot2c_f32_bf16 v238, s12, v204
  v_dot2c_f32_bf16 v239, s12, v205
  v_dot2c_f32_bf16 v238, s12, v206
  v_dot2c_f32_bf16 v239, s12, v207
  v_dot2c_f32_bf16 v238, s12, v208
  v_dot2c_f32_bf16 v239, s12, v209
  v_dot2c_f32_bf16 v238, s12, v210
  v_dot2c_f32_bf16 v239, s12, v211
  v_dot2c_f32_bf16 v238, s12, v160
  v_dot2c_f32_bf16 v239, s12, v161
  v_dot2c_f32_bf16 v238, s12, v162
  v_dot2c_f32_bf16 v239, s12, v163
  v_dot2c_f32_bf16 v238, s12, v164
  v_dot2c_f32_bf16 v239, s12, v165
  v_dot2c_f32_bf16 v238, s12, v166
  v_dot2c_f32_bf16 v239, s12, v167
  v_dot2c_f32_bf16 v238, s12, v168
  v_dot2c_f32_bf16 v239, s12, v169
  v_dot2c_f32_bf16 v238, s12, v170
  v_dot2c_f32_bf16 v239, s12, v171
  v_dot2c_f32_bf16 v238, s12, v172
  v_dot2c_f32_bf16 v239, s12, v173
  v_dot2c_f32_bf16 v238, s12, v174
  v_dot2c_f32_bf16 v239, s12, v175
  v_dot2c_f32_bf16 v238, s12, v176
  v_dot2c_f32_bf16 v239, s12, v177
  v_dot2c_f32_bf16 v238, s12, v178
  v_dot2c_f32_bf16 v239, s12, v179
  v_dot2c_f32_bf16 v238, s12, v180
  v_dot2c_f32_bf16 v239, s12, v181
  v_dot2c_f32_bf16 v238, s12, v182
  v_dot2c_f32_bf16 v239, s12, v183
  v_dot2c_f32_bf16 v238, s12, v184
  v_dot2c_f32_bf16 v239, s12, v185
  v_dot2c_f32_bf16 v238, s12, v186
  v_dot2c_f32_bf16 v239, s12, v187
  v_dot2c_f32_bf16 v238, s12, v188
  v_dot2c_f32_bf16 v239, s12, v189
  v_dot2c_f32_bf16 v238, s12, v190
  v_dot2c_f32_bf16 v239, s12, v191
L_cqe_10:
  s_nop 2
  v_add_f32 v238, v238, v239
  v_mov_b32 v239, v238
  s_nop 1
  v_permlane32_swap_b32 v238, v239
  v_add_f32 v238, v238, v239
  ds_write_b32 v230, v238 offset:3072
  v_mfma_f32_32x32x16_bf16 v[48:63], v[176:179], a[112:115], v[48:63]
  s_lshl_b32 s100, s74, 5
  s_add_u32 s100, s100, s73
  s_mul_i32 s17, s100, 8704
  s_add_u32 s17, s17, 524288
  s_lshl_b32 s100, s68, 11
  v_add_u32 v226, s100, v2
  v_mfma_f32_32x32x16_bf16 v[48:63], v[180:183], a[116:119], v[48:63]
  v_and_b32 v227, 7, v1
  s_lshl_b32 s100, s68, 7
  s_add_u32 s100, s100, 8192
  v_lshl_add_u32 v227, v227, 4, s100
  s_waitcnt lgkmcnt(0)
  s_barrier
  ds_read_b128 v[128:131], v231 offset:1024
  ds_read_b128 v[132:135], v231 offset:1056
  ds_read_b128 v[136:139], v231 offset:1088
  ds_read_b128 v[140:143], v231 offset:1120
  v_mfma_f32_32x32x16_bf16 v[48:63], v[184:187], a[120:123], v[48:63]
  ds_read_b128 v[144:147], v231 offset:1280
  ds_read_b128 v[148:151], v231 offset:1312
  ds_read_b128 v[152:155], v231 offset:1344
  ds_read_b128 v[156:159], v231 offset:1376
  v_mfma_f32_32x32x16_bf16 v[48:63], v[188:191], a[124:127], v[48:63]
  s_lshl1_add_u32 s100, s73, s20
  s_lshl_b32 s100, s100, 15
  s_lshl1_add_u32 s101, s77, s19
  s_lshl_b32 s101, s101, 12
  s_add_u32 s100, s100, s101
  s_lshr_b32 s101, s74, 2
  s_lshl_b32 s101, s101, 21
  s_add_u32 s100, s100, s101
  s_add_u32 s3, s100, 4194304
  s_waitcnt lgkmcnt(4)
  s_nop 1
  v_pk_fma_f32 v[48:49], v[128:129], v[232:233], v[48:49] op_sel_hi:[1,0,1]
  v_pk_fma_f32 v[50:51], v[130:131], v[232:233], v[50:51] op_sel_hi:[1,0,1]
  v_pk_fma_f32 v[52:53], v[132:133], v[232:233], v[52:53] op_sel_hi:[1,0,1]
  v_pk_fma_f32 v[54:55], v[134:135], v[232:233], v[54:55] op_sel_hi:[1,0,1]
  v_pk_fma_f32 v[56:57], v[136:137], v[232:233], v[56:57] op_sel_hi:[1,0,1]
  v_pk_fma_f32 v[58:59], v[138:139], v[232:233], v[58:59] op_sel_hi:[1,0,1]
  v_pk_fma_f32 v[60:61], v[140:141], v[232:233], v[60:61] op_sel_hi:[1,0,1]
  v_pk_fma_f32 v[62:63], v[142:143], v[232:233], v[62:63] op_sel_hi:[1,0,1]
  s_waitcnt lgkmcnt(0)
  v_pk_fma_f32 v[48:49], v[144:145], v[232:233], v[48:49] op_sel_hi:[1,0,1]
  v_pk_fma_f32 v[50:51], v[146:147], v[232:233], v[50:51] op_sel_hi:[1,0,1]
  v_pk_fma_f32 v[52:53], v[148:149], v[232:233], v[52:53] op_sel_hi:[1,0,1]
  v_pk_fma_f32 v[54:55], v[150:151], v[232:233], v[54:55] op_sel_hi:[1,0,1]
  v_pk_fma_f32 v[56:57], v[152:153], v[232:233], v[56:57] op_sel_hi:[1,0,1]
  v_pk_fma_f32 v[58:59], v[154:155], v[232:233], v[58:59] op_sel_hi:[1,0,1]
  v_pk_fma_f32 v[60:61], v[156:157], v[232:233], v[60:61] op_sel_hi:[1,0,1]
  v_pk_fma_f32 v[62:63], v[158:159], v[232:233], v[62:63] op_sel_hi:[1,0,1]
  v_cvt_pk_bf16_f32 v64, v48, v49
  v_cvt_pk_bf16_f32 v65, v50, v51
  v_cvt_pk_bf16_f32 v66, v52, v53
  v_cvt_pk_bf16_f32 v67, v54, v55
  v_cvt_pk_bf16_f32 v68, v56, v57
  v_cvt_pk_bf16_f32 v69, v58, v59
  v_cvt_pk_bf16_f32 v70, v60, v61
  v_cvt_pk_bf16_f32 v71, v62, v63
  v_mfma_f32_32x32x16_bf16 v[80:95], v[240:243], v[64:67], 0
  s_nop 0
  v_mfma_f32_32x32x16_bf16 v[80:95], v[244:247], v[68:71], v[80:95]
  s_lshr_b32 s100, s73, 3
  s_lshl2_add_u32 s100, s74, s100
  s_and_b32 s101, s73, 7
  s_mul_i32 s84, s100, 1088
  s_lshr_b32 s100, s101, 1
  s_mul_i32 s100, s100, 272
  s_add_u32 s84, s84, s100
  s_add_u32 s84, s84, 32768
  s_and_b32 s101, s101, 1
  s_lshl3_add_u32 s85, s101, s84
  s_add_u32 s85, s85, 256
  s_lshl_b32 s101, s101, 7
  s_add_u32 s84, s84, s101
  s_lshl_b32 s86, s2, 4
  s_add_u32 s86, s86, 4096
  s_add_u32 m0, s11, 65536
  s_add_u32 s18, s9, 0
  buffer_load_dwordx4 v212, s[40:43], s18 offen lds
  buffer_load_dwordx4 v213, s[40:43], s18 offen offset:1024 lds
  buffer_load_dwordx4 v214, s[40:43], s18 offen offset:2048 lds
  buffer_load_dwordx4 v215, s[40:43], s18 offen offset:3072 lds
  s_add_u32 m0, s11, 69632
  s_add_u32 s18, s9, 32768
  buffer_load_dwordx4 v212, s[40:43], s18 offen lds
  buffer_load_dwordx4 v213, s[40:43], s18 offen offset:1024 lds
  buffer_load_dwordx4 v214, s[40:43], s18 offen offset:2048 lds
  buffer_load_dwordx4 v215, s[40:43], s18 offen offset:3072 lds
  v_max3_f32 v160, v80, v81, v82
  v_min3_f32 v162, v80, v81, v82
  v_max3_f32 v160, v160, v83, v84
  v_min3_f32 v162, v162, v83, v84
  v_max3_f32 v160, v160, v85, v86
  v_min3_f32 v162, v162, v85, v86
  v_max3_f32 v160, v160, v87, v88
  v_min3_f32 v162, v162, v87, v88
  v_max3_f32 v160, v160, v89, v90
  v_min3_f32 v162, v162, v89, v90
  v_max3_f32 v160, v160, v91, v92
  v_min3_f32 v162, v162, v91, v92
  v_max3_f32 v160, v160, v93, v94
  v_min3_f32 v162, v162, v93, v94
  v_max_f32 v160, v160, v95
  v_min_f32 v162, v162, v95
  v_mul_f32 v160, v234, v160
  v_mul_f32_e64 v162, v234, v162
  v_pk_fma_f32 v[128:129], v[80:81], v[234:235], v[160:161] op_sel_hi:[1,0,0] neg_lo:[0,0,1] neg_hi:[0,0,1]
  v_pk_fma_f32 v[144:145], v[80:81], v[234:235], v[162:163] op_sel_hi:[1,0,0] neg_lo:[1,0,0] neg_hi:[1,0,0]
  v_pk_fma_f32 v[130:131], v[82:83], v[234:235], v[160:161] op_sel_hi:[1,0,0] neg_lo:[0,0,1] neg_hi:[0,0,1]
  v_pk_fma_f32 v[146:147], v[82:83], v[234:235], v[162:163] op_sel_hi:[1,0,0] neg_lo:[1,0,0] neg_hi:[1,0,0]
  v_pk_fma_f32 v[132:133], v[84:85], v[234:235], v[160:161] op_sel_hi:[1,0,0] neg_lo:[0,0,1] neg_hi:[0,0,1]
  v_pk_fma_f32 v[148:149], v[84:85], v[234:235], v[162:163] op_sel_hi:[1,0,0] neg_lo:[1,0,0] neg_hi:[1,0,0]
  v_pk_fma_f32 v[134:135], v[86:87], v[234:235], v[160:161] op_sel_hi:[1,0,0] neg_lo:[0,0,1] neg_hi:[0,0,1]
  v_pk_fma_f32 v[150:151], v[86:87], v[234:235], v[162:163] op_sel_hi:[1,0,0] neg_lo:[1,0,0] neg_hi:[1,0,0]
  v_pk_fma_f32 v[136:137], v[88:89], v[234:235], v[160:161] op_sel_hi:[1,0,0] neg_lo:[0,0,1] neg_hi:[0,0,1]
  v_pk_fma_f32 v[152:153], v[88:89], v[234:235], v[162:163] op_sel_hi:[1,0,0] neg_lo:[1,0,0] neg_hi:[1,0,0]
  v_pk_fma_f32 v[138:139], v[90:91], v[234:235], v[160:161] op_sel_hi:[1,0,0] neg_lo:[0,0,1] neg_hi:[0,0,1]
  v_pk_fma_f32 v[154:155], v[90:91], v[234:235], v[162:163] op_sel_hi:[1,0,0] neg_lo:[1,0,0] neg_hi:[1,0,0]
  v_pk_fma_f32 v[140:141], v[92:93], v[234:235], v[160:161] op_sel_hi:[1,0,0] neg_lo:[0,0,1] neg_hi:[0,0,1]
  v_pk_fma_f32 v[156:157], v[92:93], v[234:235], v[162:163] op_sel_hi:[1,0,0] neg_lo:[1,0,0] neg_hi:[1,0,0]
  v_pk_fma_f32 v[142:143], v[94:95], v[234:235], v[160:161] op_sel_hi:[1,0,0] neg_lo:[0,0,1] neg_hi:[0,0,1]
  v_pk_fma_f32 v[158:159], v[94:95], v[234:235], v[162:163] op_sel_hi:[1,0,0] neg_lo:[1,0,0] neg_hi:[1,0,0]
  v_exp_f32 v128, v128
  v_exp_f32 v144, v144
  v_exp_f32 v129, v129
  v_exp_f32 v145, v145
  v_exp_f32 v130, v130
  v_exp_f32 v146, v146
  v_exp_f32 v131, v131
  v_exp_f32 v147, v147
  v_exp_f32 v132, v132
  v_exp_f32 v148, v148
  buffer_load_dwordx4 v[192:195], v226, s[64:67], s17 offen offset:0 sc1
  buffer_load_dwordx4 v[196:199], v226, s[64:67], s17 offen offset:1024 sc1
  buffer_load_dwordx4 v[200:203], v227, s[64:67], s17 offen sc1
  v_exp_f32 v133, v133
  v_exp_f32 v149, v149
  v_exp_f32 v134, v134
  v_exp_f32 v150, v150
  v_exp_f32 v135, v135
  v_exp_f32 v151, v151
  v_exp_f32 v136, v136
  v_exp_f32 v152, v152
  v_exp_f32 v137, v137
  v_exp_f32 v153, v153
  v_exp_f32 v138, v138
  v_exp_f32 v154, v154
  v_exp_f32 v139, v139
  v_exp_f32 v155, v155
  v_exp_f32 v140, v140
  v_exp_f32 v156, v156
  v_exp_f32 v141, v141
  v_exp_f32 v157, v157
  v_exp_f32 v142, v142
  v_exp_f32 v158, v158
  v_exp_f32 v143, v143
  v_exp_f32 v159, v159
  v_pk_add_f32 v[80:81], v[128:129], v[130:131]
  v_pk_add_f32 v[88:89], v[144:145], v[146:147]
  v_pk_add_f32 v[82:83], v[132:133], v[134:135]
  v_pk_add_f32 v[90:91], v[148:149], v[150:151]
  v_pk_add_f32 v[84:85], v[136:137], v[138:139]
  v_pk_add_f32 v[92:93], v[152:153], v[154:155]
  v_pk_add_f32 v[86:87], v[140:141], v[142:143]
  v_pk_add_f32 v[94:95], v[156:157], v[158:159]
  v_pk_add_f32 v[80:81], v[80:81], v[82:83]
  v_pk_add_f32 v[88:89], v[88:89], v[90:91]
  v_pk_add_f32 v[84:85], v[84:85], v[86:87]
  v_pk_add_f32 v[92:93], v[92:93], v[94:95]
  v_pk_add_f32 v[80:81], v[80:81], v[84:85]
  v_pk_add_f32 v[88:89], v[88:89], v[92:93]
  v_add_f32 v80, v80, v81
  v_add_f32 v88, v88, v89
  v_rcp_f32 v80, v80
  v_rcp_f32 v88, v88
  v_pk_mul_f32 v[128:129], v[128:129], v[80:81] op_sel_hi:[1,0]
  v_pk_mul_f32 v[144:145], v[144:145], v[88:89] op_sel_hi:[1,0]
  v_pk_mul_f32 v[130:131], v[130:131], v[80:81] op_sel_hi:[1,0]
  v_pk_mul_f32 v[146:147], v[146:147], v[88:89] op_sel_hi:[1,0]
  v_pk_mul_f32 v[132:133], v[132:133], v[80:81] op_sel_hi:[1,0]
  v_pk_mul_f32 v[148:149], v[148:149], v[88:89] op_sel_hi:[1,0]
  v_pk_mul_f32 v[134:135], v[134:135], v[80:81] op_sel_hi:[1,0]
  v_pk_mul_f32 v[150:151], v[150:151], v[88:89] op_sel_hi:[1,0]
  v_pk_mul_f32 v[136:137], v[136:137], v[80:81] op_sel_hi:[1,0]
  v_pk_mul_f32 v[152:153], v[152:153], v[88:89] op_sel_hi:[1,0]
  v_pk_mul_f32 v[138:139], v[138:139], v[80:81] op_sel_hi:[1,0]
  v_pk_mul_f32 v[154:155], v[154:155], v[88:89] op_sel_hi:[1,0]
  v_pk_mul_f32 v[140:141], v[140:141], v[80:81] op_sel_hi:[1,0]
  v_pk_mul_f32 v[156:157], v[156:157], v[88:89] op_sel_hi:[1,0]
  v_pk_mul_f32 v[142:143], v[142:143], v[80:81] op_sel_hi:[1,0]
  v_pk_mul_f32 v[158:159], v[158:159], v[88:89] op_sel_hi:[1,0]
  v_cvt_pk_bf16_f32 v112, v128, v129
  v_cvt_pk_bf16_f32 v120, v144, v145
  v_cvt_pk_bf16_f32 v113, v130, v131
  v_cvt_pk_bf16_f32 v121, v146, v147
  v_cvt_pk_bf16_f32 v114, v132, v133
  v_cvt_pk_bf16_f32 v122, v148, v149
  v_cvt_pk_bf16_f32 v115, v134, v135
  v_cvt_pk_bf16_f32 v123, v150, v151
  v_cvt_pk_bf16_f32 v116, v136, v137
  v_cvt_pk_bf16_f32 v124, v152, v153
  v_cvt_pk_bf16_f32 v117, v138, v139
  v_cvt_pk_bf16_f32 v125, v154, v155
  v_cvt_pk_bf16_f32 v118, v140, v141
  v_cvt_pk_bf16_f32 v126, v156, v157
  v_cvt_pk_bf16_f32 v119, v142, v143
  v_cvt_pk_bf16_f32 v127, v158, v159
  v_permlane32_swap_b32 v112, v116
  v_permlane32_swap_b32 v113, v117
  v_permlane32_swap_b32 v114, v118
  v_permlane32_swap_b32 v115, v119
  v_and_b32 v112, -2, v112
  v_and_b32 v116, -2, v116
  buffer_store_dwordx4 v[112:115], v2, s[64:67], s3 offen offset:0 sc1
  buffer_store_dwordx4 v[116:119], v2, s[64:67], s3 offen offset:1024 sc1
  v_permlane32_swap_b32 v120, v124
  v_permlane32_swap_b32 v121, v125
  v_permlane32_swap_b32 v122, v126
  v_permlane32_swap_b32 v123, v127
  v_and_b32 v120, -2, v120
  v_and_b32 v124, -2, v124
  buffer_store_dwordx4 v[120:123], v2, s[64:67], s3 offen offset:2048 sc1
  buffer_store_dwordx4 v[124:127], v2, s[64:67], s3 offen offset:3072 sc1
  v_bfe_u32 v67, v1, 4, 1
  v_lshl_add_u32 v67, v67, 1, v15
  v_lshlrev_b32 v67, 1, v67
  v_and_b32 v68, 15, v1
  v_cmp_eq_u32 vcc, 0, v68
  v_lshl_add_u32 v68, v68, 3, v67
  v_mov_b32 v69, 0x7f000000
  v_cndmask_b32 v67, v69, v67, vcc
  v_cmp_eq_u32 vcc, 0, v0
  s_nop 1
  v_cndmask_b32 v31, v69, v1, vcc
  v_mov_b32 v30, s69
  s_lshl_b32 s100, s68, 9
  s_add_u32 s100, s100, 151552
  v_lshl_add_u32 v66, v1, 3, s100
  s_waitcnt vmcnt(4)
L_red_11:
  v_xor_b32 v64, v221, v192
  v_xor_b32 v65, v221, v193
  v_bitop3_b32 v64, v194, v221, v64 bitop3:0xbe
  v_bitop3_b32 v65, v195, v221, v65 bitop3:0xbe
  v_bitop3_b32 v64, v196, v221, v64 bitop3:0xbe
  v_bitop3_b32 v65, v197, v221, v65 bitop3:0xbe
  v_bitop3_b32 v64, v198, v221, v64 bitop3:0xbe
  v_bitop3_b32 v65, v199, v221, v65 bitop3:0xbe
  v_bitop3_b32 v64, v200, v221, v64 bitop3:0xbe
  v_bitop3_b32 v65, v201, v221, v65 bitop3:0xbe
  v_bitop3_b32 v64, v202, v221, v64 bitop3:0xbe
  v_bitop3_b32 v65, v203, v221, v65 bitop3:0xbe
  v_bitop3_b32 v64, v64, v65, v220 bitop3:0xa8
  v_cmp_ne_u32 vcc, 0, v64
  s_nop 1
  s_cbranch_vccnz L_redretry_12
L_redok_13:
  v_and_b32 v192, 0xfffff000, v192
  v_and_b32 v193, 0xfffff000, v193
  v_and_b32 v194, 0xfffff000, v194
  v_and_b32 v195, 0xfffff000, v195
  v_and_b32 v196, 0xfffff000, v196
  v_and_b32 v197, 0xfffff000, v197
  v_and_b32 v198, 0xfffff000, v198
  v_and_b32 v199, 0xfffff000, v199
  v_and_b32 v200, 0xfffff000, v200
  v_and_b32 v201, 0xfffff000, v201
  v_and_b32 v202, 0xfffff000, v202
  v_and_b32 v203, 0xfffff000, v203
  v_pk_add_f32 v[192:193], v[192:193], v[196:197]
  v_pk_add_f32 v[194:195], v[194:195], v[198:199]
  v_cndmask_b32 v200, v200, v202, s[24:25]
  v_cndmask_b32 v201, v201, v203, s[24:25]
  v_cmp_gt_u32 vcc, 32, v1
  v_permlane32_swap_b32 v192, v193
  v_permlane32_swap_b32 v194, v195
  v_cndmask_b32 v200, v201, v200, vcc
  v_add_f32 v192, v192, v193
  v_add_f32 v194, v194, v195
  s_nop 1
  v_permlane16_swap_b32 v192, v194
  v_add_f32_dpp v200, v200, v200 row_ror:4 row_mask:0xf bank_mask:0xf
  v_add_f32 v192, v192, v194
  s_nop 0
  v_add_f32_dpp v200, v200, v200 row_ror:2 row_mask:0xf bank_mask:0xf
  s_nop 1
  v_add_f32_dpp v193, v200, v200 row_ror:1 row_mask:0xf bank_mask:0xf
  ds_write_b64 v66, v[192:193]
  s_waitcnt lgkmcnt(0)
  s_barrier
  s_cmp_lg_u32 s68, 0
  s_cbranch_scc1 L_nofinal_14
  ds_read_b64 v[194:195], v66 offset:512
  ds_read_b64 v[196:197], v66 offset:1024
  ds_read_b64 v[198:199], v66 offset:1536
  s_waitcnt lgkmcnt(0)
  v_pk_add_f32 v[192:193], v[192:193], v[194:195]
  v_pk_add_f32 v[196:197], v[196:197], v[198:199]
  v_pk_add_f32 v[192:193], v[192:193], v[196:197]
  v_cvt_pk_bf16_f32 v192, v192, v192
  v_cvt_pk_bf16_f32 v193, v193, v193
  buffer_store_short v192, v68, s[64:67], s84 offen sc1
  buffer_store_short v193, v67, s[64:67], s85 offen sc1
L_nofinal_14:
  s_add_u32 m0, s11, 73728
  s_add_u32 s18, s9, 65536
  buffer_load_dwordx4 v212, s[40:43], s18 offen lds
  s_cmp_ge_u32 s72, 28
  s_cselect_b32 s83, 1, 0
  s_cselect_b32 s38, 0, s46
  s_mov_b32 s92, 0
  s_mov_b32 s93, 65536
  buffer_load_dwordx4 v213, s[40:43], s18 offen offset:1024 lds
  s_mov_b32 s94, 131072
  s_mov_b32 s95, 196608
  s_mov_b32 s96, 262144
  s_mov_b32 s97, 327680
  s_mov_b32 s98, 393216
  buffer_load_dwordx4 v214, s[40:43], s18 offen offset:2048 lds
  s_mov_b32 s99, 458752
  s_mov_b32 s73, 0
  s_mov_b32 s74, 4096
  s_mov_b32 s75, 8192
  s_mov_b32 s80, 12288
  buffer_load_dwordx4 v215, s[40:43], s18 offen offset:3072 lds
  s_mov_b32 s82, 16384
  s_mov_b32 s70, 20480
  s_mov_b32 s26, 24576
  s_mov_b32 s36, s44
  s_mov_b32 s37, s45
  s_add_u32 m0, s11, 77824
  s_add_u32 s18, s9, 98304
  buffer_load_dwordx4 v212, s[40:43], s18 offen lds
  s_and_b32 s22, s72, 3
  s_lshl_b32 s22, s22, 16
  s_and_b32 s100, s16, 0xfffffc00
  s_add_u32 s22, s22, s100
  v_and_b32 v14, 31, v1
  buffer_load_dwordx4 v213, s[40:43], s18 offen offset:1024 lds
  s_lshl_b32 s100, s20, 6
  v_mul_u32_u24 v4, 512, v15
  v_bfe_u32 v72, v1, 2, 2
  v_lshl_add_u32 v4, v72, 7, v4
  v_bfe_u32 v72, v1, 3, 1
  buffer_load_dwordx4 v214, s[40:43], s18 offen offset:2048 lds
  v_lshlrev_b32 v72, 6, v72
  v_bfe_u32 v73, v1, 4, 1
  v_lshl_or_b32 v72, v73, 5, v72
  v_and_b32 v73, 3, v1
  v_lshl_or_b32 v72, v73, 3, v72
  buffer_load_dwordx4 v215, s[40:43], s18 offen offset:3072 lds
  v_xor_b32 v72, s100, v72
  v_add_u32 v4, v4, v72
  v_add_u32 v4, s11, v4
  v_xor_b32 v5, 64, v4
  v_add_u32 v6, 0x10000, v4
  s_add_u32 m0, s11, 0
  s_add_u32 s18, s8, 0
  buffer_load_dwordx4 v212, s[40:43], s18 offen lds
  v_add_u32 v7, 0x10000, v5
  s_lshl_b32 s100, s19, 6
  v_mul_u32_u24 v8, 1024, v15
  v_bfe_u32 v72, v1, 2, 2
  v_lshl_add_u32 v8, v72, 7, v8
  buffer_load_dwordx4 v213, s[40:43], s18 offen offset:1024 lds
  v_bfe_u32 v72, v1, 3, 1
  v_lshlrev_b32 v72, 6, v72
  v_bfe_u32 v73, v1, 4, 1
  v_lshl_or_b32 v72, v73, 5, v72
  v_and_b32 v73, 3, v1
  buffer_load_dwordx4 v214, s[40:43], s18 offen offset:2048 lds
  v_lshl_or_b32 v72, v73, 3, v72
  v_xor_b32 v72, s100, v72
  v_add_u32 v8, v8, v72
  v_add_u32 v8, s11, v8
  v_xor_b32 v9, 64, v8
  buffer_load_dwordx4 v215, s[40:43], s18 offen offset:3072 lds
  v_add_u32 v10, 0x10000, v8
  v_add_u32 v11, 0x10000, v9
  v_add_u32 v12, s11, v2
  s_lshl_b32 s100, s68, 13
  s_add_u32 s100, s100, 131072
  s_add_u32 m0, s11, 4096
  s_add_u32 s18, s8, 32768
  buffer_load_dwordx4 v212, s[40:43], s18 offen lds
  v_bfe_u32 v72, v1, 1, 3
  v_xor_b32 v72, v72, v15
  v_lshlrev_b32 v252, 6, v14
  v_lshl_add_u32 v252, v72, 3, v252
  v_add_u32 v252, s100, v252
  buffer_load_dwordx4 v213, s[40:43], s18 offen offset:1024 lds
  v_bfe_u32 v253, v1, 2, 2
  v_lshl_add_u32 v253, v15, 3, v253
  v_lshrrev_b32 v72, 1, v253
  v_bfe_u32 v73, v1, 4, 1
  v_and_b32 v74, 3, v1
  buffer_load_dwordx4 v214, s[40:43], s18 offen offset:2048 lds
  v_lshl_add_u32 v73, v73, 2, v74
  v_xor_b32 v72, v72, v73
  v_lshlrev_b32 v253, 6, v253
  v_lshl_add_u32 v253, v72, 3, v253
  v_add_u32 v253, s100, v253
  buffer_load_dwordx4 v215, s[40:43], s18 offen offset:3072 lds
  v_xor_b32 v254, 16, v253
  v_add_u32 v254, 256, v254
  v_mov_b32 v255, 0x7f000000
  v_cmp_gt_u32 vcc, 32, v0
  s_nop 1
  v_cndmask_b32 v255, v255, v2, vcc
  s_waitcnt vmcnt(16)
  s_barrier
  buffer_store_dword v30, v31, s[64:67], s86 offen sc1
  s_add_u32 m0, s11, 8192
  s_add_u32 s18, s8, 65536
  buffer_load_dwordx4 v212, s[40:43], s18 offen lds
  v_lshlrev_b32 v13, 4, v14
  v_lshl_add_u32 v13, v15, 10, v13
  v_lshlrev_b32 v14, 2, v1
  v_add_u32 v14, 151552, v14
  s_lshl_b32 s90, s76, 11
  buffer_load_dwordx4 v213, s[40:43], s18 offen offset:1024 lds
  s_add_u32 s90, s90, 131072
  s_lshl2_add_u32 s100, s77, s68
  s_lshl4_add_u32 s91, s76, s100
  s_lshl_b32 s91, s91, 11
  s_add_u32 s91, s91, 8388608
  buffer_load_dwordx4 v214, s[40:43], s18 offen offset:2048 lds
  v_and_b32 v72, 31, v1
  v_min_u32 v72, 16, v72
  v_mul_u32_u24 v28, 272, v15
  v_lshl_add_u32 v28, v72, 4, v28
  v_add_u32 v28, s11, v28
  buffer_load_dwordx4 v215, s[40:43], s18 offen offset:3072 lds
  s_add_u32 m0, s11, 12288
  s_add_u32 s18, s8, 98304
  buffer_load_dwordx4 v212, s[40:43], s18 offen lds
  buffer_load_dwordx4 v213, s[40:43], s18 offen offset:1024 lds
  buffer_load_dwordx4 v214, s[40:43], s18 offen offset:2048 lds
  buffer_load_dwordx4 v215, s[40:43], s18 offen offset:3072 lds
  v_and_b32 v70, 31, v1
  v_lshlrev_b32 v70, 10, v70
  v_lshl_add_u32 v70, v15, 4, v70
  s_lshl_b32 s3, s76, 15
  s_lshl2_add_u32 s100, s77, s68
  s_lshl_b32 s100, s100, 6
  s_add_u32 s3, s3, s100
  buffer_load_dwordx4 v[16:19], v70, s[28:31], s3 offen offset:0
  buffer_load_dwordx4 v[20:23], v70, s[28:31], s3 offen offset:32
  s_mul_i32 s84, s68, 8704
  s_add_u32 s84, s84, 32768
  s_lshl1_add_u32 s86, s76, s20
  s_lshl_b32 s86, s86, 14
  s_lshl_b32 s100, s19, 21
  s_add_u32 s86, s86, s100
  s_add_u32 s86, s86, 4194304
  s_lshl_b32 s87, s68, 10
  s_add_u32 s87, s87, 4096
  ds_read_b64_tr_b16 a[64:65], v6 offset:0
  ds_read_b64_tr_b16 a[66:67], v6 offset:1024
  ds_read_b64_tr_b16 a[68:69], v7 offset:0
  ds_read_b64_tr_b16 a[70:71], v7 offset:1024
  ds_read_b64_tr_b16 a[72:73], v6 offset:2048
  ds_read_b64_tr_b16 a[74:75], v6 offset:3072
  ds_read_b64_tr_b16 a[76:77], v7 offset:2048
  ds_read_b64_tr_b16 a[78:79], v7 offset:3072
  ds_read_b64_tr_b16 a[80:81], v6 offset:4096
  ds_read_b64_tr_b16 a[82:83], v6 offset:5120
  ds_read_b64_tr_b16 a[84:85], v7 offset:4096
  ds_read_b64_tr_b16 a[86:87], v7 offset:5120
  ds_read_b64_tr_b16 a[88:89], v6 offset:6144
  ds_read_b64_tr_b16 a[90:91], v6 offset:7168
  ds_read_b64_tr_b16 a[92:93], v7 offset:6144
  ds_read_b64_tr_b16 a[94:95], v7 offset:7168
  s_waitcnt lgkmcnt(8)
  s_add_u32 m0, s11, 65536
  s_add_u32 s18, s15, 0
  buffer_load_dwordx4 v248, s[36:39], s18 offen lds
  buffer_load_dwordx4 v249, s[36:39], s18 offen offset:1024 lds
  buffer_load_dwordx4 v250, s[36:39], s18 offen offset:2048 lds
  buffer_load_dwordx4 v251, s[36:39], s18 offen offset:3072 lds
  s_waitcnt vmcnt(27)
  ds_read_b64_tr_b16 a[96:97], v6 offset:8192
  ds_read_b64_tr_b16 a[98:99], v6 offset:9216
  ds_read_b64_tr_b16 a[100:101], v7 offset:8192
  ds_read_b64_tr_b16 a[102:103], v7 offset:9216
  ds_read_b64_tr_b16 a[104:105], v6 offset:10240
  ds_read_b64_tr_b16 a[106:107], v6 offset:11264
  ds_read_b64_tr_b16 a[108:109], v7 offset:10240
  ds_read_b64_tr_b16 a[110:111], v7 offset:11264
  s_waitcnt lgkmcnt(8)
  s_add_u32 m0, s11, 69632
  s_add_u32 s18, s15, 114688
  buffer_load_dwordx4 v248, s[36:39], s18 offen lds
  buffer_load_dwordx4 v249, s[36:39], s18 offen offset:1024 lds
  buffer_load_dwordx4 v250, s[36:39], s18 offen offset:2048 lds
  buffer_load_dwordx4 v251, s[36:39], s18 offen offset:3072 lds
  s_waitcnt vmcnt(27)
  ds_read_b64_tr_b16 a[112:113], v6 offset:12288
  ds_read_b64_tr_b16 a[114:115], v6 offset:13312
  ds_read_b64_tr_b16 a[116:117], v7 offset:12288
  ds_read_b64_tr_b16 a[118:119], v7 offset:13312
  ds_read_b64_tr_b16 a[120:121], v6 offset:14336
  ds_read_b64_tr_b16 a[122:123], v6 offset:15360
  ds_read_b64_tr_b16 a[124:125], v7 offset:14336
  ds_read_b64_tr_b16 a[126:127], v7 offset:15360
  s_waitcnt lgkmcnt(8)
  s_add_u32 m0, s11, 73728
  s_add_u32 s18, s15, 229376
  buffer_load_dwordx4 v248, s[36:39], s18 offen lds
  buffer_load_dwordx4 v249, s[36:39], s18 offen offset:1024 lds
  buffer_load_dwordx4 v250, s[36:39], s18 offen offset:2048 lds
  buffer_load_dwordx4 v251, s[36:39], s18 offen offset:3072 lds
  s_waitcnt lgkmcnt(0)
  s_add_u32 m0, s11, 77824
  s_add_u32 s18, s15, 344064
  buffer_load_dwordx4 v248, s[36:39], s18 offen lds
  buffer_load_dwordx4 v249, s[36:39], s18 offen offset:1024 lds
  buffer_load_dwordx4 v250, s[36:39], s18 offen offset:2048 lds
  buffer_load_dwordx4 v251, s[36:39], s18 offen offset:3072 lds
  s_waitcnt vmcnt(18)
  ds_read_b64_tr_b16 a[0:1], v4 offset:0
  ds_read_b64_tr_b16 a[2:3], v4 offset:1024
  ds_read_b64_tr_b16 a[4:5], v5 offset:0
  ds_read_b64_tr_b16 a[6:7], v5 offset:1024
  ds_read_b64_tr_b16 a[8:9], v4 offset:2048
  ds_read_b64_tr_b16 a[10:11], v4 offset:3072
  ds_read_b64_tr_b16 a[12:13], v5 offset:2048
  ds_read_b64_tr_b16 a[14:15], v5 offset:3072
  ds_read_b64_tr_b16 a[16:17], v4 offset:4096
  ds_read_b64_tr_b16 a[18:19], v4 offset:5120
  ds_read_b64_tr_b16 a[20:21], v5 offset:4096
  ds_read_b64_tr_b16 a[22:23], v5 offset:5120
  ds_read_b64_tr_b16 a[24:25], v4 offset:6144
  ds_read_b64_tr_b16 a[26:27], v4 offset:7168
  ds_read_b64_tr_b16 a[28:29], v5 offset:6144
  ds_read_b64_tr_b16 a[30:31], v5 offset:7168
  ds_read_b64_tr_b16 a[32:33], v4 offset:8192
  ds_read_b64_tr_b16 a[34:35], v4 offset:9216
  ds_read_b64_tr_b16 a[36:37], v5 offset:8192
  ds_read_b64_tr_b16 a[38:39], v5 offset:9216
  ds_read_b64_tr_b16 a[40:41], v4 offset:10240
  ds_read_b64_tr_b16 a[42:43], v4 offset:11264
  ds_read_b64_tr_b16 a[44:45], v5 offset:10240
  ds_read_b64_tr_b16 a[46:47], v5 offset:11264
  ds_read_b64_tr_b16 a[48:49], v4 offset:12288
  ds_read_b64_tr_b16 a[50:51], v4 offset:13312
  ds_read_b64_tr_b16 a[52:53], v5 offset:12288
  ds_read_b64_tr_b16 a[54:55], v5 offset:13312
  ds_read_b64_tr_b16 a[56:57], v4 offset:14336
  ds_read_b64_tr_b16 a[58:59], v4 offset:15360
  ds_read_b64_tr_b16 a[60:61], v5 offset:14336
  ds_read_b64_tr_b16 a[62:63], v5 offset:15360
  v_and_b32 v7, 7, v1
  v_lshrrev_b32 v6, 3, v1
  v_lshlrev_b32 v7, 12, v7
  v_lshl_add_u32 v7, v6, 7, v7
  buffer_load_dword v71, v2, s[64:67], s87 offen sc1
  s_waitcnt vmcnt(0) lgkmcnt(0)
L_pollf1_15:
  v_cmp_ne_u32 vcc, s69, v71
  s_nop 1
  s_cbranch_vccnz L_retryf1_16
L_donef1_17:
  s_barrier
  s_add_u32 m0, s11, 0
  s_add_u32 s18, s84, 0
  buffer_load_dwordx4 v2, s[64:67], s18 offen offset:0 sc1 lds
  buffer_load_dwordx4 v2, s[64:67], s18 offen offset:1024 sc1 lds
  buffer_load_dwordx4 v2, s[64:67], s18 offen offset:2048 sc1 lds
  s_add_u32 s18, s86, 0
  buffer_load_dwordx4 v[64:67], v2, s[64:67], s18 offen sc1
  buffer_load_dwordx4 v[72:75], v2, s[64:67], s18 offen offset:2048 sc1
  buffer_load_dwordx4 v[68:71], v2, s[64:67], s18 offen offset:1024 sc1
  buffer_load_dwordx4 v[76:79], v2, s[64:67], s18 offen offset:3072 sc1
  s_add_u32 m0, s11, 3072
  s_add_u32 s18, s84, 3072
  buffer_load_dwordx4 v2, s[64:67], s18 offen offset:0 sc1 lds
  buffer_load_dwordx4 v2, s[64:67], s18 offen offset:1024 sc1 lds
  s_add_u32 s18, s86, 4096
  buffer_load_dwordx4 v[80:83], v2, s[64:67], s18 offen sc1
  buffer_load_dwordx4 v[88:91], v2, s[64:67], s18 offen offset:2048 sc1
  buffer_load_dwordx4 v[84:87], v2, s[64:67], s18 offen offset:1024 sc1
  buffer_load_dwordx4 v[92:95], v2, s[64:67], s18 offen offset:3072 sc1
  s_cmp_lg_u32 s2, 0
  s_cbranch_scc1 L_noep_18
  buffer_store_dword v30, v31, s[64:67], 0 offen sc1
L_noep_18:
  v_permlane32_swap_b32 v16, v18
  v_permlane32_swap_b32 v17, v19
  v_permlane32_swap_b32 v20, v22
  v_permlane32_swap_b32 v21, v23
  v_lshlrev_b32 v128, 16, v16
  v_and_b32 v129, 0xffff0000, v16
  v_lshlrev_b32 v130, 16, v17
  v_and_b32 v131, 0xffff0000, v17
  v_lshlrev_b32 v132, 16, v18
  v_and_b32 v133, 0xffff0000, v18
  v_lshlrev_b32 v134, 16, v19
  v_and_b32 v135, 0xffff0000, v19
  v_lshlrev_b32 v136, 16, v20
  v_and_b32 v137, 0xffff0000, v20
  v_lshlrev_b32 v138, 16, v21
  v_and_b32 v139, 0xffff0000, v21
  v_lshlrev_b32 v140, 16, v22
  v_and_b32 v141, 0xffff0000, v22
  v_lshlrev_b32 v142, 16, v23
  v_and_b32 v143, 0xffff0000, v23
  v_bfe_u32 v4, v1, 3, 2
  s_lshl_b32 s100, s72, 2
  v_add_u32 v4, s100, v4
  v_and_b32 v6, 7, v1
  v_lshlrev_b32 v6, 7, v6
  v_lshl_add_u32 v4, v4, 12, v6
  s_and_b32 s23, s16, 0xfffffc00
  v_mov_b32 v25, v222
  s_waitcnt vmcnt(6)
  ds_read_b128 v[192:195], v28 offset:0
  ds_read_b128 v[196:199], v28 offset:544
  ds_read_b128 v[200:203], v28 offset:1088
  ds_read_b128 v[204:207], v28 offset:1632
  s_add_u32 m0, s11, 5120
  s_add_u32 s18, s84, 5120
  buffer_load_dwordx4 v2, s[64:67], s18 offen offset:0 sc1 lds
  buffer_load_dwordx4 v2, s[64:67], s18 offen offset:1024 sc1 lds
  s_add_u32 s18, s86, 8192
  buffer_load_dwordx4 v[96:99], v2, s[64:67], s18 offen sc1
  buffer_load_dwordx4 v[104:107], v2, s[64:67], s18 offen offset:2048 sc1
  buffer_load_dwordx4 v[100:103], v2, s[64:67], s18 offen offset:1024 sc1
  buffer_load_dwordx4 v[108:111], v2, s[64:67], s18 offen offset:3072 sc1
  s_add_u32 m0, s11, 7168
  s_add_u32 s18, s84, 7168
  buffer_load_dwordx4 v2, s[64:67], s18 offen offset:0 sc1 lds
  buffer_load_dwordx4 v2, s[64:67], s18 offen offset:1024 sc1 lds
  s_add_u32 s18, s86, 12288
  buffer_load_dwordx4 v[112:115], v2, s[64:67], s18 offen sc1
  buffer_load_dwordx4 v[120:123], v2, s[64:67], s18 offen offset:2048 sc1
  buffer_load_dwordx4 v[116:119], v2, s[64:67], s18 offen offset:1024 sc1
  buffer_load_dwordx4 v[124:127], v2, s[64:67], s18 offen offset:3072 sc1
  s_waitcnt lgkmcnt(2)
  v_mfma_f32_32x32x16_bf16 v[32:47], v[192:195], v[64:67], 0
  v_mfma_f32_32x32x16_bf16 v[32:47], v[196:199], v[72:75], v[32:47]
  s_waitcnt lgkmcnt(0)
  v_mfma_f32_32x32x16_bf16 v[48:63], v[200:203], v[68:71], 0
  v_mfma_f32_32x32x16_bf16 v[48:63], v[204:207], v[76:79], v[48:63]
  s_waitcnt vmcnt(12)
  ds_read_b128 v[208:211], v28 offset:2176
  ds_read_b128 v[212:215], v28 offset:2720
  ds_read_b128 v[216:219], v28 offset:3264
  ds_read_b128 v[220:223], v28 offset:3808
  v_add_f32 v24, 0x358637bd, v40
  v_rcp_f32 v24, v24
  s_nop 0
  v_mul_f32 v32, v24, v32
  v_mul_f32 v33, v24, v33
  v_mul_f32 v34, v24, v34
  v_mul_f32 v35, v24, v35
  v_mul_f32 v36, v24, v36
  v_mul_f32 v37, v24, v37
  v_mul_f32 v38, v24, v38
  v_mul_f32 v39, v24, v39
  v_cvt_pk_bf16_f32 v240, v32, v33
  v_cvt_pk_bf16_f32 v241, v34, v35
  v_cvt_pk_bf16_f32 v242, v36, v37
  v_cvt_pk_bf16_f32 v243, v38, v39
  s_waitcnt lgkmcnt(2)
  v_mfma_f32_32x32x16_bf16 v[224:239], v[208:211], v[80:83], 0
  v_mfma_f32_32x32x16_bf16 v[224:239], v[212:215], v[88:91], v[224:239]
  ds_read_b64_tr_b16 a[128:129], v10 offset:0
  ds_read_b64_tr_b16 a[130:131], v10 offset:512
  ds_read_b64_tr_b16 a[132:133], v11 offset:0
  ds_read_b64_tr_b16 a[134:135], v11 offset:512
  ds_read_b64_tr_b16 a[136:137], v10 offset:2048
  ds_read_b64_tr_b16 a[138:139], v10 offset:2560
  ds_read_b64_tr_b16 a[140:141], v11 offset:2048
  ds_read_b64_tr_b16 a[142:143], v11 offset:2560
  ds_read_b64_tr_b16 a[144:145], v10 offset:4096
  ds_read_b64_tr_b16 a[146:147], v10 offset:4608
  ds_read_b64_tr_b16 a[148:149], v11 offset:4096
  ds_read_b64_tr_b16 a[150:151], v11 offset:4608
  ds_read_b64_tr_b16 a[152:153], v10 offset:6144
  ds_read_b64_tr_b16 a[154:155], v10 offset:6656
  ds_read_b64_tr_b16 a[156:157], v11 offset:6144
  ds_read_b64_tr_b16 a[158:159], v11 offset:6656
  s_waitcnt vmcnt(6)
  ds_read_b128 v[192:195], v28 offset:4352
  ds_read_b128 v[196:199], v28 offset:4896
  ds_read_b128 v[200:203], v28 offset:5440
  ds_read_b128 v[204:207], v28 offset:5984
  v_mfma_f32_32x32x16_bf16 v[128:143], a[0:3], v[240:243], v[128:143]
  v_add_f32 v24, 0x358637bd, v56
  v_rcp_f32 v24, v24
  ds_read_b64_tr_b16 a[160:161], v10 offset:8192
  ds_read_b64_tr_b16 a[162:163], v10 offset:8704
  ds_read_b64_tr_b16 a[164:165], v11 offset:8192
  ds_read_b64_tr_b16 a[166:167], v11 offset:8704
  ds_read_b64_tr_b16 a[168:169], v10 offset:10240
  ds_read_b64_tr_b16 a[170:171], v10 offset:10752
  ds_read_b64_tr_b16 a[172:173], v11 offset:10240
  ds_read_b64_tr_b16 a[174:175], v11 offset:10752
  v_mfma_f32_32x32x16_bf16 v[144:159], a[4:7], v[240:243], 0
  v_mul_f32 v48, v24, v48
  v_mul_f32 v49, v24, v49
  v_mul_f32 v50, v24, v50
  v_mul_f32 v51, v24, v51
  ds_read_b64_tr_b16 a[176:177], v10 offset:12288
  ds_read_b64_tr_b16 a[178:179], v10 offset:12800
  ds_read_b64_tr_b16 a[180:181], v11 offset:12288
  ds_read_b64_tr_b16 a[182:183], v11 offset:12800
  ds_read_b64_tr_b16 a[184:185], v10 offset:14336
  ds_read_b64_tr_b16 a[186:187], v10 offset:14848
  ds_read_b64_tr_b16 a[188:189], v11 offset:14336
  ds_read_b64_tr_b16 a[190:191], v11 offset:14848
  v_mfma_f32_32x32x16_bf16 v[160:175], a[64:67], v[240:243], 0
  v_mul_f32 v52, v24, v52
  v_mul_f32 v53, v24, v53
  v_mul_f32 v54, v24, v54
  v_mul_f32 v55, v24, v55
  s_waitcnt lgkmcnt(0)
  v_mfma_f32_32x32x16_bf16 v[176:191], a[68:71], v[240:243], 0
  v_cvt_pk_bf16_f32 v244, v48, v49
  v_cvt_pk_bf16_f32 v245, v50, v51
  v_cvt_pk_bf16_f32 v246, v52, v53
  v_cvt_pk_bf16_f32 v247, v54, v55
  s_add_u32 m0, s11, 65536
  s_add_u32 s18, s15, 458752
  buffer_load_dwordx4 v248, s[36:39], s18 offen lds
  v_mfma_f32_32x32x16_bf16 v[32:47], v[216:219], v[84:87], 0
  v_mfma_f32_32x32x16_bf16 v[32:47], v[220:223], v[92:95], v[32:47]
  buffer_load_dwordx4 v249, s[36:39], s18 offen offset:1024 lds
  buffer_load_dwordx4 v250, s[36:39], s18 offen offset:2048 lds
  v_mfma_f32_32x32x16_bf16 v[128:143], a[8:11], v[244:247], v[128:143]
  v_add_f32 v24, 0x358637bd, v232
  v_rcp_f32 v24, v24
  buffer_load_dwordx4 v251, s[36:39], s18 offen offset:3072 lds
  v_mfma_f32_32x32x16_bf16 v[144:159], a[12:15], v[244:247], v[144:159]
  v_mul_f32 v224, v24, v224
  v_mul_f32 v225, v24, v225
  v_mul_f32 v226, v24, v226
  v_mul_f32 v227, v24, v227
  s_add_u32 m0, s11, 69632
  s_add_u32 s18, s15, 573440
  buffer_load_dwordx4 v248, s[36:39], s18 offen lds
  v_mfma_f32_32x32x16_bf16 v[160:175], a[72:75], v[244:247], v[160:175]
  v_mul_f32 v228, v24, v228
  v_mul_f32 v229, v24, v229
  v_mul_f32 v230, v24, v230
  v_mul_f32 v231, v24, v231
  buffer_load_dwordx4 v249, s[36:39], s18 offen offset:1024 lds
  v_mfma_f32_32x32x16_bf16 v[176:191], a[76:79], v[244:247], v[176:191]
  v_cvt_pk_bf16_f32 v240, v224, v225
  v_cvt_pk_bf16_f32 v241, v226, v227
  v_cvt_pk_bf16_f32 v242, v228, v229
  v_cvt_pk_bf16_f32 v243, v230, v231
  buffer_load_dwordx4 v250, s[36:39], s18 offen offset:2048 lds
  v_mfma_f32_32x32x16_bf16 v[48:63], v[192:195], v[96:99], 0
  v_mfma_f32_32x32x16_bf16 v[48:63], v[196:199], v[104:107], v[48:63]
  buffer_load_dwordx4 v251, s[36:39], s18 offen offset:3072 lds
  s_add_u32 m0, s11, 73728
  s_add_u32 s18, s15, 688128
  buffer_load_dwordx4 v248, s[36:39], s18 offen lds
  s_waitcnt vmcnt(9)
  ds_read_b128 v[208:211], v28 offset:6528
  ds_read_b128 v[212:215], v28 offset:7072
  ds_read_b128 v[216:219], v28 offset:7616
  ds_read_b128 v[220:223], v28 offset:8160
  v_mfma_f32_32x32x16_bf16 v[128:143], a[16:19], v[240:243], v[128:143]
  v_add_f32 v24, 0x358637bd, v40
  v_rcp_f32 v24, v24
  buffer_load_dwordx4 v249, s[36:39], s18 offen offset:1024 lds
  v_mfma_f32_32x32x16_bf16 v[144:159], a[20:23], v[240:243], v[144:159]
  v_mul_f32 v32, v24, v32
  v_mul_f32 v33, v24, v33
  v_mul_f32 v34, v24, v34
  v_mul_f32 v35, v24, v35
  buffer_load_dwordx4 v250, s[36:39], s18 offen offset:2048 lds
  v_mfma_f32_32x32x16_bf16 v[160:175], a[80:83], v[240:243], v[160:175]
  v_mul_f32 v36, v24, v36
  v_mul_f32 v37, v24, v37
  v_mul_f32 v38, v24, v38
  v_mul_f32 v39, v24, v39
  buffer_load_dwordx4 v251, s[36:39], s18 offen offset:3072 lds
  v_mfma_f32_32x32x16_bf16 v[176:191], a[84:87], v[240:243], v[176:191]
  v_cvt_pk_bf16_f32 v244, v32, v33
  v_cvt_pk_bf16_f32 v245, v34, v35
  v_cvt_pk_bf16_f32 v246, v36, v37
  v_cvt_pk_bf16_f32 v247, v38, v39
  s_add_u32 m0, s11, 77824
  s_add_u32 s18, s15, 802816
  buffer_load_dwordx4 v248, s[36:39], s18 offen lds
  v_mfma_f32_32x32x16_bf16 v[224:239], v[200:203], v[100:103], 0
  v_mfma_f32_32x32x16_bf16 v[224:239], v[204:207], v[108:111], v[224:239]
  buffer_load_dwordx4 v249, s[36:39], s18 offen offset:1024 lds
  buffer_load_dwordx4 v250, s[36:39], s18 offen offset:2048 lds
  v_mfma_f32_32x32x16_bf16 v[128:143], a[24:27], v[244:247], v[128:143]
  v_add_f32 v24, 0x358637bd, v56
  v_rcp_f32 v24, v24
  buffer_load_dwordx4 v251, s[36:39], s18 offen offset:3072 lds
  v_mfma_f32_32x32x16_bf16 v[144:159], a[28:31], v[244:247], v[144:159]
  v_mul_f32 v48, v24, v48
  v_mul_f32 v49, v24, v49
  v_mul_f32 v50, v24, v50
  v_mul_f32 v51, v24, v51
  s_add_u32 s101, s21, 1376256
  buffer_load_dword v5, v25, s[44:47], s101 offen
  v_mfma_f32_32x32x16_bf16 v[160:175], a[88:91], v[244:247], v[160:175]
  v_mul_f32 v52, v24, v52
  v_mul_f32 v53, v24, v53
  v_mul_f32 v54, v24, v54
  v_mul_f32 v55, v24, v55
  s_and_b32 s101, s16, 0xfffffc00
  s_add_u32 s101, s101, 0
  buffer_load_dword v5, v4, s[52:55], s101 offen
  v_mfma_f32_32x32x16_bf16 v[176:191], a[92:95], v[244:247], v[176:191]
  v_cvt_pk_bf16_f32 v240, v48, v49
  v_cvt_pk_bf16_f32 v241, v50, v51
  v_cvt_pk_bf16_f32 v242, v52, v53
  v_cvt_pk_bf16_f32 v243, v54, v55
  s_waitcnt lgkmcnt(2)
  v_mfma_f32_32x32x16_bf16 v[32:47], v[208:211], v[112:115], 0
  v_mfma_f32_32x32x16_bf16 v[32:47], v[212:215], v[120:123], v[32:47]
  v_mfma_f32_32x32x16_bf16 v[128:143], a[32:35], v[240:243], v[128:143]
  v_add_f32 v24, 0x358637bd, v232
  v_rcp_f32 v24, v24
  v_mfma_f32_32x32x16_bf16 v[144:159], a[36:39], v[240:243], v[144:159]
  v_mul_f32 v224, v24, v224
  v_mul_f32 v225, v24, v225
  v_mul_f32 v226, v24, v226
  v_mul_f32 v227, v24, v227
  v_mfma_f32_32x32x16_bf16 v[160:175], a[96:99], v[240:243], v[160:175]
  v_mul_f32 v228, v24, v228
  v_mul_f32 v229, v24, v229
  v_mul_f32 v230, v24, v230
  v_mul_f32 v231, v24, v231
  v_mfma_f32_32x32x16_bf16 v[176:191], a[100:103], v[240:243], v[176:191]
  v_cvt_pk_bf16_f32 v244, v224, v225
  v_cvt_pk_bf16_f32 v245, v226, v227
  v_cvt_pk_bf16_f32 v246, v228, v229
  v_cvt_pk_bf16_f32 v247, v230, v231
  s_waitcnt lgkmcnt(0)
  v_mfma_f32_32x32x16_bf16 v[48:63], v[216:219], v[116:119], 0
  v_mfma_f32_32x32x16_bf16 v[48:63], v[220:223], v[124:127], v[48:63]
  v_mfma_f32_32x32x16_bf16 v[128:143], a[40:43], v[244:247], v[128:143]
  v_add_f32 v24, 0x358637bd, v40
  v_rcp_f32 v24, v24
  v_mfma_f32_32x32x16_bf16 v[144:159], a[44:47], v[244:247], v[144:159]
  v_mul_f32 v32, v24, v32
  v_mul_f32 v33, v24, v33
  v_mul_f32 v34, v24, v34
  v_mul_f32 v35, v24, v35
  v_mfma_f32_32x32x16_bf16 v[160:175], a[104:107], v[244:247], v[160:175]
  v_mul_f32 v36, v24, v36
  v_mul_f32 v37, v24, v37
  v_mul_f32 v38, v24, v38
  v_mul_f32 v39, v24, v39
  v_mfma_f32_32x32x16_bf16 v[176:191], a[108:111], v[244:247], v[176:191]
  v_cvt_pk_bf16_f32 v240, v32, v33
  v_cvt_pk_bf16_f32 v241, v34, v35
  v_cvt_pk_bf16_f32 v242, v36, v37
  v_cvt_pk_bf16_f32 v243, v38, v39
  v_add_f32 v24, 0x358637bd, v56
  v_rcp_f32 v24, v24
  s_nop 0
  v_mul_f32 v48, v24, v48
  v_mul_f32 v49, v24, v49
  v_mul_f32 v50, v24, v50
  v_mul_f32 v51, v24, v51
  v_mul_f32 v52, v24, v52
  v_mul_f32 v53, v24, v53
  v_mul_f32 v54, v24, v54
  v_mul_f32 v55, v24, v55
  v_cvt_pk_bf16_f32 v244, v48, v49
  v_cvt_pk_bf16_f32 v245, v50, v51
  v_cvt_pk_bf16_f32 v246, v52, v53
  v_cvt_pk_bf16_f32 v247, v54, v55
  v_mfma_f32_32x32x16_bf16 v[144:159], a[52:55], v[240:243], v[144:159]
  s_nop 0
  v_mfma_f32_32x32x16_bf16 v[144:159], a[60:63], v[244:247], v[144:159]
  v_mfma_f32_32x32x16_bf16 v[160:175], a[112:115], v[240:243], v[160:175]
  v_mfma_f32_32x32x16_bf16 v[160:175], a[120:123], v[244:247], v[160:175]
  ds_write_b128 v12, v[144:147] offset:4096
  ds_write_b128 v12, v[148:151] offset:5120
  ds_write_b128 v12, v[152:155] offset:6144
  ds_write_b128 v12, v[156:159] offset:7168
  v_mfma_f32_32x32x16_bf16 v[176:191], a[116:119], v[240:243], v[176:191]
  v_mfma_f32_32x32x16_bf16 v[176:191], a[124:127], v[244:247], v[176:191]
  ds_write_b128 v12, v[160:163] offset:8192
  ds_write_b128 v12, v[164:167] offset:9216
  ds_write_b128 v12, v[168:171] offset:10240
  ds_write_b128 v12, v[172:175] offset:11264
  v_mfma_f32_32x32x16_bf16 v[128:143], a[48:51], v[240:243], v[128:143]
  v_mfma_f32_32x32x16_bf16 v[128:143], a[56:59], v[244:247], v[128:143]
  ds_write_b128 v12, v[176:179] offset:12288
  ds_write_b128 v12, v[180:183] offset:13312
  ds_write_b128 v12, v[184:187] offset:14336
  ds_write_b128 v12, v[188:191] offset:15360
  v_xor_b32 v113, 16384, v12
  v_xor_b32 v114, 32768, v12
  v_xor_b32 v115, 49152, v12
  s_waitcnt lgkmcnt(0)
  s_barrier
  ds_read_b128 v[64:67], v113 offset:4096
  ds_read_b128 v[68:71], v113 offset:5120
  ds_read_b128 v[72:75], v113 offset:6144
  ds_read_b128 v[76:79], v113 offset:7168
  ds_read_b128 v[80:83], v114 offset:8192
  ds_read_b128 v[84:87], v114 offset:9216
  ds_read_b128 v[88:91], v114 offset:10240
  ds_read_b128 v[92:95], v114 offset:11264
  ds_read_b128 v[96:99], v115 offset:12288
  ds_read_b128 v[100:103], v115 offset:13312
  ds_read_b128 v[104:107], v115 offset:14336
  ds_read_b128 v[108:111], v115 offset:15360
  s_waitcnt lgkmcnt(8)
  v_pk_add_f32 v[128:129], v[128:129], v[64:65]
  v_pk_add_f32 v[130:131], v[130:131], v[66:67]
  v_pk_add_f32 v[132:133], v[132:133], v[68:69]
  v_pk_add_f32 v[134:135], v[134:135], v[70:71]
  v_pk_add_f32 v[136:137], v[136:137], v[72:73]
  v_pk_add_f32 v[138:139], v[138:139], v[74:75]
  v_pk_add_f32 v[140:141], v[140:141], v[76:77]
  v_pk_add_f32 v[142:143], v[142:143], v[78:79]
  s_waitcnt lgkmcnt(4)
  v_pk_add_f32 v[128:129], v[128:129], v[80:81]
  v_pk_add_f32 v[130:131], v[130:131], v[82:83]
  v_pk_add_f32 v[132:133], v[132:133], v[84:85]
  v_pk_add_f32 v[134:135], v[134:135], v[86:87]
  v_pk_add_f32 v[136:137], v[136:137], v[88:89]
  v_pk_add_f32 v[138:139], v[138:139], v[90:91]
  v_pk_add_f32 v[140:141], v[140:141], v[92:93]
  v_pk_add_f32 v[142:143], v[142:143], v[94:95]
  s_waitcnt lgkmcnt(0)
  v_pk_add_f32 v[128:129], v[128:129], v[96:97]
  v_pk_add_f32 v[130:131], v[130:131], v[98:99]
  v_pk_add_f32 v[132:133], v[132:133], v[100:101]
  v_pk_add_f32 v[134:135], v[134:135], v[102:103]
  v_pk_add_f32 v[136:137], v[136:137], v[104:105]
  v_pk_add_f32 v[138:139], v[138:139], v[106:107]
  v_pk_add_f32 v[140:141], v[140:141], v[108:109]
  v_pk_add_f32 v[142:143], v[142:143], v[110:111]
  v_pk_add_f32 v[64:65], v[128:129], v[130:131]
  v_pk_mul_f32 v[66:67], v[128:129], v[128:129]
  v_pk_fma_f32 v[66:67], v[130:131], v[130:131], v[66:67]
  v_pk_add_f32 v[64:65], v[64:65], v[132:133]
  v_pk_fma_f32 v[66:67], v[132:133], v[132:133], v[66:67]
  v_pk_add_f32 v[64:65], v[64:65], v[134:135]
  v_pk_fma_f32 v[66:67], v[134:135], v[134:135], v[66:67]
  v_pk_add_f32 v[64:65], v[64:65], v[136:137]
  v_pk_fma_f32 v[66:67], v[136:137], v[136:137], v[66:67]
  v_pk_add_f32 v[64:65], v[64:65], v[138:139]
  v_pk_fma_f32 v[66:67], v[138:139], v[138:139], v[66:67]
  v_pk_add_f32 v[64:65], v[64:65], v[140:141]
  v_pk_fma_f32 v[66:67], v[140:141], v[140:141], v[66:67]
  v_pk_add_f32 v[64:65], v[64:65], v[142:143]
  v_pk_fma_f32 v[66:67], v[142:143], v[142:143], v[66:67]
  v_add_f32 v64, v64, v65
  v_add_f32 v66, v66, v67
  s_lshl_b32 s100, s68, 8
  v_add_u32 v65, s100, v14
  v_permlane32_swap_b32 v64, v66
  v_add_f32_e64 v64, v64, v66
  ds_write_b32 v65, v64
  v_cvt_pk_bf16_f32 v112, v128, v129
  v_cvt_pk_bf16_f32 v113, v130, v131
  v_cvt_pk_bf16_f32 v114, v132, v133
  v_cvt_pk_bf16_f32 v115, v134, v135
  v_cvt_pk_bf16_f32 v116, v136, v137
  v_cvt_pk_bf16_f32 v117, v138, v139
  v_cvt_pk_bf16_f32 v118, v140, v141
  v_cvt_pk_bf16_f32 v119, v142, v143
  s_waitcnt lgkmcnt(0)
  s_barrier
  ds_read_b32 v66, v14 offset:0
  ds_read_b32 v67, v14 offset:256
  ds_read_b32 v68, v14 offset:512
  ds_read_b32 v69, v14 offset:768
  s_lshl_b32 s100, s77, 9
  s_add_u32 s100, s100, s90
  v_mov_b32 v74, v30
  v_mov_b32 v75, v30
  s_waitcnt lgkmcnt(0)
  v_add_f32 v66, v66, v67
  v_add_f32 v68, v68, v69
  v_add_f32 v72, v66, v68
  v_mov_b32 v73, v72
  s_nop 1
  v_permlane32_swap_b32 v72, v73
  buffer_store_dwordx4 v[72:75], v255, s[64:67], s100 offen sc1
  buffer_store_dwordx4 v[112:115], v2, s[64:67], s91 offen offset:0 sc1
  buffer_store_dwordx4 v[116:119], v2, s[64:67], s91 offen offset:1024 sc1
  s_barrier
  s_add_u32 m0, s11, 0
  s_add_u32 s18, s15, 917504
  buffer_load_dwordx4 v248, s[36:39], s18 offen lds
  buffer_load_dwordx4 v249, s[36:39], s18 offen offset:1024 lds
  buffer_load_dwordx4 v250, s[36:39], s18 offen offset:2048 lds
  buffer_load_dwordx4 v251, s[36:39], s18 offen offset:3072 lds
  s_add_u32 m0, s11, 4096
  s_add_u32 s18, s15, 1032192
  buffer_load_dwordx4 v248, s[36:39], s18 offen lds
  buffer_load_dwordx4 v249, s[36:39], s18 offen offset:1024 lds
  buffer_load_dwordx4 v250, s[36:39], s18 offen offset:2048 lds
  buffer_load_dwordx4 v251, s[36:39], s18 offen offset:3072 lds
  s_add_u32 m0, s11, 8192
  s_add_u32 s18, s15, 1146880
  buffer_load_dwordx4 v248, s[36:39], s18 offen lds
  buffer_load_dwordx4 v249, s[36:39], s18 offen offset:1024 lds
  buffer_load_dwordx4 v250, s[36:39], s18 offen offset:2048 lds
  buffer_load_dwordx4 v251, s[36:39], s18 offen offset:3072 lds
  s_add_u32 m0, s11, 12288
  s_add_u32 s18, s15, 1261568
  buffer_load_dwordx4 v248, s[36:39], s18 offen lds
  buffer_load_dwordx4 v249, s[36:39], s18 offen offset:1024 lds
  buffer_load_dwordx4 v250, s[36:39], s18 offen offset:2048 lds
  buffer_load_dwordx4 v251, s[36:39], s18 offen offset:3072 lds
  s_waitcnt vmcnt(21)
  ds_read_b64_tr_b16 a[192:193], v10 offset:0
  ds_read_b64_tr_b16 a[194:195], v10 offset:512
  ds_read_b64_tr_b16 a[196:197], v11 offset:0
  ds_read_b64_tr_b16 a[198:199], v11 offset:512
  ds_read_b64_tr_b16 a[200:201], v10 offset:2048
  ds_read_b64_tr_b16 a[202:203], v10 offset:2560
  ds_read_b64_tr_b16 a[204:205], v11 offset:2048
  ds_read_b64_tr_b16 a[206:207], v11 offset:2560
  ds_read_b64_tr_b16 a[208:209], v10 offset:4096
  ds_read_b64_tr_b16 a[210:211], v10 offset:4608
  ds_read_b64_tr_b16 a[212:213], v11 offset:4096
  ds_read_b64_tr_b16 a[214:215], v11 offset:4608
  ds_read_b64_tr_b16 a[216:217], v10 offset:6144
  ds_read_b64_tr_b16 a[218:219], v10 offset:6656
  ds_read_b64_tr_b16 a[220:221], v11 offset:6144
  ds_read_b64_tr_b16 a[222:223], v11 offset:6656
  ds_read_b64_tr_b16 a[224:225], v10 offset:8192
  ds_read_b64_tr_b16 a[226:227], v10 offset:8704
  ds_read_b64_tr_b16 a[228:229], v11 offset:8192
  ds_read_b64_tr_b16 a[230:231], v11 offset:8704
  ds_read_b64_tr_b16 a[232:233], v10 offset:10240
  ds_read_b64_tr_b16 a[234:235], v10 offset:10752
  ds_read_b64_tr_b16 a[236:237], v11 offset:10240
  ds_read_b64_tr_b16 a[238:239], v11 offset:10752
  ds_read_b64_tr_b16 a[240:241], v10 offset:12288
  ds_read_b64_tr_b16 a[242:243], v10 offset:12800
  ds_read_b64_tr_b16 a[244:245], v11 offset:12288
  ds_read_b64_tr_b16 a[246:247], v11 offset:12800
  ds_read_b64_tr_b16 a[248:249], v10 offset:14336
  ds_read_b64_tr_b16 a[250:251], v10 offset:14848
  ds_read_b64_tr_b16 a[252:253], v11 offset:14336
  ds_read_b64_tr_b16 a[254:255], v11 offset:14848
  s_waitcnt lgkmcnt(0)
  buffer_load_dwordx4 v[76:79], v13, s[64:67], s90 offen sc1
  buffer_load_dwordx4 v[80:83], v13, s[64:67], s90 offen offset:512 sc1
  s_add_u32 m0, s11, 65536
  s_add_u32 s18, s15, 1376256
  buffer_load_dwordx4 v248, s[36:39], s18 offen lds
  buffer_load_dwordx4 v249, s[36:39], s18 offen offset:1024 lds
  buffer_load_dwordx4 v250, s[36:39], s18 offen offset:2048 lds
  buffer_load_dwordx4 v251, s[36:39], s18 offen offset:3072 lds
  s_add_u32 m0, s11, 69632
  s_add_u32 s18, s15, 1490944
  buffer_load_dwordx4 v248, s[36:39], s18 offen lds
  buffer_load_dwordx4 v249, s[36:39], s18 offen offset:1024 lds
  buffer_load_dwordx4 v250, s[36:39], s18 offen offset:2048 lds
  buffer_load_dwordx4 v251, s[36:39], s18 offen offset:3072 lds
  s_waitcnt vmcnt(10)
  ds_read_b64_tr_b16 a[0:1], v8 offset:0
  ds_read_b64_tr_b16 a[2:3], v8 offset:512
  ds_read_b64_tr_b16 a[4:5], v9 offset:0
  ds_read_b64_tr_b16 a[6:7], v9 offset:512
  ds_read_b64_tr_b16 a[8:9], v8 offset:2048
  ds_read_b64_tr_b16 a[10:11], v8 offset:2560
  ds_read_b64_tr_b16 a[12:13], v9 offset:2048
  ds_read_b64_tr_b16 a[14:15], v9 offset:2560
  ds_read_b64_tr_b16 a[16:17], v8 offset:4096
  ds_read_b64_tr_b16 a[18:19], v8 offset:4608
  ds_read_b64_tr_b16 a[20:21], v9 offset:4096
  ds_read_b64_tr_b16 a[22:23], v9 offset:4608
  ds_read_b64_tr_b16 a[24:25], v8 offset:6144
  ds_read_b64_tr_b16 a[26:27], v8 offset:6656
  ds_read_b64_tr_b16 a[28:29], v9 offset:6144
  ds_read_b64_tr_b16 a[30:31], v9 offset:6656
  ds_read_b64_tr_b16 a[32:33], v8 offset:8192
  ds_read_b64_tr_b16 a[34:35], v8 offset:8704
  ds_read_b64_tr_b16 a[36:37], v9 offset:8192
  ds_read_b64_tr_b16 a[38:39], v9 offset:8704
  ds_read_b64_tr_b16 a[40:41], v8 offset:10240
  ds_read_b64_tr_b16 a[42:43], v8 offset:10752
  ds_read_b64_tr_b16 a[44:45], v9 offset:10240
  ds_read_b64_tr_b16 a[46:47], v9 offset:10752
  ds_read_b64_tr_b16 a[48:49], v8 offset:12288
  ds_read_b64_tr_b16 a[50:51], v8 offset:12800
  ds_read_b64_tr_b16 a[52:53], v9 offset:12288
  ds_read_b64_tr_b16 a[54:55], v9 offset:12800
  ds_read_b64_tr_b16 a[56:57], v8 offset:14336
  ds_read_b64_tr_b16 a[58:59], v8 offset:14848
  ds_read_b64_tr_b16 a[60:61], v9 offset:14336
  ds_read_b64_tr_b16 a[62:63], v9 offset:14848
  s_lshl_b32 s100, s78, 12
  s_lshl_b32 s101, s68, 19
  s_add_u32 s100, s100, s101
  s_lshl_b32 s101, s20, 11
  s_add_u32 s100, s100, s101
  s_add_u32 s100, s100, 4194304
  v_add_u32 v26, s100, v2
  v_xor_b32 v27, 0x800, v26
  v_add_u32 v30, 0x8000, v26
  v_add_u32 v31, 0x8000, v27
  v_mov_b32 v34, v4
  v_lshrrev_b32 v28, 3, v1
  v_mul_u32_u24 v36, 4096, v28
  v_bfe_u32 v28, v1, 4, 1
  v_lshlrev_b32 v28, 2, v28
  v_xor_b32 v28, v1, v28
  v_and_b32 v28, 7, v28
  v_lshl_add_u32 v36, v28, 4, v36
  v_add_u32 v37, 31744, v36
  v_add_u32 v38, 63488, v36
  v_add_u32 v39, 95232, v36
  s_lshl1_add_u32 s3, s79, s19
  s_lshl_b32 s3, s3, 6
  v_lshlrev_b32 v14, 3, v15
  buffer_load_dwordx2 v[16:17], v14, s[48:51], s3 offen offset:0
  buffer_load_dwordx2 v[18:19], v14, s[48:51], s3 offen offset:16
  buffer_load_dwordx2 v[20:21], v14, s[48:51], s3 offen offset:32
  buffer_load_dwordx2 v[22:23], v14, s[48:51], s3 offen offset:48
  s_waitcnt vmcnt(12)
L_st_19:
  v_xor_b32 v64, v74, v78
  v_bitop3_b32 v64, v79, v74, v64 bitop3:0xbe
  v_bitop3_b32 v64, v82, v74, v64 bitop3:0xbe
  v_bitop3_b32 v64, v83, v74, v64 bitop3:0xbe
  v_cmp_ne_u32 vcc, 0, v64
  s_nop 1
  s_cbranch_vccnz L_stretry_20
L_stok_21:
  v_pk_add_f32 v[76:77], v[76:77], v[80:81]
  v_mov_b32 v78, v76
  v_mov_b32 v79, v77
  v_mov_b32 v66, 0x3b000000
  v_mov_b32 v67, 0x3727c5ac
  v_permlane32_swap_b32 v76, v78
  v_permlane32_swap_b32 v77, v79
  v_pk_add_f32 v[76:77], v[76:77], v[78:79]
  v_mul_f32 v76, v66, v76
  v_mul_f32 v77, v66, v77
  v_fma_f32 v77, -v76, v76, v77
  v_max_f32 v77, 0, v77
  v_add_f32 v78, v67, v77
  v_rsq_f32 v78, v78
  s_nop 0
  v_mul_f32 v77, v77, v78
  v_fma_f32 v77, v77, v78, v67
  v_rsq_f32 v77, v77
  s_nop 0
  v_mul_f32_e64 v78, v78, v77
  v_mul_f32 v76, -v76, v78
  v_pk_fma_f32 v[128:129], v[128:129], v[78:79], v[76:77] op_sel_hi:[1,0,0]
  v_pk_fma_f32 v[130:131], v[130:131], v[78:79], v[76:77] op_sel_hi:[1,0,0]
  v_pk_fma_f32 v[132:133], v[132:133], v[78:79], v[76:77] op_sel_hi:[1,0,0]
  v_pk_fma_f32 v[134:135], v[134:135], v[78:79], v[76:77] op_sel_hi:[1,0,0]
  v_pk_fma_f32 v[136:137], v[136:137], v[78:79], v[76:77] op_sel_hi:[1,0,0]
  v_pk_fma_f32 v[138:139], v[138:139], v[78:79], v[76:77] op_sel_hi:[1,0,0]
  v_pk_fma_f32 v[140:141], v[140:141], v[78:79], v[76:77] op_sel_hi:[1,0,0]
  v_pk_fma_f32 v[142:143], v[142:143], v[78:79], v[76:77] op_sel_hi:[1,0,0]
  v_cvt_pk_bf16_f32 v112, v128, v129
  v_cvt_pk_bf16_f32 v113, v130, v131
  ds_write_b64 v252, v[112:113]
  v_cvt_pk_bf16_f32 v114, v132, v133
  v_cvt_pk_bf16_f32 v115, v134, v135
  v_xor_b32 v67, 16, v252
  ds_write_b64 v67, v[114:115]
  v_cvt_pk_bf16_f32 v116, v136, v137
  v_cvt_pk_bf16_f32 v117, v138, v139
  v_xor_b32 v68, 32, v252
  ds_write_b64 v68, v[116:117]
  v_cvt_pk_bf16_f32 v118, v140, v141
  v_cvt_pk_bf16_f32 v119, v142, v143
  v_xor_b32 v69, 48, v252
  ds_write_b64 v69, v[118:119]
  s_waitcnt lgkmcnt(0)
  ds_read_b64_tr_b16 v[80:81], v253 offset:0
  ds_read_b64_tr_b16 v[82:83], v254 offset:0
  ds_read_b64_tr_b16 v[84:85], v253 offset:1024
  ds_read_b64_tr_b16 v[86:87], v254 offset:1024
  s_waitcnt lgkmcnt(2)
  v_or_b32 v80, 1, v80
  buffer_store_dwordx4 v[80:83], v2, s[64:67], s13 offen offset:0 sc1
  s_waitcnt lgkmcnt(0)
  v_or_b32 v84, 1, v84
  buffer_store_dwordx4 v[84:87], v2, s[64:67], s13 offen offset:1024 sc1
  s_add_u32 m0, s11, 73728
  s_add_u32 s18, s15, 1605632
  buffer_load_dwordx4 v248, s[36:39], s18 offen lds
  buffer_load_dwordx4 v249, s[36:39], s18 offen offset:1024 lds
  buffer_load_dwordx4 v250, s[36:39], s18 offen offset:2048 lds
  buffer_load_dwordx4 v251, s[36:39], s18 offen offset:3072 lds
  s_add_u32 m0, s11, 77824
  s_add_u32 s18, s15, 1720320
  buffer_load_dwordx4 v248, s[36:39], s18 offen lds
  buffer_load_dwordx4 v249, s[36:39], s18 offen offset:1024 lds
  buffer_load_dwordx4 v250, s[36:39], s18 offen offset:2048 lds
  buffer_load_dwordx4 v251, s[36:39], s18 offen offset:3072 lds
  s_cmp_eq_u32 s83, 1
  s_cbranch_scc1 L_skipC_22
  s_waitcnt vmcnt(18)
  ds_read_b64_tr_b16 a[64:65], v10 offset:0
  ds_read_b64_tr_b16 a[66:67], v10 offset:512
  ds_read_b64_tr_b16 a[68:69], v11 offset:0
  ds_read_b64_tr_b16 a[70:71], v11 offset:512
  ds_read_b64_tr_b16 a[72:73], v10 offset:2048
  ds_read_b64_tr_b16 a[74:75], v10 offset:2560
  ds_read_b64_tr_b16 a[76:77], v11 offset:2048
  ds_read_b64_tr_b16 a[78:79], v11 offset:2560
  s_waitcnt vmcnt(14)
  ds_read_b64_tr_b16 a[80:81], v10 offset:4096
  ds_read_b64_tr_b16 a[82:83], v10 offset:4608
  ds_read_b64_tr_b16 a[84:85], v11 offset:4096
  ds_read_b64_tr_b16 a[86:87], v11 offset:4608
  ds_read_b64_tr_b16 a[88:89], v10 offset:6144
  ds_read_b64_tr_b16 a[90:91], v10 offset:6656
  ds_read_b64_tr_b16 a[92:93], v11 offset:6144
  ds_read_b64_tr_b16 a[94:95], v11 offset:6656
  s_waitcnt lgkmcnt(8)
  s_add_u32 m0, s11, 65536
  s_add_u32 s18, s16, 0
  buffer_load_dwordx4 v36, s[52:55], s18 offen lds
  buffer_load_dwordx4 v37, s[52:55], s18 offen offset:1024 lds
  buffer_load_dwordx4 v38, s[52:55], s18 offen offset:2048 lds
  buffer_load_dwordx4 v39, s[52:55], s18 offen offset:3072 lds
  s_waitcnt vmcnt(8)
  ds_read_b64_tr_b16 a[96:97], v10 offset:8192
  ds_read_b64_tr_b16 a[98:99], v10 offset:8704
  ds_read_b64_tr_b16 a[100:101], v11 offset:8192
  ds_read_b64_tr_b16 a[102:103], v11 offset:8704
  ds_read_b64_tr_b16 a[104:105], v10 offset:10240
  ds_read_b64_tr_b16 a[106:107], v10 offset:10752
  ds_read_b64_tr_b16 a[108:109], v11 offset:10240
  ds_read_b64_tr_b16 a[110:111], v11 offset:10752
  s_waitcnt lgkmcnt(8)
  s_add_u32 m0, s11, 69632
  s_add_u32 s18, s16, 131072
  buffer_load_dwordx4 v36, s[52:55], s18 offen lds
  buffer_load_dwordx4 v37, s[52:55], s18 offen offset:1024 lds
  buffer_load_dwordx4 v38, s[52:55], s18 offen offset:2048 lds
  buffer_load_dwordx4 v39, s[52:55], s18 offen offset:3072 lds
  s_waitcnt vmcnt(8)
  ds_read_b64_tr_b16 a[112:113], v10 offset:12288
  ds_read_b64_tr_b16 a[114:115], v10 offset:12800
  ds_read_b64_tr_b16 a[116:117], v11 offset:12288
  ds_read_b64_tr_b16 a[118:119], v11 offset:12800
  ds_read_b64_tr_b16 a[120:121], v10 offset:14336
  ds_read_b64_tr_b16 a[122:123], v10 offset:14848
  ds_read_b64_tr_b16 a[124:125], v11 offset:14336
  ds_read_b64_tr_b16 a[126:127], v11 offset:14848
  s_waitcnt lgkmcnt(8)
  s_add_u32 m0, s11, 73728
  s_add_u32 s18, s16, 262144
  buffer_load_dwordx4 v36, s[52:55], s18 offen lds
  buffer_load_dwordx4 v37, s[52:55], s18 offen offset:1024 lds
  buffer_load_dwordx4 v38, s[52:55], s18 offen offset:2048 lds
  buffer_load_dwordx4 v39, s[52:55], s18 offen offset:3072 lds
  s_waitcnt lgkmcnt(0)
  s_add_u32 m0, s11, 77824
  s_add_u32 s18, s16, 393216
  buffer_load_dwordx4 v36, s[52:55], s18 offen lds
  buffer_load_dwordx4 v37, s[52:55], s18 offen offset:1024 lds
  buffer_load_dwordx4 v38, s[52:55], s18 offen offset:2048 lds
  buffer_load_dwordx4 v39, s[52:55], s18 offen offset:3072 lds
  v_lshlrev_b32 v128, 16, v16
  v_and_b32 v129, 0xffff0000, v16
  v_lshlrev_b32 v130, 16, v17
  v_and_b32 v131, 0xffff0000, v17
  v_lshlrev_b32 v132, 16, v18
  v_and_b32 v133, 0xffff0000, v18
  v_lshlrev_b32 v134, 16, v19
  v_and_b32 v135, 0xffff0000, v19
  v_lshlrev_b32 v136, 16, v20
  v_and_b32 v137, 0xffff0000, v20
  v_lshlrev_b32 v138, 16, v21
  v_and_b32 v139, 0xffff0000, v21
  v_lshlrev_b32 v140, 16, v22
  v_and_b32 v141, 0xffff0000, v22
  v_lshlrev_b32 v142, 16, v23
  v_and_b32 v143, 0xffff0000, v23
  buffer_load_dwordx4 v[64:67], v26, s[64:67], s92 offen offset:0 sc1
  buffer_load_dwordx4 v[68:71], v27, s[64:67], s92 offen offset:0 sc1
  buffer_load_dwordx4 v[72:75], v26, s[64:67], s92 offen offset:1024 sc1
  buffer_load_dwordx4 v[76:79], v27, s[64:67], s92 offen offset:1024 sc1
  buffer_load_dwordx4 v[80:83], v30, s[64:67], s92 offen offset:0 sc1
  buffer_load_dwordx4 v[84:87], v31, s[64:67], s92 offen offset:0 sc1
  buffer_load_dwordx4 v[88:91], v30, s[64:67], s92 offen offset:1024 sc1
  buffer_load_dwordx4 v[92:95], v31, s[64:67], s92 offen offset:1024 sc1
  buffer_load_dwordx4 v[96:99], v26, s[64:67], s93 offen offset:0 sc1
  buffer_load_dwordx4 v[100:103], v27, s[64:67], s93 offen offset:0 sc1
  buffer_load_dwordx4 v[104:107], v26, s[64:67], s93 offen offset:1024 sc1
  buffer_load_dwordx4 v[108:111], v27, s[64:67], s93 offen offset:1024 sc1
  buffer_load_dwordx4 v[112:115], v30, s[64:67], s93 offen offset:0 sc1
  buffer_load_dwordx4 v[116:119], v31, s[64:67], s93 offen offset:0 sc1
  s_waitcnt vmcnt(12)
L_Cc_23:
  v_bitop3_b32 v24, v64, v68, 1 bitop3:0x80
  v_cmp_eq_u32 vcc, 0, v24
  s_nop 1
  s_cbranch_vccnz L_Cr_24
L_Ck_25:
  v_mfma_f32_32x32x16_bf16 v[128:143], a[128:131], v[64:67], v[128:143]
  v_mfma_f32_32x32x16_bf16 v[144:159], a[128:131], v[68:71], 0
  buffer_load_dwordx4 v[120:123], v30, s[64:67], s93 offen offset:1024 sc1
  buffer_load_dwordx4 v[124:127], v31, s[64:67], s93 offen offset:1024 sc1
  v_mfma_f32_32x32x16_bf16 v[160:175], a[132:135], v[64:67], 0
  v_mfma_f32_32x32x16_bf16 v[176:191], a[132:135], v[68:71], 0
  s_waitcnt vmcnt(12)
L_Cc_26:
  v_bitop3_b32 v24, v72, v76, 1 bitop3:0x80
  v_cmp_eq_u32 vcc, 0, v24
  s_nop 1
  s_cbranch_vccnz L_Cr_27
L_Ck_28:
  v_mfma_f32_32x32x16_bf16 v[128:143], a[136:139], v[72:75], v[128:143]
  v_mfma_f32_32x32x16_bf16 v[144:159], a[136:139], v[76:79], v[144:159]
  buffer_load_dwordx4 v[64:67], v26, s[64:67], s94 offen offset:0 sc1
  buffer_load_dwordx4 v[68:71], v27, s[64:67], s94 offen offset:0 sc1
  v_mfma_f32_32x32x16_bf16 v[160:175], a[140:143], v[72:75], v[160:175]
  v_mfma_f32_32x32x16_bf16 v[176:191], a[140:143], v[76:79], v[176:191]
  s_waitcnt vmcnt(12)
L_Cc_29:
  v_bitop3_b32 v24, v80, v84, 1 bitop3:0x80
  v_cmp_eq_u32 vcc, 0, v24
  s_nop 1
  s_cbranch_vccnz L_Cr_30
L_Ck_31:
  v_mfma_f32_32x32x16_bf16 v[128:143], a[144:147], v[80:83], v[128:143]
  s_lshl_b32 s100, s20, 6
  v_mfma_f32_32x32x16_bf16 v[144:159], a[144:147], v[84:87], v[144:159]
  buffer_load_dwordx4 v[72:75], v26, s[64:67], s94 offen offset:1024 sc1
  buffer_load_dwordx4 v[76:79], v27, s[64:67], s94 offen offset:1024 sc1
  v_mul_u32_u24 v4, 512, v15
  v_mfma_f32_32x32x16_bf16 v[160:175], a[148:151], v[80:83], v[160:175]
  v_bfe_u32 v28, v1, 2, 2
  v_mfma_f32_32x32x16_bf16 v[176:191], a[148:151], v[84:87], v[176:191]
  v_lshl_add_u32 v4, v28, 7, v4
  s_waitcnt vmcnt(12)
L_Cc_32:
  v_bitop3_b32 v24, v88, v92, 1 bitop3:0x80
  v_cmp_eq_u32 vcc, 0, v24
  s_nop 1
  s_cbranch_vccnz L_Cr_33
L_Ck_34:
  v_mfma_f32_32x32x16_bf16 v[128:143], a[152:155], v[88:91], v[128:143]
  v_bfe_u32 v28, v1, 3, 1
  v_mfma_f32_32x32x16_bf16 v[144:159], a[152:155], v[92:95], v[144:159]
  buffer_load_dwordx4 v[80:83], v30, s[64:67], s94 offen offset:0 sc1
  buffer_load_dwordx4 v[84:87], v31, s[64:67], s94 offen offset:0 sc1
  v_lshlrev_b32 v28, 6, v28
  v_mfma_f32_32x32x16_bf16 v[160:175], a[156:159], v[88:91], v[160:175]
  v_bfe_u32 v29, v1, 4, 1
  v_mfma_f32_32x32x16_bf16 v[176:191], a[156:159], v[92:95], v[176:191]
  v_lshl_or_b32 v28, v29, 5, v28
  s_waitcnt vmcnt(12)
L_Cc_35:
  v_bitop3_b32 v24, v96, v100, 1 bitop3:0x80
  v_cmp_eq_u32 vcc, 0, v24
  s_nop 1
  s_cbranch_vccnz L_Cr_36
L_Ck_37:
  v_mfma_f32_32x32x16_bf16 v[128:143], a[160:163], v[96:99], v[128:143]
  v_and_b32 v29, 3, v1
  v_mfma_f32_32x32x16_bf16 v[144:159], a[160:163], v[100:103], v[144:159]
  buffer_load_dwordx4 v[88:91], v30, s[64:67], s94 offen offset:1024 sc1
  buffer_load_dwordx4 v[92:95], v31, s[64:67], s94 offen offset:1024 sc1
  v_lshl_or_b32 v28, v29, 3, v28
  v_mfma_f32_32x32x16_bf16 v[160:175], a[164:167], v[96:99], v[160:175]
  v_xor_b32 v28, s100, v28
  v_mfma_f32_32x32x16_bf16 v[176:191], a[164:167], v[100:103], v[176:191]
  v_add_u32 v4, v4, v28
  s_waitcnt vmcnt(12)
L_Cc_38:
  v_bitop3_b32 v24, v104, v108, 1 bitop3:0x80
  v_cmp_eq_u32 vcc, 0, v24
  s_nop 1
  s_cbranch_vccnz L_Cr_39
L_Ck_40:
  v_mfma_f32_32x32x16_bf16 v[128:143], a[168:171], v[104:107], v[128:143]
  v_add_u32 v4, s11, v4
  v_mfma_f32_32x32x16_bf16 v[144:159], a[168:171], v[108:111], v[144:159]
  buffer_load_dwordx4 v[96:99], v26, s[64:67], s95 offen offset:0 sc1
  buffer_load_dwordx4 v[100:103], v27, s[64:67], s95 offen offset:0 sc1
  v_xor_b32 v5, 64, v4
  v_mfma_f32_32x32x16_bf16 v[160:175], a[172:175], v[104:107], v[160:175]
  v_add_u32 v6, 0x10000, v4
  v_mfma_f32_32x32x16_bf16 v[176:191], a[172:175], v[108:111], v[176:191]
  v_add_u32 v7, 0x10000, v5
  s_waitcnt vmcnt(12)
L_Cc_41:
  v_bitop3_b32 v24, v112, v116, 1 bitop3:0x80
  v_cmp_eq_u32 vcc, 0, v24
  s_nop 1
  s_cbranch_vccnz L_Cr_42
L_Ck_43:
  v_mfma_f32_32x32x16_bf16 v[128:143], a[176:179], v[112:115], v[128:143]
  s_lshl_b32 s100, s68, 13
  v_mfma_f32_32x32x16_bf16 v[144:159], a[176:179], v[116:119], v[144:159]
  buffer_load_dwordx4 v[104:107], v26, s[64:67], s95 offen offset:1024 sc1
  buffer_load_dwordx4 v[108:111], v27, s[64:67], s95 offen offset:1024 sc1
  s_sub_u32 s100, 0x20000, s100
  v_mfma_f32_32x32x16_bf16 v[160:175], a[180:183], v[112:115], v[160:175]
  v_add_u32 v28, s100, v4
  v_mfma_f32_32x32x16_bf16 v[176:191], a[180:183], v[116:119], v[176:191]
  v_add_u32 v29, s100, v5
  s_waitcnt vmcnt(12)
L_Cc_44:
  v_bitop3_b32 v24, v120, v124, 1 bitop3:0x80
  v_cmp_eq_u32 vcc, 0, v24
  s_nop 1
  s_cbranch_vccnz L_Cr_45
L_Ck_46:
  v_mfma_f32_32x32x16_bf16 v[128:143], a[184:187], v[120:123], v[128:143]
  s_lshl1_add_u32 s100, s81, s20
  v_mfma_f32_32x32x16_bf16 v[144:159], a[184:187], v[124:127], v[144:159]
  buffer_load_dwordx4 v[112:115], v30, s[64:67], s95 offen offset:0 sc1
  buffer_load_dwordx4 v[116:119], v31, s[64:67], s95 offen offset:0 sc1
  s_lshl1_add_u32 s101, s78, s19
  v_mfma_f32_32x32x16_bf16 v[160:175], a[188:191], v[120:123], v[160:175]
  s_lshl_b32 s84, s100, 15
  v_mfma_f32_32x32x16_bf16 v[176:191], a[188:191], v[124:127], v[176:191]
  s_lshl_b32 s85, s101, 6
  s_waitcnt vmcnt(12)
L_Cc_47:
  v_bitop3_b32 v24, v64, v68, 1 bitop3:0x80
  v_cmp_eq_u32 vcc, 0, v24
  s_nop 1
  s_cbranch_vccnz L_Cr_48
L_Ck_49:
  v_mfma_f32_32x32x16_bf16 v[128:143], a[192:195], v[64:67], v[128:143]
  s_add_u32 s84, s84, s85
  v_mfma_f32_32x32x16_bf16 v[144:159], a[192:195], v[68:71], v[144:159]
  buffer_load_dwordx4 v[120:123], v30, s[64:67], s95 offen offset:1024 sc1
  buffer_load_dwordx4 v[124:127], v31, s[64:67], s95 offen offset:1024 sc1
  s_lshl_b32 s85, s100, 6
  v_mfma_f32_32x32x16_bf16 v[160:175], a[196:199], v[64:67], v[160:175]
  s_lshl4_add_u32 s86, s100, s101
  v_mfma_f32_32x32x16_bf16 v[176:191], a[196:199], v[68:71], v[176:191]
  s_lshl_b32 s86, s86, 11
  s_waitcnt vmcnt(12)
L_Cc_50:
  v_bitop3_b32 v24, v72, v76, 1 bitop3:0x80
  v_cmp_eq_u32 vcc, 0, v24
  s_nop 1
  s_cbranch_vccnz L_Cr_51
L_Ck_52:
  v_mfma_f32_32x32x16_bf16 v[128:143], a[200:203], v[72:75], v[128:143]
  s_add_u32 s86, s86, 8388608
  v_mfma_f32_32x32x16_bf16 v[144:159], a[200:203], v[76:79], v[144:159]
  buffer_load_dwordx4 v[64:67], v26, s[64:67], s96 offen offset:0 sc1
  buffer_load_dwordx4 v[68:71], v27, s[64:67], s96 offen offset:0 sc1
  v_and_b32 v14, 31, v1
  v_mfma_f32_32x32x16_bf16 v[160:175], a[204:207], v[72:75], v[160:175]
  v_lshlrev_b32 v43, 1, v14
  v_mfma_f32_32x32x16_bf16 v[176:191], a[204:207], v[76:79], v[176:191]
  v_lshlrev_b32 v13, 10, v14
  s_waitcnt vmcnt(12)
L_Cc_53:
  v_bitop3_b32 v24, v80, v84, 1 bitop3:0x80
  v_cmp_eq_u32 vcc, 0, v24
  s_nop 1
  s_cbranch_vccnz L_Cr_54
L_Ck_55:
  v_mfma_f32_32x32x16_bf16 v[128:143], a[208:211], v[80:83], v[128:143]
  v_lshl_add_u32 v13, v15, 4, v13
  v_mfma_f32_32x32x16_bf16 v[144:159], a[208:211], v[84:87], v[144:159]
  buffer_load_dwordx4 v[72:75], v26, s[64:67], s96 offen offset:1024 sc1
  buffer_load_dwordx4 v[76:79], v27, s[64:67], s96 offen offset:1024 sc1
  s_mul_i32 s100, s78, 229376
  v_mfma_f32_32x32x16_bf16 v[160:175], a[212:215], v[80:83], v[160:175]
  s_mul_i32 s101, s68, 28672
  v_mfma_f32_32x32x16_bf16 v[176:191], a[212:215], v[84:87], v[176:191]
  s_add_u32 s100, s100, s101
  s_waitcnt vmcnt(12)
L_Cc_56:
  v_bitop3_b32 v24, v88, v92, 1 bitop3:0x80
  v_cmp_eq_u32 vcc, 0, v24
  s_nop 1
  s_cbranch_vccnz L_Cr_57
L_Ck_58:
  v_mfma_f32_32x32x16_bf16 v[128:143], a[216:219], v[88:91], v[128:143]
  s_add_u32 s17, s100, 6291456
  v_mfma_f32_32x32x16_bf16 v[144:159], a[216:219], v[92:95], v[144:159]
  buffer_load_dwordx4 v[80:83], v30, s[64:67], s96 offen offset:0 sc1
  buffer_load_dwordx4 v[84:87], v31, s[64:67], s96 offen offset:0 sc1
  s_mul_i32 s101, s19, 114688
  v_mfma_f32_32x32x16_bf16 v[160:175], a[220:223], v[88:91], v[160:175]
  s_add_u32 s100, s17, s101
  v_mfma_f32_32x32x16_bf16 v[176:191], a[220:223], v[92:95], v[176:191]
  v_add_u32 v40, s100, v2
  s_waitcnt vmcnt(12)
L_Cc_59:
  v_bitop3_b32 v24, v96, v100, 1 bitop3:0x80
  v_cmp_eq_u32 vcc, 0, v24
  s_nop 1
  s_cbranch_vccnz L_Cr_60
L_Ck_61:
  v_mfma_f32_32x32x16_bf16 v[128:143], a[224:227], v[96:99], v[128:143]
  s_sub_u32 s101, 114688, s101
  v_mfma_f32_32x32x16_bf16 v[144:159], a[224:227], v[100:103], v[144:159]
  buffer_load_dwordx4 v[88:91], v30, s[64:67], s96 offen offset:1024 sc1
  buffer_load_dwordx4 v[92:95], v31, s[64:67], s96 offen offset:1024 sc1
  s_add_u32 s100, s17, s101
  v_mfma_f32_32x32x16_bf16 v[160:175], a[228:231], v[96:99], v[160:175]
  v_add_u32 v41, s100, v2
  v_mfma_f32_32x32x16_bf16 v[176:191], a[228:231], v[100:103], v[176:191]
  s_waitcnt vmcnt(12)
L_Cc_62:
  v_bitop3_b32 v24, v104, v108, 1 bitop3:0x80
  v_cmp_eq_u32 vcc, 0, v24
  s_nop 1
  s_cbranch_vccnz L_Cr_63
L_Ck_64:
  v_mfma_f32_32x32x16_bf16 v[128:143], a[232:235], v[104:107], v[128:143]
  v_mfma_f32_32x32x16_bf16 v[144:159], a[232:235], v[108:111], v[144:159]
  buffer_load_dwordx4 v[96:99], v26, s[64:67], s97 offen offset:0 sc1
  buffer_load_dwordx4 v[100:103], v27, s[64:67], s97 offen offset:0 sc1
  v_mfma_f32_32x32x16_bf16 v[160:175], a[236:239], v[104:107], v[160:175]
  v_mfma_f32_32x32x16_bf16 v[176:191], a[236:239], v[108:111], v[176:191]
  s_waitcnt vmcnt(12)
L_Cc_65:
  v_bitop3_b32 v24, v112, v116, 1 bitop3:0x80
  v_cmp_eq_u32 vcc, 0, v24
  s_nop 1
  s_cbranch_vccnz L_Cr_66
L_Ck_67:
  v_mfma_f32_32x32x16_bf16 v[128:143], a[240:243], v[112:115], v[128:143]
  v_mfma_f32_32x32x16_bf16 v[144:159], a[240:243], v[116:119], v[144:159]
  buffer_load_dwordx4 v[104:107], v26, s[64:67], s97 offen offset:1024 sc1
  buffer_load_dwordx4 v[108:111], v27, s[64:67], s97 offen offset:1024 sc1
  v_mfma_f32_32x32x16_bf16 v[160:175], a[244:247], v[112:115], v[160:175]
  v_mfma_f32_32x32x16_bf16 v[176:191], a[244:247], v[116:119], v[176:191]
  s_waitcnt vmcnt(12)
L_Cc_68:
  v_bitop3_b32 v24, v120, v124, 1 bitop3:0x80
  v_cmp_eq_u32 vcc, 0, v24
  s_nop 1
  s_cbranch_vccnz L_Cr_69
L_Ck_70:
  v_mfma_f32_32x32x16_bf16 v[128:143], a[248:251], v[120:123], v[128:143]
  v_mfma_f32_32x32x16_bf16 v[144:159], a[248:251], v[124:127], v[144:159]
  buffer_load_dwordx4 v[112:115], v30, s[64:67], s97 offen offset:0 sc1
  buffer_load_dwordx4 v[116:119], v31, s[64:67], s97 offen offset:0 sc1
  v_mfma_f32_32x32x16_bf16 v[160:175], a[252:255], v[120:123], v[160:175]
  v_mfma_f32_32x32x16_bf16 v[176:191], a[252:255], v[124:127], v[176:191]
  s_waitcnt vmcnt(12)
L_Cc_71:
  v_bitop3_b32 v24, v64, v68, 1 bitop3:0x80
  v_cmp_eq_u32 vcc, 0, v24
  s_nop 1
  s_cbranch_vccnz L_Cr_72
L_Ck_73:
  v_mfma_f32_32x32x16_bf16 v[128:143], a[0:3], v[64:67], v[128:143]
  ds_read_b64_tr_b16 a[128:129], v6 offset:0
  v_mfma_f32_32x32x16_bf16 v[144:159], a[0:3], v[68:71], v[144:159]
  buffer_load_dwordx4 v[120:123], v30, s[64:67], s97 offen offset:1024 sc1
  buffer_load_dwordx4 v[124:127], v31, s[64:67], s97 offen offset:1024 sc1
  ds_read_b64_tr_b16 a[130:131], v6 offset:1024
  v_mfma_f32_32x32x16_bf16 v[160:175], a[4:7], v[64:67], v[160:175]
  ds_read_b64_tr_b16 a[132:133], v7 offset:0
  v_mfma_f32_32x32x16_bf16 v[176:191], a[4:7], v[68:71], v[176:191]
  ds_read_b64_tr_b16 a[134:135], v7 offset:1024
  s_waitcnt vmcnt(12)
L_Cc_74:
  v_bitop3_b32 v24, v72, v76, 1 bitop3:0x80
  v_cmp_eq_u32 vcc, 0, v24
  s_nop 1
  s_cbranch_vccnz L_Cr_75
L_Ck_76:
  v_mfma_f32_32x32x16_bf16 v[128:143], a[8:11], v[72:75], v[128:143]
  ds_read_b64_tr_b16 a[136:137], v6 offset:2048
  v_mfma_f32_32x32x16_bf16 v[144:159], a[8:11], v[76:79], v[144:159]
  buffer_load_dwordx4 v[64:67], v26, s[64:67], s98 offen offset:0 sc1
  buffer_load_dwordx4 v[68:71], v27, s[64:67], s98 offen offset:0 sc1
  ds_read_b64_tr_b16 a[138:139], v6 offset:3072
  v_mfma_f32_32x32x16_bf16 v[160:175], a[12:15], v[72:75], v[160:175]
  ds_read_b64_tr_b16 a[140:141], v7 offset:2048
  v_mfma_f32_32x32x16_bf16 v[176:191], a[12:15], v[76:79], v[176:191]
  ds_read_b64_tr_b16 a[142:143], v7 offset:3072
  s_waitcnt vmcnt(12)
L_Cc_77:
  v_bitop3_b32 v24, v80, v84, 1 bitop3:0x80
  v_cmp_eq_u32 vcc, 0, v24
  s_nop 1
  s_cbranch_vccnz L_Cr_78
L_Ck_79:
  v_mfma_f32_32x32x16_bf16 v[128:143], a[16:19], v[80:83], v[128:143]
  ds_read_b64_tr_b16 a[144:145], v6 offset:4096
  v_mfma_f32_32x32x16_bf16 v[144:159], a[16:19], v[84:87], v[144:159]
  buffer_load_dwordx4 v[72:75], v26, s[64:67], s98 offen offset:1024 sc1
  buffer_load_dwordx4 v[76:79], v27, s[64:67], s98 offen offset:1024 sc1
  ds_read_b64_tr_b16 a[146:147], v6 offset:5120
  v_mfma_f32_32x32x16_bf16 v[160:175], a[20:23], v[80:83], v[160:175]
  ds_read_b64_tr_b16 a[148:149], v7 offset:4096
  v_mfma_f32_32x32x16_bf16 v[176:191], a[20:23], v[84:87], v[176:191]
  ds_read_b64_tr_b16 a[150:151], v7 offset:5120
  s_waitcnt vmcnt(12)
L_Cc_80:
  v_bitop3_b32 v24, v88, v92, 1 bitop3:0x80
  v_cmp_eq_u32 vcc, 0, v24
  s_nop 1
  s_cbranch_vccnz L_Cr_81
L_Ck_82:
  v_mfma_f32_32x32x16_bf16 v[128:143], a[24:27], v[88:91], v[128:143]
  ds_read_b64_tr_b16 a[152:153], v6 offset:6144
  v_mfma_f32_32x32x16_bf16 v[144:159], a[24:27], v[92:95], v[144:159]
  buffer_load_dwordx4 v[80:83], v30, s[64:67], s98 offen offset:0 sc1
  buffer_load_dwordx4 v[84:87], v31, s[64:67], s98 offen offset:0 sc1
  ds_read_b64_tr_b16 a[154:155], v6 offset:7168
  v_mfma_f32_32x32x16_bf16 v[160:175], a[28:31], v[88:91], v[160:175]
  ds_read_b64_tr_b16 a[156:157], v7 offset:6144
  v_mfma_f32_32x32x16_bf16 v[176:191], a[28:31], v[92:95], v[176:191]
  ds_read_b64_tr_b16 a[158:159], v7 offset:7168
  s_waitcnt vmcnt(12)
L_Cc_83:
  v_bitop3_b32 v24, v96, v100, 1 bitop3:0x80
  v_cmp_eq_u32 vcc, 0, v24
  s_nop 1
  s_cbranch_vccnz L_Cr_84
L_Ck_85:
  v_mfma_f32_32x32x16_bf16 v[128:143], a[32:35], v[96:99], v[128:143]
  ds_read_b64_tr_b16 a[160:161], v6 offset:8192
  v_mfma_f32_32x32x16_bf16 v[144:159], a[32:35], v[100:103], v[144:159]
  buffer_load_dwordx4 v[88:91], v30, s[64:67], s98 offen offset:1024 sc1
  buffer_load_dwordx4 v[92:95], v31, s[64:67], s98 offen offset:1024 sc1
  ds_read_b64_tr_b16 a[162:163], v6 offset:9216
  v_mfma_f32_32x32x16_bf16 v[160:175], a[36:39], v[96:99], v[160:175]
  ds_read_b64_tr_b16 a[164:165], v7 offset:8192
  v_mfma_f32_32x32x16_bf16 v[176:191], a[36:39], v[100:103], v[176:191]
  ds_read_b64_tr_b16 a[166:167], v7 offset:9216
  s_waitcnt vmcnt(12)
L_Cc_86:
  v_bitop3_b32 v24, v104, v108, 1 bitop3:0x80
  v_cmp_eq_u32 vcc, 0, v24
  s_nop 1
  s_cbranch_vccnz L_Cr_87
L_Ck_88:
  v_mfma_f32_32x32x16_bf16 v[128:143], a[40:43], v[104:107], v[128:143]
  ds_read_b64_tr_b16 a[168:169], v6 offset:10240
  v_mfma_f32_32x32x16_bf16 v[144:159], a[40:43], v[108:111], v[144:159]
  buffer_load_dwordx4 v[96:99], v26, s[64:67], s99 offen offset:0 sc1
  buffer_load_dwordx4 v[100:103], v27, s[64:67], s99 offen offset:0 sc1
  ds_read_b64_tr_b16 a[170:171], v6 offset:11264
  v_mfma_f32_32x32x16_bf16 v[160:175], a[44:47], v[104:107], v[160:175]
  ds_read_b64_tr_b16 a[172:173], v7 offset:10240
  v_mfma_f32_32x32x16_bf16 v[176:191], a[44:47], v[108:111], v[176:191]
  ds_read_b64_tr_b16 a[174:175], v7 offset:11264
  s_waitcnt vmcnt(12)
L_Cc_89:
  v_bitop3_b32 v24, v112, v116, 1 bitop3:0x80
  v_cmp_eq_u32 vcc, 0, v24
  s_nop 1
  s_cbranch_vccnz L_Cr_90
L_Ck_91:
  v_mfma_f32_32x32x16_bf16 v[128:143], a[48:51], v[112:115], v[128:143]
  ds_read_b64_tr_b16 a[176:177], v6 offset:12288
  v_mfma_f32_32x32x16_bf16 v[144:159], a[48:51], v[116:119], v[144:159]
  buffer_load_dwordx4 v[104:107], v26, s[64:67], s99 offen offset:1024 sc1
  buffer_load_dwordx4 v[108:111], v27, s[64:67], s99 offen offset:1024 sc1
  ds_read_b64_tr_b16 a[178:179], v6 offset:13312
  v_mfma_f32_32x32x16_bf16 v[160:175], a[52:55], v[112:115], v[160:175]
  ds_read_b64_tr_b16 a[180:181], v7 offset:12288
  v_mfma_f32_32x32x16_bf16 v[176:191], a[52:55], v[116:119], v[176:191]
  ds_read_b64_tr_b16 a[182:183], v7 offset:13312
  s_waitcnt vmcnt(12)
L_Cc_92:
  v_bitop3_b32 v24, v120, v124, 1 bitop3:0x80
  v_cmp_eq_u32 vcc, 0, v24
  s_nop 1
  s_cbranch_vccnz L_Cr_93
L_Ck_94:
  v_mfma_f32_32x32x16_bf16 v[128:143], a[56:59], v[120:123], v[128:143]
  ds_read_b64_tr_b16 a[184:185], v6 offset:14336
  v_mfma_f32_32x32x16_bf16 v[144:159], a[56:59], v[124:127], v[144:159]
  buffer_load_dwordx4 v[112:115], v30, s[64:67], s99 offen offset:0 sc1
  buffer_load_dwordx4 v[116:119], v31, s[64:67], s99 offen offset:0 sc1
  ds_read_b64_tr_b16 a[186:187], v6 offset:15360
  v_mfma_f32_32x32x16_bf16 v[160:175], a[60:63], v[120:123], v[160:175]
  ds_read_b64_tr_b16 a[188:189], v7 offset:14336
  v_mfma_f32_32x32x16_bf16 v[176:191], a[60:63], v[124:127], v[176:191]
  ds_read_b64_tr_b16 a[190:191], v7 offset:15360
  s_waitcnt vmcnt(12)
L_Cc_95:
  v_bitop3_b32 v24, v64, v68, 1 bitop3:0x80
  v_cmp_eq_u32 vcc, 0, v24
  s_nop 1
  s_cbranch_vccnz L_Cr_96
L_Ck_97:
  v_mfma_f32_32x32x16_bf16 v[128:143], a[64:67], v[64:67], v[128:143]
  v_mfma_f32_32x32x16_bf16 v[144:159], a[64:67], v[68:71], v[144:159]
  buffer_load_dwordx4 v[120:123], v30, s[64:67], s99 offen offset:1024 sc1
  buffer_load_dwordx4 v[124:127], v31, s[64:67], s99 offen offset:1024 sc1
  v_mfma_f32_32x32x16_bf16 v[160:175], a[68:71], v[64:67], v[160:175]
  v_mfma_f32_32x32x16_bf16 v[176:191], a[68:71], v[68:71], v[176:191]
  s_waitcnt vmcnt(12)
L_Cc_98:
  v_bitop3_b32 v24, v72, v76, 1 bitop3:0x80
  v_cmp_eq_u32 vcc, 0, v24
  s_nop 1
  s_cbranch_vccnz L_Cr_99
L_Ck_100:
  v_mfma_f32_32x32x16_bf16 v[128:143], a[72:75], v[72:75], v[128:143]
  v_mfma_f32_32x32x16_bf16 v[144:159], a[72:75], v[76:79], v[144:159]
  s_waitcnt lgkmcnt(0)
  v_mfma_f32_32x32x16_bf16 v[160:175], a[76:79], v[72:75], v[160:175]
  v_mfma_f32_32x32x16_bf16 v[176:191], a[76:79], v[76:79], v[176:191]
  s_add_u32 m0, s11, 65536
  s_add_u32 s18, s16, 524288
  buffer_load_dwordx4 v36, s[52:55], s18 offen lds
  s_waitcnt vmcnt(11)
L_Cc_101:
  v_bitop3_b32 v24, v80, v84, 1 bitop3:0x80
  v_cmp_eq_u32 vcc, 0, v24
  s_nop 1
  s_cbranch_vccnz L_Cr_102
L_Ck_103:
  v_mfma_f32_32x32x16_bf16 v[128:143], a[80:83], v[80:83], v[128:143]
  v_mfma_f32_32x32x16_bf16 v[144:159], a[80:83], v[84:87], v[144:159]
  buffer_load_dwordx4 v37, s[52:55], s18 offen offset:1024 lds
  v_mfma_f32_32x32x16_bf16 v[160:175], a[84:87], v[80:83], v[160:175]
  v_mfma_f32_32x32x16_bf16 v[176:191], a[84:87], v[84:87], v[176:191]
  buffer_load_dwordx4 v38, s[52:55], s18 offen offset:2048 lds
  s_waitcnt vmcnt(11)
L_Cc_104:
  v_bitop3_b32 v24, v88, v92, 1 bitop3:0x80
  v_cmp_eq_u32 vcc, 0, v24
  s_nop 1
  s_cbranch_vccnz L_Cr_105
L_Ck_106:
  v_mfma_f32_32x32x16_bf16 v[128:143], a[88:91], v[88:91], v[128:143]
  v_mfma_f32_32x32x16_bf16 v[144:159], a[88:91], v[92:95], v[144:159]
  buffer_load_dwordx4 v39, s[52:55], s18 offen offset:3072 lds
  v_mfma_f32_32x32x16_bf16 v[160:175], a[92:95], v[88:91], v[160:175]
  v_mfma_f32_32x32x16_bf16 v[176:191], a[92:95], v[92:95], v[176:191]
  s_add_u32 m0, s11, 69632
  s_add_u32 s18, s16, 655360
  buffer_load_dwordx4 v36, s[52:55], s18 offen lds
  s_waitcnt vmcnt(11)
L_Cc_107:
  v_bitop3_b32 v24, v96, v100, 1 bitop3:0x80
  v_cmp_eq_u32 vcc, 0, v24
  s_nop 1
  s_cbranch_vccnz L_Cr_108
L_Ck_109:
  s_waitcnt vmcnt(9)
L_Cc_110:
  v_bitop3_b32 v24, v104, v108, 1 bitop3:0x80
  v_cmp_eq_u32 vcc, 0, v24
  s_nop 1
  s_cbranch_vccnz L_Cr_111
L_Ck_112:
  s_waitcnt vmcnt(7)
L_Cc_113:
  v_bitop3_b32 v24, v112, v116, 1 bitop3:0x80
  v_cmp_eq_u32 vcc, 0, v24
  s_nop 1
  s_cbranch_vccnz L_Cr_114
L_Ck_115:
  s_waitcnt vmcnt(5)
L_Cc_116:
  v_bitop3_b32 v24, v120, v124, 1 bitop3:0x80
  v_cmp_eq_u32 vcc, 0, v24
  s_nop 1
  s_cbranch_vccnz L_Cr_117
L_Ck_118:
  v_mfma_f32_32x32x16_bf16 v[144:159], a[96:99], v[100:103], v[144:159]
  v_mfma_f32_32x32x16_bf16 v[144:159], a[104:107], v[108:111], v[144:159]
  buffer_load_dwordx4 v37, s[52:55], s18 offen offset:1024 lds
  v_mfma_f32_32x32x16_bf16 v[144:159], a[112:115], v[116:119], v[144:159]
  v_mfma_f32_32x32x16_bf16 v[144:159], a[120:123], v[124:127], v[144:159]
  buffer_load_dwordx4 v38, s[52:55], s18 offen offset:2048 lds
  v_mfma_f32_32x32x16_bf16 v[160:175], a[100:103], v[96:99], v[160:175]
  v_mfma_f32_32x32x16_bf16 v[160:175], a[108:111], v[104:107], v[160:175]
  ds_write_b128 v12, v[144:147] offset:4096
  ds_write_b128 v12, v[148:151] offset:5120
  buffer_load_dwordx4 v39, s[52:55], s18 offen offset:3072 lds
  v_mfma_f32_32x32x16_bf16 v[160:175], a[116:119], v[112:115], v[160:175]
  ds_write_b128 v12, v[152:155] offset:6144
  ds_write_b128 v12, v[156:159] offset:7168
  v_mfma_f32_32x32x16_bf16 v[160:175], a[124:127], v[120:123], v[160:175]
  s_add_u32 m0, s11, 73728
  s_add_u32 s18, s16, 786432
  buffer_load_dwordx4 v36, s[52:55], s18 offen lds
  v_mfma_f32_32x32x16_bf16 v[176:191], a[100:103], v[100:103], v[176:191]
  v_mfma_f32_32x32x16_bf16 v[176:191], a[108:111], v[108:111], v[176:191]
  ds_write_b128 v12, v[160:163] offset:8192
  ds_write_b128 v12, v[164:167] offset:9216
  buffer_load_dwordx4 v37, s[52:55], s18 offen offset:1024 lds
  v_mfma_f32_32x32x16_bf16 v[176:191], a[116:119], v[116:119], v[176:191]
  ds_write_b128 v12, v[168:171] offset:10240
  ds_write_b128 v12, v[172:175] offset:11264
  v_mfma_f32_32x32x16_bf16 v[176:191], a[124:127], v[124:127], v[176:191]
  buffer_load_dwordx4 v38, s[52:55], s18 offen offset:2048 lds
  v_mfma_f32_32x32x16_bf16 v[128:143], a[96:99], v[96:99], v[128:143]
  v_mfma_f32_32x32x16_bf16 v[128:143], a[104:107], v[104:107], v[128:143]
  ds_write_b128 v12, v[176:179] offset:12288
  ds_write_b128 v12, v[180:183] offset:13312
  buffer_load_dwordx4 v39, s[52:55], s18 offen offset:3072 lds
  v_mfma_f32_32x32x16_bf16 v[128:143], a[112:115], v[112:115], v[128:143]
  ds_write_b128 v12, v[184:187] offset:14336
  ds_write_b128 v12, v[188:191] offset:15360
  v_mfma_f32_32x32x16_bf16 v[128:143], a[120:123], v[120:123], v[128:143]
  s_add_u32 m0, s11, 77824
  s_add_u32 s18, s16, 917504
  buffer_load_dwordx4 v36, s[52:55], s18 offen lds
  buffer_load_dwordx4 v37, s[52:55], s18 offen offset:1024 lds
  buffer_load_dwordx4 v38, s[52:55], s18 offen offset:2048 lds
  buffer_load_dwordx4 v39, s[52:55], s18 offen offset:3072 lds
  s_and_b32 s101, s16, 0xfffffc00
  s_add_u32 s101, s101, 1048576
  buffer_load_dword v33, v34, s[52:55], s101 offen
  v_xor_b32 v113, 16384, v12
  v_xor_b32 v114, 32768, v12
  v_xor_b32 v115, 49152, v12
  s_waitcnt lgkmcnt(0)
  s_barrier
  ds_read_b128 v[64:67], v113 offset:4096
  ds_read_b128 v[68:71], v113 offset:5120
  ds_read_b128 v[72:75], v113 offset:6144
  ds_read_b128 v[76:79], v113 offset:7168
  ds_read_b128 v[80:83], v114 offset:8192
  ds_read_b128 v[84:87], v114 offset:9216
  ds_read_b128 v[88:91], v114 offset:10240
  ds_read_b128 v[92:95], v114 offset:11264
  ds_read_b128 v[96:99], v115 offset:12288
  ds_read_b128 v[100:103], v115 offset:13312
  ds_read_b128 v[104:107], v115 offset:14336
  ds_read_b128 v[108:111], v115 offset:15360
  s_waitcnt lgkmcnt(8)
  v_pk_add_f32 v[128:129], v[128:129], v[64:65]
  v_pk_add_f32 v[130:131], v[130:131], v[66:67]
  v_pk_add_f32 v[132:133], v[132:133], v[68:69]
  v_pk_add_f32 v[134:135], v[134:135], v[70:71]
  v_pk_add_f32 v[136:137], v[136:137], v[72:73]
  v_pk_add_f32 v[138:139], v[138:139], v[74:75]
  v_pk_add_f32 v[140:141], v[140:141], v[76:77]
  v_pk_add_f32 v[142:143], v[142:143], v[78:79]
  s_waitcnt lgkmcnt(4)
  v_pk_add_f32 v[128:129], v[128:129], v[80:81]
  v_pk_add_f32 v[130:131], v[130:131], v[82:83]
  v_pk_add_f32 v[132:133], v[132:133], v[84:85]
  v_pk_add_f32 v[134:135], v[134:135], v[86:87]
  v_pk_add_f32 v[136:137], v[136:137], v[88:89]
  v_pk_add_f32 v[138:139], v[138:139], v[90:91]
  v_pk_add_f32 v[140:141], v[140:141], v[92:93]
  v_pk_add_f32 v[142:143], v[142:143], v[94:95]
  s_waitcnt lgkmcnt(0)
  v_pk_add_f32 v[128:129], v[128:129], v[96:97]
  v_pk_add_f32 v[130:131], v[130:131], v[98:99]
  v_pk_add_f32 v[132:133], v[132:133], v[100:101]
  v_pk_add_f32 v[134:135], v[134:135], v[102:103]
  v_pk_add_f32 v[136:137], v[136:137], v[104:105]
  v_pk_add_f32 v[138:139], v[138:139], v[106:107]
  v_pk_add_f32 v[140:141], v[140:141], v[108:109]
  v_pk_add_f32 v[142:143], v[142:143], v[110:111]
  v_mov_b32 v64, 0xc0135761
  v_mov_b32 v66, 0xbdd2d3e8
  v_pk_mul_f32 v[80:81], v[128:129], v[128:129]
  v_pk_mul_f32 v[82:83], v[130:131], v[130:131]
  v_pk_mul_f32 v[84:85], v[132:133], v[132:133]
  v_pk_mul_f32 v[86:87], v[134:135], v[134:135]
  v_pk_mul_f32 v[88:89], v[136:137], v[136:137]
  v_pk_mul_f32 v[90:91], v[138:139], v[138:139]
  v_pk_mul_f32 v[92:93], v[140:141], v[140:141]
  v_pk_mul_f32 v[94:95], v[142:143], v[142:143]
  v_pk_fma_f32 v[80:81], v[80:81], v[66:67], v[64:65] op_sel_hi:[1,0,0]
  v_pk_fma_f32 v[82:83], v[82:83], v[66:67], v[64:65] op_sel_hi:[1,0,0]
  v_pk_fma_f32 v[84:85], v[84:85], v[66:67], v[64:65] op_sel_hi:[1,0,0]
  v_pk_fma_f32 v[86:87], v[86:87], v[66:67], v[64:65] op_sel_hi:[1,0,0]
  v_pk_fma_f32 v[88:89], v[88:89], v[66:67], v[64:65] op_sel_hi:[1,0,0]
  v_pk_fma_f32 v[90:91], v[90:91], v[66:67], v[64:65] op_sel_hi:[1,0,0]
  v_pk_fma_f32 v[92:93], v[92:93], v[66:67], v[64:65] op_sel_hi:[1,0,0]
  v_pk_fma_f32 v[94:95], v[94:95], v[66:67], v[64:65] op_sel_hi:[1,0,0]
  v_pk_mul_f32 v[80:81], v[80:81], v[128:129]
  v_pk_mul_f32 v[82:83], v[82:83], v[130:131]
  v_pk_mul_f32 v[84:85], v[84:85], v[132:133]
  v_pk_mul_f32 v[86:87], v[86:87], v[134:135]
  v_pk_mul_f32 v[88:89], v[88:89], v[136:137]
  v_pk_mul_f32 v[90:91], v[90:91], v[138:139]
  v_pk_mul_f32 v[92:93], v[92:93], v[140:141]
  v_pk_mul_f32 v[94:95], v[94:95], v[142:143]
  v_exp_f32 v80, v80
  v_exp_f32 v81, v81
  v_exp_f32 v82, v82
  v_exp_f32 v83, v83
  v_exp_f32 v84, v84
  v_exp_f32 v85, v85
  v_exp_f32 v86, v86
  v_exp_f32 v87, v87
  v_exp_f32 v88, v88
  v_exp_f32 v89, v89
  v_exp_f32 v90, v90
  v_exp_f32 v91, v91
  v_exp_f32 v92, v92
  v_exp_f32 v93, v93
  v_exp_f32 v94, v94
  v_exp_f32_e64 v95, v95
  v_pk_add_f32 v[80:81], v[80:81], 1.0 op_sel_hi:[1,0]
  v_pk_add_f32 v[82:83], v[82:83], 1.0 op_sel_hi:[1,0]
  v_pk_add_f32 v[84:85], v[84:85], 1.0 op_sel_hi:[1,0]
  v_pk_add_f32 v[86:87], v[86:87], 1.0 op_sel_hi:[1,0]
  v_pk_add_f32 v[88:89], v[88:89], 1.0 op_sel_hi:[1,0]
  v_pk_add_f32 v[90:91], v[90:91], 1.0 op_sel_hi:[1,0]
  v_pk_add_f32 v[92:93], v[92:93], 1.0 op_sel_hi:[1,0]
  v_pk_add_f32 v[94:95], v[94:95], 1.0 op_sel_hi:[1,0]
  v_rcp_f32 v80, v80
  v_rcp_f32 v81, v81
  v_rcp_f32 v82, v82
  v_rcp_f32 v83, v83
  v_rcp_f32 v84, v84
  v_rcp_f32 v85, v85
  v_rcp_f32 v86, v86
  v_rcp_f32 v87, v87
  v_rcp_f32 v88, v88
  v_rcp_f32 v89, v89
  v_rcp_f32 v90, v90
  v_rcp_f32 v91, v91
  v_rcp_f32 v92, v92
  v_rcp_f32 v93, v93
  v_rcp_f32 v94, v94
  v_rcp_f32 v95, v95
  v_pk_mul_f32 v[128:129], v[128:129], v[80:81]
  v_pk_mul_f32 v[130:131], v[130:131], v[82:83]
  v_pk_mul_f32 v[132:133], v[132:133], v[84:85]
  v_pk_mul_f32 v[134:135], v[134:135], v[86:87]
  v_cvt_pk_bf16_f32 v112, v128, v129
  v_cvt_pk_bf16_f32 v113, v130, v131
  v_cvt_pk_bf16_f32 v114, v132, v133
  v_cvt_pk_bf16_f32 v115, v134, v135
  v_or_b32_e64 v112, 1, v112
  buffer_store_dwordx4 v[112:115], v2, s[64:67], s14 offen offset:0 sc1
  v_pk_mul_f32 v[136:137], v[136:137], v[88:89]
  v_pk_mul_f32 v[138:139], v[138:139], v[90:91]
  v_pk_mul_f32 v[140:141], v[140:141], v[92:93]
  v_pk_mul_f32 v[142:143], v[142:143], v[94:95]
  v_cvt_pk_bf16_f32 v116, v136, v137
  v_cvt_pk_bf16_f32 v117, v138, v139
  v_cvt_pk_bf16_f32 v118, v140, v141
  v_cvt_pk_bf16_f32 v119, v142, v143
  v_or_b32 v116, 1, v116
  buffer_store_dwordx4 v[116:119], v2, s[64:67], s14 offen offset:1024 sc1
  s_barrier
  s_add_u32 m0, s11, 0
  s_add_u32 s18, s16, 1048576
  buffer_load_dwordx4 v36, s[52:55], s18 offen lds
  buffer_load_dwordx4 v37, s[52:55], s18 offen offset:1024 lds
  buffer_load_dwordx4 v38, s[52:55], s18 offen offset:2048 lds
  buffer_load_dwordx4 v39, s[52:55], s18 offen offset:3072 lds
  s_add_u32 m0, s11, 4096
  s_add_u32 s18, s16, 1179648
  buffer_load_dwordx4 v36, s[52:55], s18 offen lds
  buffer_load_dwordx4 v37, s[52:55], s18 offen offset:1024 lds
  buffer_load_dwordx4 v38, s[52:55], s18 offen offset:2048 lds
  buffer_load_dwordx4 v39, s[52:55], s18 offen offset:3072 lds
  s_add_u32 m0, s11, 8192
  s_add_u32 s18, s16, 1310720
  buffer_load_dwordx4 v36, s[52:55], s18 offen lds
  buffer_load_dwordx4 v37, s[52:55], s18 offen offset:1024 lds
  buffer_load_dwordx4 v38, s[52:55], s18 offen offset:2048 lds
  buffer_load_dwordx4 v39, s[52:55], s18 offen offset:3072 lds
  s_add_u32 m0, s11, 12288
  s_add_u32 s18, s16, 1441792
  buffer_load_dwordx4 v36, s[52:55], s18 offen lds
  buffer_load_dwordx4 v37, s[52:55], s18 offen offset:1024 lds
  buffer_load_dwordx4 v38, s[52:55], s18 offen offset:2048 lds
  buffer_load_dwordx4 v39, s[52:55], s18 offen offset:3072 lds
L_skipC2_119:
  buffer_load_ushort v42, v43, s[56:59], s85 offen
  s_waitcnt vmcnt(20)
  ds_read_b64_tr_b16 a[192:193], v6 offset:0
  ds_read_b64_tr_b16 a[194:195], v6 offset:1024
  ds_read_b64_tr_b16 a[196:197], v7 offset:0
  ds_read_b64_tr_b16 a[198:199], v7 offset:1024
  ds_read_b64_tr_b16 a[200:201], v6 offset:2048
  ds_read_b64_tr_b16 a[202:203], v6 offset:3072
  ds_read_b64_tr_b16 a[204:205], v7 offset:2048
  ds_read_b64_tr_b16 a[206:207], v7 offset:3072
  ds_read_b64_tr_b16 a[208:209], v6 offset:4096
  ds_read_b64_tr_b16 a[210:211], v6 offset:5120
  ds_read_b64_tr_b16 a[212:213], v7 offset:4096
  ds_read_b64_tr_b16 a[214:215], v7 offset:5120
  ds_read_b64_tr_b16 a[216:217], v6 offset:6144
  ds_read_b64_tr_b16 a[218:219], v6 offset:7168
  ds_read_b64_tr_b16 a[220:221], v7 offset:6144
  ds_read_b64_tr_b16 a[222:223], v7 offset:7168
  ds_read_b64_tr_b16 a[224:225], v6 offset:8192
  ds_read_b64_tr_b16 a[226:227], v6 offset:9216
  ds_read_b64_tr_b16 a[228:229], v7 offset:8192
  ds_read_b64_tr_b16 a[230:231], v7 offset:9216
  ds_read_b64_tr_b16 a[232:233], v6 offset:10240
  ds_read_b64_tr_b16 a[234:235], v6 offset:11264
  ds_read_b64_tr_b16 a[236:237], v7 offset:10240
  ds_read_b64_tr_b16 a[238:239], v7 offset:11264
  ds_read_b64_tr_b16 a[240:241], v6 offset:12288
  ds_read_b64_tr_b16 a[242:243], v6 offset:13312
  ds_read_b64_tr_b16 a[244:245], v7 offset:12288
  ds_read_b64_tr_b16 a[246:247], v7 offset:13312
  ds_read_b64_tr_b16 a[248:249], v6 offset:14336
  ds_read_b64_tr_b16 a[250:251], v6 offset:15360
  ds_read_b64_tr_b16 a[252:253], v7 offset:14336
  ds_read_b64_tr_b16 a[254:255], v7 offset:15360
  buffer_load_dwordx4 v[64:67], v40, s[64:67], s73 offen offset:0 sc1
  buffer_load_dwordx4 v[68:71], v41, s[64:67], s73 offen offset:0 sc1
  buffer_load_dwordx4 v[72:75], v40, s[64:67], s73 offen offset:1024 sc1
  buffer_load_dwordx4 v[76:79], v41, s[64:67], s73 offen offset:1024 sc1
  buffer_load_dwordx4 v[80:83], v40, s[64:67], s73 offen offset:2048 sc1
  buffer_load_dwordx4 v[84:87], v41, s[64:67], s73 offen offset:2048 sc1
  buffer_load_dwordx4 v[88:91], v40, s[64:67], s73 offen offset:3072 sc1
  buffer_load_dwordx4 v[92:95], v41, s[64:67], s73 offen offset:3072 sc1
  buffer_load_dwordx4 v[96:99], v40, s[64:67], s74 offen offset:0 sc1
  buffer_load_dwordx4 v[100:103], v41, s[64:67], s74 offen offset:0 sc1
  buffer_load_dwordx4 v[104:107], v40, s[64:67], s74 offen offset:1024 sc1
  buffer_load_dwordx4 v[108:111], v41, s[64:67], s74 offen offset:1024 sc1
  buffer_load_dwordx4 v[112:115], v40, s[64:67], s74 offen offset:2048 sc1
  buffer_load_dwordx4 v[116:119], v41, s[64:67], s74 offen offset:2048 sc1
  s_waitcnt vmcnt(14)
  v_lshlrev_b32 v128, 16, v42
  v_mov_b32 v129, v128
  v_mov_b32 v130, v128
  v_mov_b32 v131, v128
  v_mov_b32 v132, v128
  v_mov_b32 v133, v128
  v_mov_b32 v134, v128
  v_mov_b32 v135, v128
  v_mov_b32 v136, v128
  v_mov_b32 v137, v128
  v_mov_b32 v138, v128
  v_mov_b32 v139, v128
  v_mov_b32 v140, v128
  v_mov_b32 v141, v128
  v_mov_b32 v142, v128
  v_mov_b32 v143, v128
  s_waitcnt vmcnt(12)
L_Dc_120:
  v_bitop3_b32 v24, v64, v68, 1 bitop3:0x80
  v_cmp_eq_u32 vcc, 0, v24
  s_nop 1
  s_cbranch_vccnz L_Dr_121
L_Dk_122:
  v_mfma_f32_32x32x16_bf16 v[128:143], v[64:67], a[128:131], v[128:143]
  s_lshl_b32 s101, s68, 13
  s_add_u32 m0, s101, 131072
  s_add_u32 s18, s16, 1572864
  buffer_load_dwordx4 v36, s[52:55], s18 offen lds
  v_mfma_f32_32x32x16_bf16 v[144:159], v[64:67], a[132:135], 0
  buffer_load_dwordx4 v[120:123], v40, s[64:67], s74 offen offset:3072 sc1
  buffer_load_dwordx4 v[124:127], v41, s[64:67], s74 offen offset:3072 sc1
  buffer_load_dwordx4 v37, s[52:55], s18 offen offset:1024 lds
  v_mfma_f32_32x32x16_bf16 v[160:175], v[68:71], a[128:131], 0
  buffer_load_dwordx4 v38, s[52:55], s18 offen offset:2048 lds
  v_mfma_f32_32x32x16_bf16 v[176:191], v[68:71], a[132:135], 0
  buffer_load_dwordx4 v39, s[52:55], s18 offen offset:3072 lds
  s_waitcnt vmcnt(16)
L_Dc_123:
  v_bitop3_b32 v24, v72, v76, 1 bitop3:0x80
  v_cmp_eq_u32 vcc, 0, v24
  s_nop 1
  s_cbranch_vccnz L_Dr_124
L_Dk_125:
  v_mfma_f32_32x32x16_bf16 v[128:143], v[72:75], a[136:139], v[128:143]
  s_lshl_b32 s101, s68, 13
  s_add_u32 m0, s101, 135168
  s_add_u32 s18, s16, 1703936
  buffer_load_dwordx4 v36, s[52:55], s18 offen lds
  v_mfma_f32_32x32x16_bf16 v[144:159], v[72:75], a[140:143], v[144:159]
  buffer_load_dwordx4 v[64:67], v40, s[64:67], s75 offen offset:0 sc1
  buffer_load_dwordx4 v[68:71], v41, s[64:67], s75 offen offset:0 sc1
  buffer_load_dwordx4 v37, s[52:55], s18 offen offset:1024 lds
  v_mfma_f32_32x32x16_bf16 v[160:175], v[76:79], a[136:139], v[160:175]
  buffer_load_dwordx4 v38, s[52:55], s18 offen offset:2048 lds
  v_mfma_f32_32x32x16_bf16 v[176:191], v[76:79], a[140:143], v[176:191]
  buffer_load_dwordx4 v39, s[52:55], s18 offen offset:3072 lds
  s_waitcnt vmcnt(20)
L_Dc_126:
  v_bitop3_b32 v24, v80, v84, 1 bitop3:0x80
  v_cmp_eq_u32 vcc, 0, v24
  s_nop 1
  s_cbranch_vccnz L_Dr_127
L_Dk_128:
  v_mfma_f32_32x32x16_bf16 v[128:143], v[80:83], a[144:147], v[128:143]
  v_mfma_f32_32x32x16_bf16 v[144:159], v[80:83], a[148:151], v[144:159]
  buffer_load_dwordx4 v[72:75], v40, s[64:67], s75 offen offset:1024 sc1
  buffer_load_dwordx4 v[76:79], v41, s[64:67], s75 offen offset:1024 sc1
  v_mfma_f32_32x32x16_bf16 v[160:175], v[84:87], a[144:147], v[160:175]
  v_mfma_f32_32x32x16_bf16 v[176:191], v[84:87], a[148:151], v[176:191]
  s_waitcnt vmcnt(20)
L_Dc_129:
  v_bitop3_b32 v24, v88, v92, 1 bitop3:0x80
  v_cmp_eq_u32 vcc, 0, v24
  s_nop 1
  s_cbranch_vccnz L_Dr_130
L_Dk_131:
  v_mfma_f32_32x32x16_bf16 v[128:143], v[88:91], a[152:155], v[128:143]
  v_mfma_f32_32x32x16_bf16 v[144:159], v[88:91], a[156:159], v[144:159]
  buffer_load_dwordx4 v[80:83], v40, s[64:67], s75 offen offset:2048 sc1
  buffer_load_dwordx4 v[84:87], v41, s[64:67], s75 offen offset:2048 sc1
  v_mfma_f32_32x32x16_bf16 v[160:175], v[92:95], a[152:155], v[160:175]
  v_mfma_f32_32x32x16_bf16 v[176:191], v[92:95], a[156:159], v[176:191]
  s_waitcnt vmcnt(20)
L_Dc_132:
  v_bitop3_b32 v24, v96, v100, 1 bitop3:0x80
  v_cmp_eq_u32 vcc, 0, v24
  s_nop 1
  s_cbranch_vccnz L_Dr_133
L_Dk_134:
  v_mfma_f32_32x32x16_bf16 v[128:143], v[96:99], a[160:163], v[128:143]
  v_mfma_f32_32x32x16_bf16 v[144:159], v[96:99], a[164:167], v[144:159]
  buffer_load_dwordx4 v[88:91], v40, s[64:67], s75 offen offset:3072 sc1
  buffer_load_dwordx4 v[92:95], v41, s[64:67], s75 offen offset:3072 sc1
  v_mfma_f32_32x32x16_bf16 v[160:175], v[100:103], a[160:163], v[160:175]
  v_mfma_f32_32x32x16_bf16 v[176:191], v[100:103], a[164:167], v[176:191]
  s_waitcnt lgkmcnt(0)
  s_waitcnt vmcnt(20)
L_Dc_135:
  v_bitop3_b32 v24, v104, v108, 1 bitop3:0x80
  v_cmp_eq_u32 vcc, 0, v24
  s_nop 1
  s_cbranch_vccnz L_Dr_136
L_Dk_137:
  v_mfma_f32_32x32x16_bf16 v[128:143], v[104:107], a[168:171], v[128:143]
  v_mfma_f32_32x32x16_bf16 v[144:159], v[104:107], a[172:175], v[144:159]
  buffer_load_dwordx4 v[96:99], v40, s[64:67], s80 offen offset:0 sc1
  buffer_load_dwordx4 v[100:103], v41, s[64:67], s80 offen offset:0 sc1
  v_mfma_f32_32x32x16_bf16 v[160:175], v[108:111], a[168:171], v[160:175]
  v_mfma_f32_32x32x16_bf16 v[176:191], v[108:111], a[172:175], v[176:191]
  s_waitcnt vmcnt(20)
L_Dc_138:
  v_bitop3_b32 v24, v112, v116, 1 bitop3:0x80
  v_cmp_eq_u32 vcc, 0, v24
  s_nop 1
  s_cbranch_vccnz L_Dr_139
L_Dk_140:
  v_mfma_f32_32x32x16_bf16 v[128:143], v[112:115], a[176:179], v[128:143]
  v_mfma_f32_32x32x16_bf16 v[144:159], v[112:115], a[180:183], v[144:159]
  buffer_load_dwordx4 v[104:107], v40, s[64:67], s80 offen offset:1024 sc1
  buffer_load_dwordx4 v[108:111], v41, s[64:67], s80 offen offset:1024 sc1
  v_mfma_f32_32x32x16_bf16 v[160:175], v[116:119], a[176:179], v[160:175]
  v_mfma_f32_32x32x16_bf16 v[176:191], v[116:119], a[180:183], v[176:191]
  s_waitcnt vmcnt(19)
L_Dc_141:
  v_bitop3_b32 v24, v120, v124, 1 bitop3:0x80
  v_cmp_eq_u32 vcc, 0, v24
  s_nop 1
  s_cbranch_vccnz L_Dr_142
L_Dk_143:
  v_mfma_f32_32x32x16_bf16 v[128:143], v[120:123], a[184:187], v[128:143]
  v_mfma_f32_32x32x16_bf16 v[144:159], v[120:123], a[188:191], v[144:159]
  buffer_load_dwordx4 v[112:115], v40, s[64:67], s80 offen offset:2048 sc1
  buffer_load_dwordx4 v[116:119], v41, s[64:67], s80 offen offset:2048 sc1
  v_mfma_f32_32x32x16_bf16 v[160:175], v[124:127], a[184:187], v[160:175]
  v_mfma_f32_32x32x16_bf16 v[176:191], v[124:127], a[188:191], v[176:191]
  s_waitcnt vmcnt(15)
L_Dc_144:
  v_bitop3_b32 v24, v64, v68, 1 bitop3:0x80
  v_cmp_eq_u32 vcc, 0, v24
  s_nop 1
  s_cbranch_vccnz L_Dr_145
L_Dk_146:
  v_mfma_f32_32x32x16_bf16 v[128:143], v[64:67], a[192:195], v[128:143]
  v_mfma_f32_32x32x16_bf16 v[144:159], v[64:67], a[196:199], v[144:159]
  buffer_load_dwordx4 v[120:123], v40, s[64:67], s80 offen offset:3072 sc1
  buffer_load_dwordx4 v[124:127], v41, s[64:67], s80 offen offset:3072 sc1
  v_mfma_f32_32x32x16_bf16 v[160:175], v[68:71], a[192:195], v[160:175]
  v_mfma_f32_32x32x16_bf16 v[176:191], v[68:71], a[196:199], v[176:191]
  s_waitcnt vmcnt(12)
L_Dc_147:
  v_bitop3_b32 v24, v72, v76, 1 bitop3:0x80
  v_cmp_eq_u32 vcc, 0, v24
  s_nop 1
  s_cbranch_vccnz L_Dr_148
L_Dk_149:
  v_mfma_f32_32x32x16_bf16 v[128:143], v[72:75], a[200:203], v[128:143]
  v_mfma_f32_32x32x16_bf16 v[144:159], v[72:75], a[204:207], v[144:159]
  buffer_load_dwordx4 v[64:67], v40, s[64:67], s82 offen offset:0 sc1
  buffer_load_dwordx4 v[68:71], v41, s[64:67], s82 offen offset:0 sc1
  v_mfma_f32_32x32x16_bf16 v[160:175], v[76:79], a[200:203], v[160:175]
  v_mfma_f32_32x32x16_bf16 v[176:191], v[76:79], a[204:207], v[176:191]
  s_waitcnt vmcnt(12)
L_Dc_150:
  v_bitop3_b32 v24, v80, v84, 1 bitop3:0x80
  v_cmp_eq_u32 vcc, 0, v24
  s_nop 1
  s_cbranch_vccnz L_Dr_151
L_Dk_152:
  v_mfma_f32_32x32x16_bf16 v[128:143], v[80:83], a[208:211], v[128:143]
  v_mfma_f32_32x32x16_bf16 v[144:159], v[80:83], a[212:215], v[144:159]
  buffer_load_dwordx4 v[72:75], v40, s[64:67], s82 offen offset:1024 sc1
  buffer_load_dwordx4 v[76:79], v41, s[64:67], s82 offen offset:1024 sc1
  v_mfma_f32_32x32x16_bf16 v[160:175], v[84:87], a[208:211], v[160:175]
  v_mfma_f32_32x32x16_bf16 v[176:191], v[84:87], a[212:215], v[176:191]
  s_waitcnt vmcnt(12)
L_Dc_153:
  v_bitop3_b32 v24, v88, v92, 1 bitop3:0x80
  v_cmp_eq_u32 vcc, 0, v24
  s_nop 1
  s_cbranch_vccnz L_Dr_154
L_Dk_155:
  v_mfma_f32_32x32x16_bf16 v[128:143], v[88:91], a[216:219], v[128:143]
  v_mfma_f32_32x32x16_bf16 v[144:159], v[88:91], a[220:223], v[144:159]
  buffer_load_dwordx4 v[80:83], v40, s[64:67], s82 offen offset:2048 sc1
  buffer_load_dwordx4 v[84:87], v41, s[64:67], s82 offen offset:2048 sc1
  v_mfma_f32_32x32x16_bf16 v[160:175], v[92:95], a[216:219], v[160:175]
  v_mfma_f32_32x32x16_bf16 v[176:191], v[92:95], a[220:223], v[176:191]
  s_waitcnt vmcnt(12)
L_Dc_156:
  v_bitop3_b32 v24, v96, v100, 1 bitop3:0x80
  v_cmp_eq_u32 vcc, 0, v24
  s_nop 1
  s_cbranch_vccnz L_Dr_157
L_Dk_158:
  v_mfma_f32_32x32x16_bf16 v[128:143], v[96:99], a[224:227], v[128:143]
  ds_read_b64_tr_b16 a[32:33], v4 offset:0
  ds_read_b64_tr_b16 a[34:35], v4 offset:1024
  v_mfma_f32_32x32x16_bf16 v[144:159], v[96:99], a[228:231], v[144:159]
  buffer_load_dwordx4 v[88:91], v40, s[64:67], s82 offen offset:3072 sc1
  buffer_load_dwordx4 v[92:95], v41, s[64:67], s82 offen offset:3072 sc1
  ds_read_b64_tr_b16 a[36:37], v5 offset:0
  ds_read_b64_tr_b16 a[38:39], v5 offset:1024
  v_mfma_f32_32x32x16_bf16 v[160:175], v[100:103], a[224:227], v[160:175]
  ds_read_b64_tr_b16 a[40:41], v4 offset:2048
  ds_read_b64_tr_b16 a[42:43], v4 offset:3072
  v_mfma_f32_32x32x16_bf16 v[176:191], v[100:103], a[228:231], v[176:191]
  ds_read_b64_tr_b16 a[44:45], v5 offset:2048
  ds_read_b64_tr_b16 a[46:47], v5 offset:3072
  s_waitcnt vmcnt(12)
L_Dc_159:
  v_bitop3_b32 v24, v104, v108, 1 bitop3:0x80
  v_cmp_eq_u32 vcc, 0, v24
  s_nop 1
  s_cbranch_vccnz L_Dr_160
L_Dk_161:
  v_mfma_f32_32x32x16_bf16 v[128:143], v[104:107], a[232:235], v[128:143]
  ds_read_b64_tr_b16 a[48:49], v4 offset:4096
  ds_read_b64_tr_b16 a[50:51], v4 offset:5120
  v_mfma_f32_32x32x16_bf16 v[144:159], v[104:107], a[236:239], v[144:159]
  buffer_load_dwordx4 v[96:99], v40, s[64:67], s70 offen offset:0 sc1
  buffer_load_dwordx4 v[100:103], v41, s[64:67], s70 offen offset:0 sc1
  buffer_load_dwordx4 v[16:19], v2, s[64:67], s86 offen offset:0 sc1
  buffer_load_dwordx4 v[20:23], v2, s[64:67], s86 offen offset:1024 sc1
  ds_read_b64_tr_b16 a[52:53], v5 offset:4096
  ds_read_b64_tr_b16 a[54:55], v5 offset:5120
  v_mfma_f32_32x32x16_bf16 v[160:175], v[108:111], a[232:235], v[160:175]
  ds_read_b64_tr_b16 a[56:57], v4 offset:6144
  ds_read_b64_tr_b16 a[58:59], v4 offset:7168
  v_mfma_f32_32x32x16_bf16 v[176:191], v[108:111], a[236:239], v[176:191]
  ds_read_b64_tr_b16 a[60:61], v5 offset:6144
  ds_read_b64_tr_b16 a[62:63], v5 offset:7168
  s_waitcnt vmcnt(14)
L_Dc_162:
  v_bitop3_b32 v24, v112, v116, 1 bitop3:0x80
  v_cmp_eq_u32 vcc, 0, v24
  s_nop 1
  s_cbranch_vccnz L_Dr_163
L_Dk_164:
  v_mfma_f32_32x32x16_bf16 v[128:143], v[112:115], a[240:243], v[128:143]
  ds_read_b64_tr_b16 a[64:65], v4 offset:8192
  ds_read_b64_tr_b16 a[66:67], v4 offset:9216
  v_mfma_f32_32x32x16_bf16 v[144:159], v[112:115], a[244:247], v[144:159]
  buffer_load_dwordx4 v[104:107], v40, s[64:67], s70 offen offset:1024 sc1
  buffer_load_dwordx4 v[108:111], v41, s[64:67], s70 offen offset:1024 sc1
  ds_read_b64_tr_b16 a[68:69], v5 offset:8192
  ds_read_b64_tr_b16 a[70:71], v5 offset:9216
  v_mfma_f32_32x32x16_bf16 v[160:175], v[116:119], a[240:243], v[160:175]
  ds_read_b64_tr_b16 a[72:73], v4 offset:10240
  ds_read_b64_tr_b16 a[74:75], v4 offset:11264
  v_mfma_f32_32x32x16_bf16 v[176:191], v[116:119], a[244:247], v[176:191]
  ds_read_b64_tr_b16 a[76:77], v5 offset:10240
  ds_read_b64_tr_b16 a[78:79], v5 offset:11264
  s_waitcnt vmcnt(14)
L_Dc_165:
  v_bitop3_b32 v24, v120, v124, 1 bitop3:0x80
  v_cmp_eq_u32 vcc, 0, v24
  s_nop 1
  s_cbranch_vccnz L_Dr_166
L_Dk_167:
  v_mfma_f32_32x32x16_bf16 v[128:143], v[120:123], a[248:251], v[128:143]
  ds_read_b64_tr_b16 a[80:81], v4 offset:12288
  ds_read_b64_tr_b16 a[82:83], v4 offset:13312
  v_mfma_f32_32x32x16_bf16 v[144:159], v[120:123], a[252:255], v[144:159]
  buffer_load_dwordx4 v[112:115], v40, s[64:67], s70 offen offset:2048 sc1
  buffer_load_dwordx4 v[116:119], v41, s[64:67], s70 offen offset:2048 sc1
  ds_read_b64_tr_b16 a[84:85], v5 offset:12288
  ds_read_b64_tr_b16 a[86:87], v5 offset:13312
  v_mfma_f32_32x32x16_bf16 v[160:175], v[124:127], a[248:251], v[160:175]
  ds_read_b64_tr_b16 a[88:89], v4 offset:14336
  ds_read_b64_tr_b16 a[90:91], v4 offset:15360
  v_mfma_f32_32x32x16_bf16 v[176:191], v[124:127], a[252:255], v[176:191]
  ds_read_b64_tr_b16 a[92:93], v5 offset:14336
  ds_read_b64_tr_b16 a[94:95], v5 offset:15360
  s_waitcnt lgkmcnt(0)
  s_waitcnt vmcnt(14)
L_Dc_168:
  v_bitop3_b32 v24, v64, v68, 1 bitop3:0x80
  v_cmp_eq_u32 vcc, 0, v24
  s_nop 1
  s_cbranch_vccnz L_Dr_169
L_Dk_170:
  v_mfma_f32_32x32x16_bf16 v[128:143], v[64:67], a[32:35], v[128:143]
  v_mfma_f32_32x32x16_bf16 v[144:159], v[64:67], a[36:39], v[144:159]
  buffer_load_dwordx4 v[120:123], v40, s[64:67], s70 offen offset:3072 sc1
  buffer_load_dwordx4 v[124:127], v41, s[64:67], s70 offen offset:3072 sc1
  v_mfma_f32_32x32x16_bf16 v[160:175], v[68:71], a[32:35], v[160:175]
  v_mfma_f32_32x32x16_bf16 v[176:191], v[68:71], a[36:39], v[176:191]
  s_waitcnt vmcnt(14)
L_Dc_171:
  v_bitop3_b32 v24, v72, v76, 1 bitop3:0x80
  v_cmp_eq_u32 vcc, 0, v24
  s_nop 1
  s_cbranch_vccnz L_Dr_172
L_Dk_173:
  v_mfma_f32_32x32x16_bf16 v[128:143], v[72:75], a[40:43], v[128:143]
  v_mfma_f32_32x32x16_bf16 v[144:159], v[72:75], a[44:47], v[144:159]
  buffer_load_dwordx4 v[64:67], v40, s[64:67], s26 offen offset:0 sc1
  buffer_load_dwordx4 v[68:71], v41, s[64:67], s26 offen offset:0 sc1
  v_mfma_f32_32x32x16_bf16 v[160:175], v[76:79], a[40:43], v[160:175]
  v_mfma_f32_32x32x16_bf16 v[176:191], v[76:79], a[44:47], v[176:191]
  s_waitcnt vmcnt(14)
L_Dc_174:
  v_bitop3_b32 v24, v80, v84, 1 bitop3:0x80
  v_cmp_eq_u32 vcc, 0, v24
  s_nop 1
  s_cbranch_vccnz L_Dr_175
L_Dk_176:
  v_mfma_f32_32x32x16_bf16 v[128:143], v[80:83], a[48:51], v[128:143]
  ds_read_b64_tr_b16 a[0:1], v28 offset:0
  v_mfma_f32_32x32x16_bf16 v[144:159], v[80:83], a[52:55], v[144:159]
  buffer_load_dwordx4 v[72:75], v40, s[64:67], s26 offen offset:1024 sc1
  buffer_load_dwordx4 v[76:79], v41, s[64:67], s26 offen offset:1024 sc1
  ds_read_b64_tr_b16 a[2:3], v28 offset:1024
  v_mfma_f32_32x32x16_bf16 v[160:175], v[84:87], a[48:51], v[160:175]
  ds_read_b64_tr_b16 a[4:5], v29 offset:0
  v_mfma_f32_32x32x16_bf16 v[176:191], v[84:87], a[52:55], v[176:191]
  ds_read_b64_tr_b16 a[6:7], v29 offset:1024
  s_waitcnt vmcnt(14)
L_Dc_177:
  v_bitop3_b32 v24, v88, v92, 1 bitop3:0x80
  v_cmp_eq_u32 vcc, 0, v24
  s_nop 1
  s_cbranch_vccnz L_Dr_178
L_Dk_179:
  v_mfma_f32_32x32x16_bf16 v[128:143], v[88:91], a[56:59], v[128:143]
  ds_read_b64_tr_b16 a[8:9], v28 offset:2048
  v_mfma_f32_32x32x16_bf16 v[144:159], v[88:91], a[60:63], v[144:159]
  buffer_load_dwordx4 v[80:83], v40, s[64:67], s26 offen offset:2048 sc1
  buffer_load_dwordx4 v[84:87], v41, s[64:67], s26 offen offset:2048 sc1
  ds_read_b64_tr_b16 a[10:11], v28 offset:3072
  v_mfma_f32_32x32x16_bf16 v[160:175], v[92:95], a[56:59], v[160:175]
  ds_read_b64_tr_b16 a[12:13], v29 offset:2048
  v_mfma_f32_32x32x16_bf16 v[176:191], v[92:95], a[60:63], v[176:191]
  ds_read_b64_tr_b16 a[14:15], v29 offset:3072
  s_waitcnt vmcnt(14)
L_Dc_180:
  v_bitop3_b32 v24, v96, v100, 1 bitop3:0x80
  v_cmp_eq_u32 vcc, 0, v24
  s_nop 1
  s_cbranch_vccnz L_Dr_181
L_Dk_182:
  v_mfma_f32_32x32x16_bf16 v[128:143], v[96:99], a[64:67], v[128:143]
  ds_read_b64_tr_b16 a[16:17], v28 offset:4096
  v_mfma_f32_32x32x16_bf16 v[144:159], v[96:99], a[68:71], v[144:159]
  buffer_load_dwordx4 v[88:91], v40, s[64:67], s26 offen offset:3072 sc1
  buffer_load_dwordx4 v[92:95], v41, s[64:67], s26 offen offset:3072 sc1
  ds_read_b64_tr_b16 a[18:19], v28 offset:5120
  v_mfma_f32_32x32x16_bf16 v[160:175], v[100:103], a[64:67], v[160:175]
  ds_read_b64_tr_b16 a[20:21], v29 offset:4096
  v_mfma_f32_32x32x16_bf16 v[176:191], v[100:103], a[68:71], v[176:191]
  ds_read_b64_tr_b16 a[22:23], v29 offset:5120
  s_waitcnt vmcnt(12)
L_Dc_183:
  v_bitop3_b32 v24, v104, v108, 1 bitop3:0x80
  v_cmp_eq_u32 vcc, 0, v24
  s_nop 1
  s_cbranch_vccnz L_Dr_184
L_Dk_185:
  v_mfma_f32_32x32x16_bf16 v[128:143], v[104:107], a[72:75], v[128:143]
  ds_read_b64_tr_b16 a[24:25], v28 offset:6144
  v_mfma_f32_32x32x16_bf16 v[144:159], v[104:107], a[76:79], v[144:159]
  ds_read_b64_tr_b16 a[26:27], v28 offset:7168
  v_mfma_f32_32x32x16_bf16 v[160:175], v[108:111], a[72:75], v[160:175]
  ds_read_b64_tr_b16 a[28:29], v29 offset:6144
  v_mfma_f32_32x32x16_bf16 v[176:191], v[108:111], a[76:79], v[176:191]
  ds_read_b64_tr_b16 a[30:31], v29 offset:7168
  s_waitcnt vmcnt(10)
L_Dc_186:
  v_bitop3_b32 v24, v112, v116, 1 bitop3:0x80
  v_cmp_eq_u32 vcc, 0, v24
  s_nop 1
  s_cbranch_vccnz L_Dr_187
L_Dk_188:
  v_mfma_f32_32x32x16_bf16 v[128:143], v[112:115], a[80:83], v[128:143]
  v_lshlrev_b32 v48, 16, v16
  v_and_b32 v49, 0xffff0000, v16
  v_mfma_f32_32x32x16_bf16 v[144:159], v[112:115], a[84:87], v[144:159]
  v_lshlrev_b32 v50, 16, v17
  v_and_b32 v51, 0xffff0000, v17
  v_mfma_f32_32x32x16_bf16 v[160:175], v[116:119], a[80:83], v[160:175]
  v_lshlrev_b32 v52, 16, v18
  v_and_b32 v53, 0xffff0000, v18
  v_mfma_f32_32x32x16_bf16 v[176:191], v[116:119], a[84:87], v[176:191]
  v_lshlrev_b32 v54, 16, v19
  v_and_b32 v55, 0xffff0000, v19
  s_waitcnt vmcnt(8)
L_Dc_189:
  v_bitop3_b32 v24, v120, v124, 1 bitop3:0x80
  v_cmp_eq_u32 vcc, 0, v24
  s_nop 1
  s_cbranch_vccnz L_Dr_190
L_Dk_191:
  v_mfma_f32_32x32x16_bf16 v[128:143], v[120:123], a[88:91], v[128:143]
  v_lshlrev_b32 v56, 16, v20
  v_and_b32 v57, 0xffff0000, v20
  v_mfma_f32_32x32x16_bf16 v[144:159], v[120:123], a[92:95], v[144:159]
  v_lshlrev_b32 v58, 16, v21
  v_and_b32 v59, 0xffff0000, v21
  v_mfma_f32_32x32x16_bf16 v[160:175], v[124:127], a[88:91], v[160:175]
  v_lshlrev_b32 v60, 16, v22
  v_and_b32 v61, 0xffff0000, v22
  v_mfma_f32_32x32x16_bf16 v[176:191], v[124:127], a[92:95], v[176:191]
  v_lshlrev_b32 v62, 16, v23
  v_and_b32 v63, 0xffff0000, v23
  s_waitcnt vmcnt(6)
L_Dc_192:
  v_bitop3_b32 v24, v64, v68, 1 bitop3:0x80
  v_cmp_eq_u32 vcc, 0, v24
  s_nop 1
  s_cbranch_vccnz L_Dr_193
L_Dk_194:
  s_waitcnt vmcnt(4)
L_Dc_195:
  v_bitop3_b32 v24, v72, v76, 1 bitop3:0x80
  v_cmp_eq_u32 vcc, 0, v24
  s_nop 1
  s_cbranch_vccnz L_Dr_196
L_Dk_197:
  s_waitcnt vmcnt(2)
L_Dc_198:
  v_bitop3_b32 v24, v80, v84, 1 bitop3:0x80
  v_cmp_eq_u32 vcc, 0, v24
  s_nop 1
  s_cbranch_vccnz L_Dr_199
L_Dk_200:
  s_waitcnt vmcnt(0)
L_Dc_201:
  v_bitop3_b32 v24, v88, v92, 1 bitop3:0x80
  v_cmp_eq_u32 vcc, 0, v24
  s_nop 1
  s_cbranch_vccnz L_Dr_202
L_Dk_203:
  s_waitcnt lgkmcnt(0)
  v_mfma_f32_32x32x16_bf16 v[144:159], v[64:67], a[4:7], v[144:159]
  v_mfma_f32_32x32x16_bf16 v[144:159], v[72:75], a[12:15], v[144:159]
  v_mfma_f32_32x32x16_bf16 v[144:159], v[80:83], a[20:23], v[144:159]
  v_mfma_f32_32x32x16_bf16 v[144:159], v[88:91], a[28:31], v[144:159]
  v_mfma_f32_32x32x16_bf16 v[160:175], v[68:71], a[0:3], v[160:175]
  v_mfma_f32_32x32x16_bf16 v[160:175], v[76:79], a[8:11], v[160:175]
  ds_write_b128 v12, v[144:147] offset:4096
  ds_write_b128 v12, v[148:151] offset:5120
  v_mfma_f32_32x32x16_bf16 v[160:175], v[84:87], a[16:19], v[160:175]
  ds_write_b128 v12, v[152:155] offset:6144
  ds_write_b128 v12, v[156:159] offset:7168
  v_mfma_f32_32x32x16_bf16 v[160:175], v[92:95], a[24:27], v[160:175]
  v_mfma_f32_32x32x16_bf16 v[176:191], v[68:71], a[4:7], v[176:191]
  v_mfma_f32_32x32x16_bf16 v[176:191], v[76:79], a[12:15], v[176:191]
  ds_write_b128 v12, v[160:163] offset:8192
  ds_write_b128 v12, v[164:167] offset:9216
  v_mfma_f32_32x32x16_bf16 v[176:191], v[84:87], a[20:23], v[176:191]
  ds_write_b128 v12, v[168:171] offset:10240
  ds_write_b128 v12, v[172:175] offset:11264
  v_mfma_f32_32x32x16_bf16 v[176:191], v[92:95], a[28:31], v[176:191]
  v_mfma_f32_32x32x16_bf16 v[128:143], v[64:67], a[0:3], v[128:143]
  v_mfma_f32_32x32x16_bf16 v[128:143], v[72:75], a[8:11], v[128:143]
  ds_write_b128 v12, v[176:179] offset:12288
  ds_write_b128 v12, v[180:183] offset:13312
  v_mfma_f32_32x32x16_bf16 v[128:143], v[80:83], a[16:19], v[128:143]
  ds_write_b128 v12, v[184:187] offset:14336
  ds_write_b128 v12, v[188:191] offset:15360
  v_mfma_f32_32x32x16_bf16 v[128:143], v[88:91], a[24:27], v[128:143]
  v_xor_b32 v113, 16384, v12
  v_xor_b32 v114, 32768, v12
  v_xor_b32 v115, 49152, v12
  s_waitcnt lgkmcnt(0)
  s_barrier
  ds_read_b128 v[64:67], v113 offset:4096
  ds_read_b128 v[68:71], v113 offset:5120
  ds_read_b128 v[72:75], v113 offset:6144
  ds_read_b128 v[76:79], v113 offset:7168
  ds_read_b128 v[80:83], v114 offset:8192
  ds_read_b128 v[84:87], v114 offset:9216
  ds_read_b128 v[88:91], v114 offset:10240
  ds_read_b128 v[92:95], v114 offset:11264
  ds_read_b128 v[96:99], v115 offset:12288
  ds_read_b128 v[100:103], v115 offset:13312
  ds_read_b128 v[104:107], v115 offset:14336
  ds_read_b128 v[108:111], v115 offset:15360
  v_pk_add_f32 v[128:129], v[128:129], v[48:49]
  v_pk_add_f32 v[130:131], v[130:131], v[50:51]
  v_pk_add_f32 v[132:133], v[132:133], v[52:53]
  v_pk_add_f32 v[134:135], v[134:135], v[54:55]
  v_pk_add_f32 v[136:137], v[136:137], v[56:57]
  v_pk_add_f32 v[138:139], v[138:139], v[58:59]
  v_pk_add_f32 v[140:141], v[140:141], v[60:61]
  v_pk_add_f32 v[142:143], v[142:143], v[62:63]
  s_waitcnt lgkmcnt(8)
  v_pk_add_f32 v[128:129], v[128:129], v[64:65]
  v_pk_add_f32 v[130:131], v[130:131], v[66:67]
  v_pk_add_f32 v[132:133], v[132:133], v[68:69]
  v_pk_add_f32 v[134:135], v[134:135], v[70:71]
  v_pk_add_f32 v[136:137], v[136:137], v[72:73]
  v_pk_add_f32 v[138:139], v[138:139], v[74:75]
  v_pk_add_f32 v[140:141], v[140:141], v[76:77]
  v_pk_add_f32 v[142:143], v[142:143], v[78:79]
  s_waitcnt lgkmcnt(4)
  v_pk_add_f32 v[128:129], v[128:129], v[80:81]
  v_pk_add_f32 v[130:131], v[130:131], v[82:83]
  v_pk_add_f32 v[132:133], v[132:133], v[84:85]
  v_pk_add_f32 v[134:135], v[134:135], v[86:87]
  v_pk_add_f32 v[136:137], v[136:137], v[88:89]
  v_pk_add_f32 v[138:139], v[138:139], v[90:91]
  v_pk_add_f32 v[140:141], v[140:141], v[92:93]
  v_pk_add_f32 v[142:143], v[142:143], v[94:95]
  s_waitcnt lgkmcnt(0)
  v_pk_add_f32 v[128:129], v[128:129], v[96:97]
  v_pk_add_f32 v[130:131], v[130:131], v[98:99]
  v_pk_add_f32 v[132:133], v[132:133], v[100:101]
  v_pk_add_f32 v[134:135], v[134:135], v[102:103]
  v_pk_add_f32 v[136:137], v[136:137], v[104:105]
  v_pk_add_f32 v[138:139], v[138:139], v[106:107]
  v_pk_add_f32 v[140:141], v[140:141], v[108:109]
  v_pk_add_f32 v[142:143], v[142:143], v[110:111]
  v_cvt_pk_bf16_f32 v112, v128, v129
  v_cvt_pk_bf16_f32 v113, v130, v131
  v_cvt_pk_bf16_f32 v114, v132, v133
  v_cvt_pk_bf16_f32 v115, v134, v135
  s_nop 0
  v_permlane32_swap_b32 v112, v114
  v_permlane32_swap_b32 v113, v115
  buffer_store_dwordx4 v[112:115], v13, s[60:63], s84 offen offset:0
  v_cvt_pk_bf16_f32 v116, v136, v137
  v_cvt_pk_bf16_f32 v117, v138, v139
  v_cvt_pk_bf16_f32 v118, v140, v141
  v_cvt_pk_bf16_f32 v119, v142, v143
  s_nop 0
  v_permlane32_swap_b32 v116, v118
  v_permlane32_swap_b32 v117, v119
  buffer_store_dwordx4 v[116:119], v13, s[60:63], s84 offen offset:32
L_end:
  s_endpgm
L_redretry_12:
  s_sub_u32 s10, s10, 1
  s_cselect_b32 s10, 0, s10
  s_cbranch_scc1 L_redok_13
  buffer_load_dwordx4 v[192:195], v226, s[64:67], s17 offen offset:0 sc1
  buffer_load_dwordx4 v[196:199], v226, s[64:67], s17 offen offset:1024 sc1
  buffer_load_dwordx4 v[200:203], v227, s[64:67], s17 offen sc1
  s_waitcnt vmcnt(0)
  s_branch L_red_11
L_retryf1_16:
  s_sub_u32 s10, s10, 1
  s_cselect_b32 s10, 0, s10
  s_cbranch_scc1 L_donef1_17
  buffer_load_dword v71, v2, s[64:67], s87 offen sc1
  s_waitcnt vmcnt(0)
  s_branch L_pollf1_15
L_stretry_20:
  s_sub_u32 s10, s10, 1
  s_cselect_b32 s10, 0, s10
  s_cbranch_scc1 L_stok_21
  buffer_load_dwordx4 v[76:79], v13, s[64:67], s90 offen sc1
  buffer_load_dwordx4 v[80:83], v13, s[64:67], s90 offen offset:512 sc1
  s_waitcnt vmcnt(0)
  s_branch L_st_19
L_Cr_24:
  s_sub_u32 s10, s10, 1
  s_cselect_b32 s10, 0, s10
  s_cbranch_scc1 L_Cg_204
  buffer_load_dwordx4 v[64:67], v26, s[64:67], s92 offen offset:0 sc1
  buffer_load_dwordx4 v[68:71], v27, s[64:67], s92 offen offset:0 sc1
  s_waitcnt vmcnt(0)
  v_bitop3_b32 v24, v64, v68, 1 bitop3:0x80
  v_cmp_eq_u32 vcc, 0, v24
  s_nop 1
  s_cbranch_vccnz L_Cr_24
L_Cg_204:
  buffer_load_dwordx4 v[72:75], v26, s[64:67], s92 offen offset:1024 sc1
  buffer_load_dwordx4 v[76:79], v27, s[64:67], s92 offen offset:1024 sc1
  buffer_load_dwordx4 v[80:83], v30, s[64:67], s92 offen offset:0 sc1
  buffer_load_dwordx4 v[84:87], v31, s[64:67], s92 offen offset:0 sc1
  buffer_load_dwordx4 v[88:91], v30, s[64:67], s92 offen offset:1024 sc1
  buffer_load_dwordx4 v[92:95], v31, s[64:67], s92 offen offset:1024 sc1
  buffer_load_dwordx4 v[96:99], v26, s[64:67], s93 offen offset:0 sc1
  buffer_load_dwordx4 v[100:103], v27, s[64:67], s93 offen offset:0 sc1
  buffer_load_dwordx4 v[104:107], v26, s[64:67], s93 offen offset:1024 sc1
  buffer_load_dwordx4 v[108:111], v27, s[64:67], s93 offen offset:1024 sc1
  buffer_load_dwordx4 v[112:115], v30, s[64:67], s93 offen offset:0 sc1
  buffer_load_dwordx4 v[116:119], v31, s[64:67], s93 offen offset:0 sc1
  s_branch L_Ck_25
L_Cr_27:
  s_sub_u32 s10, s10, 1
  s_cselect_b32 s10, 0, s10
  s_cbranch_scc1 L_Cg_205
  buffer_load_dwordx4 v[72:75], v26, s[64:67], s92 offen offset:1024 sc1
  buffer_load_dwordx4 v[76:79], v27, s[64:67], s92 offen offset:1024 sc1
  s_waitcnt vmcnt(0)
  v_bitop3_b32 v24, v72, v76, 1 bitop3:0x80
  v_cmp_eq_u32 vcc, 0, v24
  s_nop 1
  s_cbranch_vccnz L_Cr_27
L_Cg_205:
  buffer_load_dwordx4 v[80:83], v30, s[64:67], s92 offen offset:0 sc1
  buffer_load_dwordx4 v[84:87], v31, s[64:67], s92 offen offset:0 sc1
  buffer_load_dwordx4 v[88:91], v30, s[64:67], s92 offen offset:1024 sc1
  buffer_load_dwordx4 v[92:95], v31, s[64:67], s92 offen offset:1024 sc1
  buffer_load_dwordx4 v[96:99], v26, s[64:67], s93 offen offset:0 sc1
  buffer_load_dwordx4 v[100:103], v27, s[64:67], s93 offen offset:0 sc1
  buffer_load_dwordx4 v[104:107], v26, s[64:67], s93 offen offset:1024 sc1
  buffer_load_dwordx4 v[108:111], v27, s[64:67], s93 offen offset:1024 sc1
  buffer_load_dwordx4 v[112:115], v30, s[64:67], s93 offen offset:0 sc1
  buffer_load_dwordx4 v[116:119], v31, s[64:67], s93 offen offset:0 sc1
  buffer_load_dwordx4 v[120:123], v30, s[64:67], s93 offen offset:1024 sc1
  buffer_load_dwordx4 v[124:127], v31, s[64:67], s93 offen offset:1024 sc1
  s_branch L_Ck_28
L_Cr_30:
  s_sub_u32 s10, s10, 1
  s_cselect_b32 s10, 0, s10
  s_cbranch_scc1 L_Cg_206
  buffer_load_dwordx4 v[80:83], v30, s[64:67], s92 offen offset:0 sc1
  buffer_load_dwordx4 v[84:87], v31, s[64:67], s92 offen offset:0 sc1
  s_waitcnt vmcnt(0)
  v_bitop3_b32 v24, v80, v84, 1 bitop3:0x80
  v_cmp_eq_u32 vcc, 0, v24
  s_nop 1
  s_cbranch_vccnz L_Cr_30
L_Cg_206:
  buffer_load_dwordx4 v[88:91], v30, s[64:67], s92 offen offset:1024 sc1
  buffer_load_dwordx4 v[92:95], v31, s[64:67], s92 offen offset:1024 sc1
  buffer_load_dwordx4 v[96:99], v26, s[64:67], s93 offen offset:0 sc1
  buffer_load_dwordx4 v[100:103], v27, s[64:67], s93 offen offset:0 sc1
  buffer_load_dwordx4 v[104:107], v26, s[64:67], s93 offen offset:1024 sc1
  buffer_load_dwordx4 v[108:111], v27, s[64:67], s93 offen offset:1024 sc1
  buffer_load_dwordx4 v[112:115], v30, s[64:67], s93 offen offset:0 sc1
  buffer_load_dwordx4 v[116:119], v31, s[64:67], s93 offen offset:0 sc1
  buffer_load_dwordx4 v[120:123], v30, s[64:67], s93 offen offset:1024 sc1
  buffer_load_dwordx4 v[124:127], v31, s[64:67], s93 offen offset:1024 sc1
  buffer_load_dwordx4 v[64:67], v26, s[64:67], s94 offen offset:0 sc1
  buffer_load_dwordx4 v[68:71], v27, s[64:67], s94 offen offset:0 sc1
  s_branch L_Ck_31
L_Cr_33:
  s_sub_u32 s10, s10, 1
  s_cselect_b32 s10, 0, s10
  s_cbranch_scc1 L_Cg_207
  buffer_load_dwordx4 v[88:91], v30, s[64:67], s92 offen offset:1024 sc1
  buffer_load_dwordx4 v[92:95], v31, s[64:67], s92 offen offset:1024 sc1
  s_waitcnt vmcnt(0)
  v_bitop3_b32 v24, v88, v92, 1 bitop3:0x80
  v_cmp_eq_u32 vcc, 0, v24
  s_nop 1
  s_cbranch_vccnz L_Cr_33
L_Cg_207:
  buffer_load_dwordx4 v[96:99], v26, s[64:67], s93 offen offset:0 sc1
  buffer_load_dwordx4 v[100:103], v27, s[64:67], s93 offen offset:0 sc1
  buffer_load_dwordx4 v[104:107], v26, s[64:67], s93 offen offset:1024 sc1
  buffer_load_dwordx4 v[108:111], v27, s[64:67], s93 offen offset:1024 sc1
  buffer_load_dwordx4 v[112:115], v30, s[64:67], s93 offen offset:0 sc1
  buffer_load_dwordx4 v[116:119], v31, s[64:67], s93 offen offset:0 sc1
  buffer_load_dwordx4 v[120:123], v30, s[64:67], s93 offen offset:1024 sc1
  buffer_load_dwordx4 v[124:127], v31, s[64:67], s93 offen offset:1024 sc1
  buffer_load_dwordx4 v[64:67], v26, s[64:67], s94 offen offset:0 sc1
  buffer_load_dwordx4 v[68:71], v27, s[64:67], s94 offen offset:0 sc1
  buffer_load_dwordx4 v[72:75], v26, s[64:67], s94 offen offset:1024 sc1
  buffer_load_dwordx4 v[76:79], v27, s[64:67], s94 offen offset:1024 sc1
  s_branch L_Ck_34
L_Cr_36:
  s_sub_u32 s10, s10, 1
  s_cselect_b32 s10, 0, s10
  s_cbranch_scc1 L_Cg_208
  buffer_load_dwordx4 v[96:99], v26, s[64:67], s93 offen offset:0 sc1
  buffer_load_dwordx4 v[100:103], v27, s[64:67], s93 offen offset:0 sc1
  s_waitcnt vmcnt(0)
  v_bitop3_b32 v24, v96, v100, 1 bitop3:0x80
  v_cmp_eq_u32 vcc, 0, v24
  s_nop 1
  s_cbranch_vccnz L_Cr_36
L_Cg_208:
  buffer_load_dwordx4 v[104:107], v26, s[64:67], s93 offen offset:1024 sc1
  buffer_load_dwordx4 v[108:111], v27, s[64:67], s93 offen offset:1024 sc1
  buffer_load_dwordx4 v[112:115], v30, s[64:67], s93 offen offset:0 sc1
  buffer_load_dwordx4 v[116:119], v31, s[64:67], s93 offen offset:0 sc1
  buffer_load_dwordx4 v[120:123], v30, s[64:67], s93 offen offset:1024 sc1
  buffer_load_dwordx4 v[124:127], v31, s[64:67], s93 offen offset:1024 sc1
  buffer_load_dwordx4 v[64:67], v26, s[64:67], s94 offen offset:0 sc1
  buffer_load_dwordx4 v[68:71], v27, s[64:67], s94 offen offset:0 sc1
  buffer_load_dwordx4 v[72:75], v26, s[64:67], s94 offen offset:1024 sc1
  buffer_load_dwordx4 v[76:79], v27, s[64:67], s94 offen offset:1024 sc1
  buffer_load_dwordx4 v[80:83], v30, s[64:67], s94 offen offset:0 sc1
  buffer_load_dwordx4 v[84:87], v31, s[64:67], s94 offen offset:0 sc1
  s_branch L_Ck_37
L_Cr_39:
  s_sub_u32 s10, s10, 1
  s_cselect_b32 s10, 0, s10
  s_cbranch_scc1 L_Cg_209
  buffer_load_dwordx4 v[104:107], v26, s[64:67], s93 offen offset:1024 sc1
  buffer_load_dwordx4 v[108:111], v27, s[64:67], s93 offen offset:1024 sc1
  s_waitcnt vmcnt(0)
  v_bitop3_b32 v24, v104, v108, 1 bitop3:0x80
  v_cmp_eq_u32 vcc, 0, v24
  s_nop 1
  s_cbranch_vccnz L_Cr_39
L_Cg_209:
  buffer_load_dwordx4 v[112:115], v30, s[64:67], s93 offen offset:0 sc1
  buffer_load_dwordx4 v[116:119], v31, s[64:67], s93 offen offset:0 sc1
  buffer_load_dwordx4 v[120:123], v30, s[64:67], s93 offen offset:1024 sc1
  buffer_load_dwordx4 v[124:127], v31, s[64:67], s93 offen offset:1024 sc1
  buffer_load_dwordx4 v[64:67], v26, s[64:67], s94 offen offset:0 sc1
  buffer_load_dwordx4 v[68:71], v27, s[64:67], s94 offen offset:0 sc1
  buffer_load_dwordx4 v[72:75], v26, s[64:67], s94 offen offset:1024 sc1
  buffer_load_dwordx4 v[76:79], v27, s[64:67], s94 offen offset:1024 sc1
  buffer_load_dwordx4 v[80:83], v30, s[64:67], s94 offen offset:0 sc1
  buffer_load_dwordx4 v[84:87], v31, s[64:67], s94 offen offset:0 sc1
  buffer_load_dwordx4 v[88:91], v30, s[64:67], s94 offen offset:1024 sc1
  buffer_load_dwordx4 v[92:95], v31, s[64:67], s94 offen offset:1024 sc1
  s_branch L_Ck_40
L_Cr_42:
  s_sub_u32 s10, s10, 1
  s_cselect_b32 s10, 0, s10
  s_cbranch_scc1 L_Cg_210
  buffer_load_dwordx4 v[112:115], v30, s[64:67], s93 offen offset:0 sc1
  buffer_load_dwordx4 v[116:119], v31, s[64:67], s93 offen offset:0 sc1
  s_waitcnt vmcnt(0)
  v_bitop3_b32 v24, v112, v116, 1 bitop3:0x80
  v_cmp_eq_u32 vcc, 0, v24
  s_nop 1
  s_cbranch_vccnz L_Cr_42
L_Cg_210:
  buffer_load_dwordx4 v[120:123], v30, s[64:67], s93 offen offset:1024 sc1
  buffer_load_dwordx4 v[124:127], v31, s[64:67], s93 offen offset:1024 sc1
  buffer_load_dwordx4 v[64:67], v26, s[64:67], s94 offen offset:0 sc1
  buffer_load_dwordx4 v[68:71], v27, s[64:67], s94 offen offset:0 sc1
  buffer_load_dwordx4 v[72:75], v26, s[64:67], s94 offen offset:1024 sc1
  buffer_load_dwordx4 v[76:79], v27, s[64:67], s94 offen offset:1024 sc1
  buffer_load_dwordx4 v[80:83], v30, s[64:67], s94 offen offset:0 sc1
  buffer_load_dwordx4 v[84:87], v31, s[64:67], s94 offen offset:0 sc1
  buffer_load_dwordx4 v[88:91], v30, s[64:67], s94 offen offset:1024 sc1
  buffer_load_dwordx4 v[92:95], v31, s[64:67], s94 offen offset:1024 sc1
  buffer_load_dwordx4 v[96:99], v26, s[64:67], s95 offen offset:0 sc1
  buffer_load_dwordx4 v[100:103], v27, s[64:67], s95 offen offset:0 sc1
  s_branch L_Ck_43
L_Cr_45:
  s_sub_u32 s10, s10, 1
  s_cselect_b32 s10, 0, s10
  s_cbranch_scc1 L_Cg_211
  buffer_load_dwordx4 v[120:123], v30, s[64:67], s93 offen offset:1024 sc1
  buffer_load_dwordx4 v[124:127], v31, s[64:67], s93 offen offset:1024 sc1
  s_waitcnt vmcnt(0)
  v_bitop3_b32 v24, v120, v124, 1 bitop3:0x80
  v_cmp_eq_u32 vcc, 0, v24
  s_nop 1
  s_cbranch_vccnz L_Cr_45
L_Cg_211:
  buffer_load_dwordx4 v[64:67], v26, s[64:67], s94 offen offset:0 sc1
  buffer_load_dwordx4 v[68:71], v27, s[64:67], s94 offen offset:0 sc1
  buffer_load_dwordx4 v[72:75], v26, s[64:67], s94 offen offset:1024 sc1
  buffer_load_dwordx4 v[76:79], v27, s[64:67], s94 offen offset:1024 sc1
  buffer_load_dwordx4 v[80:83], v30, s[64:67], s94 offen offset:0 sc1
  buffer_load_dwordx4 v[84:87], v31, s[64:67], s94 offen offset:0 sc1
  buffer_load_dwordx4 v[88:91], v30, s[64:67], s94 offen offset:1024 sc1
  buffer_load_dwordx4 v[92:95], v31, s[64:67], s94 offen offset:1024 sc1
  buffer_load_dwordx4 v[96:99], v26, s[64:67], s95 offen offset:0 sc1
  buffer_load_dwordx4 v[100:103], v27, s[64:67], s95 offen offset:0 sc1
  buffer_load_dwordx4 v[104:107], v26, s[64:67], s95 offen offset:1024 sc1
  buffer_load_dwordx4 v[108:111], v27, s[64:67], s95 offen offset:1024 sc1
  s_branch L_Ck_46
L_Cr_48:
  s_sub_u32 s10, s10, 1
  s_cselect_b32 s10, 0, s10
  s_cbranch_scc1 L_Cg_212
  buffer_load_dwordx4 v[64:67], v26, s[64:67], s94 offen offset:0 sc1
  buffer_load_dwordx4 v[68:71], v27, s[64:67], s94 offen offset:0 sc1
  s_waitcnt vmcnt(0)
  v_bitop3_b32 v24, v64, v68, 1 bitop3:0x80
  v_cmp_eq_u32 vcc, 0, v24
  s_nop 1
  s_cbranch_vccnz L_Cr_48
L_Cg_212:
  buffer_load_dwordx4 v[72:75], v26, s[64:67], s94 offen offset:1024 sc1
  buffer_load_dwordx4 v[76:79], v27, s[64:67], s94 offen offset:1024 sc1
  buffer_load_dwordx4 v[80:83], v30, s[64:67], s94 offen offset:0 sc1
  buffer_load_dwordx4 v[84:87], v31, s[64:67], s94 offen offset:0 sc1
  buffer_load_dwordx4 v[88:91], v30, s[64:67], s94 offen offset:1024 sc1
  buffer_load_dwordx4 v[92:95], v31, s[64:67], s94 offen offset:1024 sc1
  buffer_load_dwordx4 v[96:99], v26, s[64:67], s95 offen offset:0 sc1
  buffer_load_dwordx4 v[100:103], v27, s[64:67], s95 offen offset:0 sc1
  buffer_load_dwordx4 v[104:107], v26, s[64:67], s95 offen offset:1024 sc1
  buffer_load_dwordx4 v[108:111], v27, s[64:67], s95 offen offset:1024 sc1
  buffer_load_dwordx4 v[112:115], v30, s[64:67], s95 offen offset:0 sc1
  buffer_load_dwordx4 v[116:119], v31, s[64:67], s95 offen offset:0 sc1
  s_branch L_Ck_49
L_Cr_51:
  s_sub_u32 s10, s10, 1
  s_cselect_b32 s10, 0, s10
  s_cbranch_scc1 L_Cg_213
  buffer_load_dwordx4 v[72:75], v26, s[64:67], s94 offen offset:1024 sc1
  buffer_load_dwordx4 v[76:79], v27, s[64:67], s94 offen offset:1024 sc1
  s_waitcnt vmcnt(0)
  v_bitop3_b32 v24, v72, v76, 1 bitop3:0x80
  v_cmp_eq_u32 vcc, 0, v24
  s_nop 1
  s_cbranch_vccnz L_Cr_51
L_Cg_213:
  buffer_load_dwordx4 v[80:83], v30, s[64:67], s94 offen offset:0 sc1
  buffer_load_dwordx4 v[84:87], v31, s[64:67], s94 offen offset:0 sc1
  buffer_load_dwordx4 v[88:91], v30, s[64:67], s94 offen offset:1024 sc1
  buffer_load_dwordx4 v[92:95], v31, s[64:67], s94 offen offset:1024 sc1
  buffer_load_dwordx4 v[96:99], v26, s[64:67], s95 offen offset:0 sc1
  buffer_load_dwordx4 v[100:103], v27, s[64:67], s95 offen offset:0 sc1
  buffer_load_dwordx4 v[104:107], v26, s[64:67], s95 offen offset:1024 sc1
  buffer_load_dwordx4 v[108:111], v27, s[64:67], s95 offen offset:1024 sc1
  buffer_load_dwordx4 v[112:115], v30, s[64:67], s95 offen offset:0 sc1
  buffer_load_dwordx4 v[116:119], v31, s[64:67], s95 offen offset:0 sc1
  buffer_load_dwordx4 v[120:123], v30, s[64:67], s95 offen offset:1024 sc1
  buffer_load_dwordx4 v[124:127], v31, s[64:67], s95 offen offset:1024 sc1
  s_branch L_Ck_52
L_Cr_54:
  s_sub_u32 s10, s10, 1
  s_cselect_b32 s10, 0, s10
  s_cbranch_scc1 L_Cg_214
  buffer_load_dwordx4 v[80:83], v30, s[64:67], s94 offen offset:0 sc1
  buffer_load_dwordx4 v[84:87], v31, s[64:67], s94 offen offset:0 sc1
  s_waitcnt vmcnt(0)
  v_bitop3_b32 v24, v80, v84, 1 bitop3:0x80
  v_cmp_eq_u32 vcc, 0, v24
  s_nop 1
  s_cbranch_vccnz L_Cr_54
L_Cg_214:
  buffer_load_dwordx4 v[88:91], v30, s[64:67], s94 offen offset:1024 sc1
  buffer_load_dwordx4 v[92:95], v31, s[64:67], s94 offen offset:1024 sc1
  buffer_load_dwordx4 v[96:99], v26, s[64:67], s95 offen offset:0 sc1
  buffer_load_dwordx4 v[100:103], v27, s[64:67], s95 offen offset:0 sc1
  buffer_load_dwordx4 v[104:107], v26, s[64:67], s95 offen offset:1024 sc1
  buffer_load_dwordx4 v[108:111], v27, s[64:67], s95 offen offset:1024 sc1
  buffer_load_dwordx4 v[112:115], v30, s[64:67], s95 offen offset:0 sc1
  buffer_load_dwordx4 v[116:119], v31, s[64:67], s95 offen offset:0 sc1
  buffer_load_dwordx4 v[120:123], v30, s[64:67], s95 offen offset:1024 sc1
  buffer_load_dwordx4 v[124:127], v31, s[64:67], s95 offen offset:1024 sc1
  buffer_load_dwordx4 v[64:67], v26, s[64:67], s96 offen offset:0 sc1
  buffer_load_dwordx4 v[68:71], v27, s[64:67], s96 offen offset:0 sc1
  s_branch L_Ck_55
L_Cr_57:
  s_sub_u32 s10, s10, 1
  s_cselect_b32 s10, 0, s10
  s_cbranch_scc1 L_Cg_215
  buffer_load_dwordx4 v[88:91], v30, s[64:67], s94 offen offset:1024 sc1
  buffer_load_dwordx4 v[92:95], v31, s[64:67], s94 offen offset:1024 sc1
  s_waitcnt vmcnt(0)
  v_bitop3_b32 v24, v88, v92, 1 bitop3:0x80
  v_cmp_eq_u32 vcc, 0, v24
  s_nop 1
  s_cbranch_vccnz L_Cr_57
L_Cg_215:
  buffer_load_dwordx4 v[96:99], v26, s[64:67], s95 offen offset:0 sc1
  buffer_load_dwordx4 v[100:103], v27, s[64:67], s95 offen offset:0 sc1
  buffer_load_dwordx4 v[104:107], v26, s[64:67], s95 offen offset:1024 sc1
  buffer_load_dwordx4 v[108:111], v27, s[64:67], s95 offen offset:1024 sc1
  buffer_load_dwordx4 v[112:115], v30, s[64:67], s95 offen offset:0 sc1
  buffer_load_dwordx4 v[116:119], v31, s[64:67], s95 offen offset:0 sc1
  buffer_load_dwordx4 v[120:123], v30, s[64:67], s95 offen offset:1024 sc1
  buffer_load_dwordx4 v[124:127], v31, s[64:67], s95 offen offset:1024 sc1
  buffer_load_dwordx4 v[64:67], v26, s[64:67], s96 offen offset:0 sc1
  buffer_load_dwordx4 v[68:71], v27, s[64:67], s96 offen offset:0 sc1
  buffer_load_dwordx4 v[72:75], v26, s[64:67], s96 offen offset:1024 sc1
  buffer_load_dwordx4 v[76:79], v27, s[64:67], s96 offen offset:1024 sc1
  s_branch L_Ck_58
L_Cr_60:
  s_sub_u32 s10, s10, 1
  s_cselect_b32 s10, 0, s10
  s_cbranch_scc1 L_Cg_216
  buffer_load_dwordx4 v[96:99], v26, s[64:67], s95 offen offset:0 sc1
  buffer_load_dwordx4 v[100:103], v27, s[64:67], s95 offen offset:0 sc1
  s_waitcnt vmcnt(0)
  v_bitop3_b32 v24, v96, v100, 1 bitop3:0x80
  v_cmp_eq_u32 vcc, 0, v24
  s_nop 1
  s_cbranch_vccnz L_Cr_60
L_Cg_216:
  buffer_load_dwordx4 v[104:107], v26, s[64:67], s95 offen offset:1024 sc1
  buffer_load_dwordx4 v[108:111], v27, s[64:67], s95 offen offset:1024 sc1
  buffer_load_dwordx4 v[112:115], v30, s[64:67], s95 offen offset:0 sc1
  buffer_load_dwordx4 v[116:119], v31, s[64:67], s95 offen offset:0 sc1
  buffer_load_dwordx4 v[120:123], v30, s[64:67], s95 offen offset:1024 sc1
  buffer_load_dwordx4 v[124:127], v31, s[64:67], s95 offen offset:1024 sc1
  buffer_load_dwordx4 v[64:67], v26, s[64:67], s96 offen offset:0 sc1
  buffer_load_dwordx4 v[68:71], v27, s[64:67], s96 offen offset:0 sc1
  buffer_load_dwordx4 v[72:75], v26, s[64:67], s96 offen offset:1024 sc1
  buffer_load_dwordx4 v[76:79], v27, s[64:67], s96 offen offset:1024 sc1
  buffer_load_dwordx4 v[80:83], v30, s[64:67], s96 offen offset:0 sc1
  buffer_load_dwordx4 v[84:87], v31, s[64:67], s96 offen offset:0 sc1
  s_branch L_Ck_61
L_Cr_63:
  s_sub_u32 s10, s10, 1
  s_cselect_b32 s10, 0, s10
  s_cbranch_scc1 L_Cg_217
  buffer_load_dwordx4 v[104:107], v26, s[64:67], s95 offen offset:1024 sc1
  buffer_load_dwordx4 v[108:111], v27, s[64:67], s95 offen offset:1024 sc1
  s_waitcnt vmcnt(0)
  v_bitop3_b32 v24, v104, v108, 1 bitop3:0x80
  v_cmp_eq_u32 vcc, 0, v24
  s_nop 1
  s_cbranch_vccnz L_Cr_63
L_Cg_217:
  buffer_load_dwordx4 v[112:115], v30, s[64:67], s95 offen offset:0 sc1
  buffer_load_dwordx4 v[116:119], v31, s[64:67], s95 offen offset:0 sc1
  buffer_load_dwordx4 v[120:123], v30, s[64:67], s95 offen offset:1024 sc1
  buffer_load_dwordx4 v[124:127], v31, s[64:67], s95 offen offset:1024 sc1
  buffer_load_dwordx4 v[64:67], v26, s[64:67], s96 offen offset:0 sc1
  buffer_load_dwordx4 v[68:71], v27, s[64:67], s96 offen offset:0 sc1
  buffer_load_dwordx4 v[72:75], v26, s[64:67], s96 offen offset:1024 sc1
  buffer_load_dwordx4 v[76:79], v27, s[64:67], s96 offen offset:1024 sc1
  buffer_load_dwordx4 v[80:83], v30, s[64:67], s96 offen offset:0 sc1
  buffer_load_dwordx4 v[84:87], v31, s[64:67], s96 offen offset:0 sc1
  buffer_load_dwordx4 v[88:91], v30, s[64:67], s96 offen offset:1024 sc1
  buffer_load_dwordx4 v[92:95], v31, s[64:67], s96 offen offset:1024 sc1
  s_branch L_Ck_64
L_Cr_66:
  s_sub_u32 s10, s10, 1
  s_cselect_b32 s10, 0, s10
  s_cbranch_scc1 L_Cg_218
  buffer_load_dwordx4 v[112:115], v30, s[64:67], s95 offen offset:0 sc1
  buffer_load_dwordx4 v[116:119], v31, s[64:67], s95 offen offset:0 sc1
  s_waitcnt vmcnt(0)
  v_bitop3_b32 v24, v112, v116, 1 bitop3:0x80
  v_cmp_eq_u32 vcc, 0, v24
  s_nop 1
  s_cbranch_vccnz L_Cr_66
L_Cg_218:
  buffer_load_dwordx4 v[120:123], v30, s[64:67], s95 offen offset:1024 sc1
  buffer_load_dwordx4 v[124:127], v31, s[64:67], s95 offen offset:1024 sc1
  buffer_load_dwordx4 v[64:67], v26, s[64:67], s96 offen offset:0 sc1
  buffer_load_dwordx4 v[68:71], v27, s[64:67], s96 offen offset:0 sc1
  buffer_load_dwordx4 v[72:75], v26, s[64:67], s96 offen offset:1024 sc1
  buffer_load_dwordx4 v[76:79], v27, s[64:67], s96 offen offset:1024 sc1
  buffer_load_dwordx4 v[80:83], v30, s[64:67], s96 offen offset:0 sc1
  buffer_load_dwordx4 v[84:87], v31, s[64:67], s96 offen offset:0 sc1
  buffer_load_dwordx4 v[88:91], v30, s[64:67], s96 offen offset:1024 sc1
  buffer_load_dwordx4 v[92:95], v31, s[64:67], s96 offen offset:1024 sc1
  buffer_load_dwordx4 v[96:99], v26, s[64:67], s97 offen offset:0 sc1
  buffer_load_dwordx4 v[100:103], v27, s[64:67], s97 offen offset:0 sc1
  s_branch L_Ck_67
L_Cr_69:
  s_sub_u32 s10, s10, 1
  s_cselect_b32 s10, 0, s10
  s_cbranch_scc1 L_Cg_219
  buffer_load_dwordx4 v[120:123], v30, s[64:67], s95 offen offset:1024 sc1
  buffer_load_dwordx4 v[124:127], v31, s[64:67], s95 offen offset:1024 sc1
  s_waitcnt vmcnt(0)
  v_bitop3_b32 v24, v120, v124, 1 bitop3:0x80
  v_cmp_eq_u32 vcc, 0, v24
  s_nop 1
  s_cbranch_vccnz L_Cr_69
L_Cg_219:
  buffer_load_dwordx4 v[64:67], v26, s[64:67], s96 offen offset:0 sc1
  buffer_load_dwordx4 v[68:71], v27, s[64:67], s96 offen offset:0 sc1
  buffer_load_dwordx4 v[72:75], v26, s[64:67], s96 offen offset:1024 sc1
  buffer_load_dwordx4 v[76:79], v27, s[64:67], s96 offen offset:1024 sc1
  buffer_load_dwordx4 v[80:83], v30, s[64:67], s96 offen offset:0 sc1
  buffer_load_dwordx4 v[84:87], v31, s[64:67], s96 offen offset:0 sc1
  buffer_load_dwordx4 v[88:91], v30, s[64:67], s96 offen offset:1024 sc1
  buffer_load_dwordx4 v[92:95], v31, s[64:67], s96 offen offset:1024 sc1
  buffer_load_dwordx4 v[96:99], v26, s[64:67], s97 offen offset:0 sc1
  buffer_load_dwordx4 v[100:103], v27, s[64:67], s97 offen offset:0 sc1
  buffer_load_dwordx4 v[104:107], v26, s[64:67], s97 offen offset:1024 sc1
  buffer_load_dwordx4 v[108:111], v27, s[64:67], s97 offen offset:1024 sc1
  s_branch L_Ck_70
L_Cr_72:
  s_sub_u32 s10, s10, 1
  s_cselect_b32 s10, 0, s10
  s_cbranch_scc1 L_Cg_220
  buffer_load_dwordx4 v[64:67], v26, s[64:67], s96 offen offset:0 sc1
  buffer_load_dwordx4 v[68:71], v27, s[64:67], s96 offen offset:0 sc1
  s_waitcnt vmcnt(0)
  v_bitop3_b32 v24, v64, v68, 1 bitop3:0x80
  v_cmp_eq_u32 vcc, 0, v24
  s_nop 1
  s_cbranch_vccnz L_Cr_72
L_Cg_220:
  buffer_load_dwordx4 v[72:75], v26, s[64:67], s96 offen offset:1024 sc1
  buffer_load_dwordx4 v[76:79], v27, s[64:67], s96 offen offset:1024 sc1
  buffer_load_dwordx4 v[80:83], v30, s[64:67], s96 offen offset:0 sc1
  buffer_load_dwordx4 v[84:87], v31, s[64:67], s96 offen offset:0 sc1
  buffer_load_dwordx4 v[88:91], v30, s[64:67], s96 offen offset:1024 sc1
  buffer_load_dwordx4 v[92:95], v31, s[64:67], s96 offen offset:1024 sc1
  buffer_load_dwordx4 v[96:99], v26, s[64:67], s97 offen offset:0 sc1
  buffer_load_dwordx4 v[100:103], v27, s[64:67], s97 offen offset:0 sc1
  buffer_load_dwordx4 v[104:107], v26, s[64:67], s97 offen offset:1024 sc1
  buffer_load_dwordx4 v[108:111], v27, s[64:67], s97 offen offset:1024 sc1
  buffer_load_dwordx4 v[112:115], v30, s[64:67], s97 offen offset:0 sc1
  buffer_load_dwordx4 v[116:119], v31, s[64:67], s97 offen offset:0 sc1
  s_branch L_Ck_73
L_Cr_75:
  s_sub_u32 s10, s10, 1
  s_cselect_b32 s10, 0, s10
  s_cbranch_scc1 L_Cg_221
  buffer_load_dwordx4 v[72:75], v26, s[64:67], s96 offen offset:1024 sc1
  buffer_load_dwordx4 v[76:79], v27, s[64:67], s96 offen offset:1024 sc1
  s_waitcnt vmcnt(0)
  v_bitop3_b32 v24, v72, v76, 1 bitop3:0x80
  v_cmp_eq_u32 vcc, 0, v24
  s_nop 1
  s_cbranch_vccnz L_Cr_75
L_Cg_221:
  buffer_load_dwordx4 v[80:83], v30, s[64:67], s96 offen offset:0 sc1
  buffer_load_dwordx4 v[84:87], v31, s[64:67], s96 offen offset:0 sc1
  buffer_load_dwordx4 v[88:91], v30, s[64:67], s96 offen offset:1024 sc1
  buffer_load_dwordx4 v[92:95], v31, s[64:67], s96 offen offset:1024 sc1
  buffer_load_dwordx4 v[96:99], v26, s[64:67], s97 offen offset:0 sc1
  buffer_load_dwordx4 v[100:103], v27, s[64:67], s97 offen offset:0 sc1
  buffer_load_dwordx4 v[104:107], v26, s[64:67], s97 offen offset:1024 sc1
  buffer_load_dwordx4 v[108:111], v27, s[64:67], s97 offen offset:1024 sc1
  buffer_load_dwordx4 v[112:115], v30, s[64:67], s97 offen offset:0 sc1
  buffer_load_dwordx4 v[116:119], v31, s[64:67], s97 offen offset:0 sc1
  buffer_load_dwordx4 v[120:123], v30, s[64:67], s97 offen offset:1024 sc1
  buffer_load_dwordx4 v[124:127], v31, s[64:67], s97 offen offset:1024 sc1
  s_branch L_Ck_76
L_Cr_78:
  s_sub_u32 s10, s10, 1
  s_cselect_b32 s10, 0, s10
  s_cbranch_scc1 L_Cg_222
  buffer_load_dwordx4 v[80:83], v30, s[64:67], s96 offen offset:0 sc1
  buffer_load_dwordx4 v[84:87], v31, s[64:67], s96 offen offset:0 sc1
  s_waitcnt vmcnt(0)
  v_bitop3_b32 v24, v80, v84, 1 bitop3:0x80
  v_cmp_eq_u32 vcc, 0, v24
  s_nop 1
  s_cbranch_vccnz L_Cr_78
L_Cg_222:
  buffer_load_dwordx4 v[88:91], v30, s[64:67], s96 offen offset:1024 sc1
  buffer_load_dwordx4 v[92:95], v31, s[64:67], s96 offen offset:1024 sc1
  buffer_load_dwordx4 v[96:99], v26, s[64:67], s97 offen offset:0 sc1
  buffer_load_dwordx4 v[100:103], v27, s[64:67], s97 offen offset:0 sc1
  buffer_load_dwordx4 v[104:107], v26, s[64:67], s97 offen offset:1024 sc1
  buffer_load_dwordx4 v[108:111], v27, s[64:67], s97 offen offset:1024 sc1
  buffer_load_dwordx4 v[112:115], v30, s[64:67], s97 offen offset:0 sc1
  buffer_load_dwordx4 v[116:119], v31, s[64:67], s97 offen offset:0 sc1
  buffer_load_dwordx4 v[120:123], v30, s[64:67], s97 offen offset:1024 sc1
  buffer_load_dwordx4 v[124:127], v31, s[64:67], s97 offen offset:1024 sc1
  buffer_load_dwordx4 v[64:67], v26, s[64:67], s98 offen offset:0 sc1
  buffer_load_dwordx4 v[68:71], v27, s[64:67], s98 offen offset:0 sc1
  s_branch L_Ck_79
L_Cr_81:
  s_sub_u32 s10, s10, 1
  s_cselect_b32 s10, 0, s10
  s_cbranch_scc1 L_Cg_223
  buffer_load_dwordx4 v[88:91], v30, s[64:67], s96 offen offset:1024 sc1
  buffer_load_dwordx4 v[92:95], v31, s[64:67], s96 offen offset:1024 sc1
  s_waitcnt vmcnt(0)
  v_bitop3_b32 v24, v88, v92, 1 bitop3:0x80
  v_cmp_eq_u32 vcc, 0, v24
  s_nop 1
  s_cbranch_vccnz L_Cr_81
L_Cg_223:
  buffer_load_dwordx4 v[96:99], v26, s[64:67], s97 offen offset:0 sc1
  buffer_load_dwordx4 v[100:103], v27, s[64:67], s97 offen offset:0 sc1
  buffer_load_dwordx4 v[104:107], v26, s[64:67], s97 offen offset:1024 sc1
  buffer_load_dwordx4 v[108:111], v27, s[64:67], s97 offen offset:1024 sc1
  buffer_load_dwordx4 v[112:115], v30, s[64:67], s97 offen offset:0 sc1
  buffer_load_dwordx4 v[116:119], v31, s[64:67], s97 offen offset:0 sc1
  buffer_load_dwordx4 v[120:123], v30, s[64:67], s97 offen offset:1024 sc1
  buffer_load_dwordx4 v[124:127], v31, s[64:67], s97 offen offset:1024 sc1
  buffer_load_dwordx4 v[64:67], v26, s[64:67], s98 offen offset:0 sc1
  buffer_load_dwordx4 v[68:71], v27, s[64:67], s98 offen offset:0 sc1
  buffer_load_dwordx4 v[72:75], v26, s[64:67], s98 offen offset:1024 sc1
  buffer_load_dwordx4 v[76:79], v27, s[64:67], s98 offen offset:1024 sc1
  s_branch L_Ck_82
L_Cr_84:
  s_sub_u32 s10, s10, 1
  s_cselect_b32 s10, 0, s10
  s_cbranch_scc1 L_Cg_224
  buffer_load_dwordx4 v[96:99], v26, s[64:67], s97 offen offset:0 sc1
  buffer_load_dwordx4 v[100:103], v27, s[64:67], s97 offen offset:0 sc1
  s_waitcnt vmcnt(0)
  v_bitop3_b32 v24, v96, v100, 1 bitop3:0x80
  v_cmp_eq_u32 vcc, 0, v24
  s_nop 1
  s_cbranch_vccnz L_Cr_84
L_Cg_224:
  buffer_load_dwordx4 v[104:107], v26, s[64:67], s97 offen offset:1024 sc1
  buffer_load_dwordx4 v[108:111], v27, s[64:67], s97 offen offset:1024 sc1
  buffer_load_dwordx4 v[112:115], v30, s[64:67], s97 offen offset:0 sc1
  buffer_load_dwordx4 v[116:119], v31, s[64:67], s97 offen offset:0 sc1
  buffer_load_dwordx4 v[120:123], v30, s[64:67], s97 offen offset:1024 sc1
  buffer_load_dwordx4 v[124:127], v31, s[64:67], s97 offen offset:1024 sc1
  buffer_load_dwordx4 v[64:67], v26, s[64:67], s98 offen offset:0 sc1
  buffer_load_dwordx4 v[68:71], v27, s[64:67], s98 offen offset:0 sc1
  buffer_load_dwordx4 v[72:75], v26, s[64:67], s98 offen offset:1024 sc1
  buffer_load_dwordx4 v[76:79], v27, s[64:67], s98 offen offset:1024 sc1
  buffer_load_dwordx4 v[80:83], v30, s[64:67], s98 offen offset:0 sc1
  buffer_load_dwordx4 v[84:87], v31, s[64:67], s98 offen offset:0 sc1
  s_branch L_Ck_85
L_Cr_87:
  s_sub_u32 s10, s10, 1
  s_cselect_b32 s10, 0, s10
  s_cbranch_scc1 L_Cg_225
  buffer_load_dwordx4 v[104:107], v26, s[64:67], s97 offen offset:1024 sc1
  buffer_load_dwordx4 v[108:111], v27, s[64:67], s97 offen offset:1024 sc1
  s_waitcnt vmcnt(0)
  v_bitop3_b32 v24, v104, v108, 1 bitop3:0x80
  v_cmp_eq_u32 vcc, 0, v24
  s_nop 1
  s_cbranch_vccnz L_Cr_87
L_Cg_225:
  buffer_load_dwordx4 v[112:115], v30, s[64:67], s97 offen offset:0 sc1
  buffer_load_dwordx4 v[116:119], v31, s[64:67], s97 offen offset:0 sc1
  buffer_load_dwordx4 v[120:123], v30, s[64:67], s97 offen offset:1024 sc1
  buffer_load_dwordx4 v[124:127], v31, s[64:67], s97 offen offset:1024 sc1
  buffer_load_dwordx4 v[64:67], v26, s[64:67], s98 offen offset:0 sc1
  buffer_load_dwordx4 v[68:71], v27, s[64:67], s98 offen offset:0 sc1
  buffer_load_dwordx4 v[72:75], v26, s[64:67], s98 offen offset:1024 sc1
  buffer_load_dwordx4 v[76:79], v27, s[64:67], s98 offen offset:1024 sc1
  buffer_load_dwordx4 v[80:83], v30, s[64:67], s98 offen offset:0 sc1
  buffer_load_dwordx4 v[84:87], v31, s[64:67], s98 offen offset:0 sc1
  buffer_load_dwordx4 v[88:91], v30, s[64:67], s98 offen offset:1024 sc1
  buffer_load_dwordx4 v[92:95], v31, s[64:67], s98 offen offset:1024 sc1
  s_branch L_Ck_88
L_Cr_90:
  s_sub_u32 s10, s10, 1
  s_cselect_b32 s10, 0, s10
  s_cbranch_scc1 L_Cg_226
  buffer_load_dwordx4 v[112:115], v30, s[64:67], s97 offen offset:0 sc1
  buffer_load_dwordx4 v[116:119], v31, s[64:67], s97 offen offset:0 sc1
  s_waitcnt vmcnt(0)
  v_bitop3_b32 v24, v112, v116, 1 bitop3:0x80
  v_cmp_eq_u32 vcc, 0, v24
  s_nop 1
  s_cbranch_vccnz L_Cr_90
L_Cg_226:
  buffer_load_dwordx4 v[120:123], v30, s[64:67], s97 offen offset:1024 sc1
  buffer_load_dwordx4 v[124:127], v31, s[64:67], s97 offen offset:1024 sc1
  buffer_load_dwordx4 v[64:67], v26, s[64:67], s98 offen offset:0 sc1
  buffer_load_dwordx4 v[68:71], v27, s[64:67], s98 offen offset:0 sc1
  buffer_load_dwordx4 v[72:75], v26, s[64:67], s98 offen offset:1024 sc1
  buffer_load_dwordx4 v[76:79], v27, s[64:67], s98 offen offset:1024 sc1
  buffer_load_dwordx4 v[80:83], v30, s[64:67], s98 offen offset:0 sc1
  buffer_load_dwordx4 v[84:87], v31, s[64:67], s98 offen offset:0 sc1
  buffer_load_dwordx4 v[88:91], v30, s[64:67], s98 offen offset:1024 sc1
  buffer_load_dwordx4 v[92:95], v31, s[64:67], s98 offen offset:1024 sc1
  buffer_load_dwordx4 v[96:99], v26, s[64:67], s99 offen offset:0 sc1
  buffer_load_dwordx4 v[100:103], v27, s[64:67], s99 offen offset:0 sc1
  s_branch L_Ck_91
L_Cr_93:
  s_sub_u32 s10, s10, 1
  s_cselect_b32 s10, 0, s10
  s_cbranch_scc1 L_Cg_227
  buffer_load_dwordx4 v[120:123], v30, s[64:67], s97 offen offset:1024 sc1
  buffer_load_dwordx4 v[124:127], v31, s[64:67], s97 offen offset:1024 sc1
  s_waitcnt vmcnt(0)
  v_bitop3_b32 v24, v120, v124, 1 bitop3:0x80
  v_cmp_eq_u32 vcc, 0, v24
  s_nop 1
  s_cbranch_vccnz L_Cr_93
L_Cg_227:
  buffer_load_dwordx4 v[64:67], v26, s[64:67], s98 offen offset:0 sc1
  buffer_load_dwordx4 v[68:71], v27, s[64:67], s98 offen offset:0 sc1
  buffer_load_dwordx4 v[72:75], v26, s[64:67], s98 offen offset:1024 sc1
  buffer_load_dwordx4 v[76:79], v27, s[64:67], s98 offen offset:1024 sc1
  buffer_load_dwordx4 v[80:83], v30, s[64:67], s98 offen offset:0 sc1
  buffer_load_dwordx4 v[84:87], v31, s[64:67], s98 offen offset:0 sc1
  buffer_load_dwordx4 v[88:91], v30, s[64:67], s98 offen offset:1024 sc1
  buffer_load_dwordx4 v[92:95], v31, s[64:67], s98 offen offset:1024 sc1
  buffer_load_dwordx4 v[96:99], v26, s[64:67], s99 offen offset:0 sc1
  buffer_load_dwordx4 v[100:103], v27, s[64:67], s99 offen offset:0 sc1
  buffer_load_dwordx4 v[104:107], v26, s[64:67], s99 offen offset:1024 sc1
  buffer_load_dwordx4 v[108:111], v27, s[64:67], s99 offen offset:1024 sc1
  s_branch L_Ck_94
L_Cr_96:
  s_sub_u32 s10, s10, 1
  s_cselect_b32 s10, 0, s10
  s_cbranch_scc1 L_Cg_228
  buffer_load_dwordx4 v[64:67], v26, s[64:67], s98 offen offset:0 sc1
  buffer_load_dwordx4 v[68:71], v27, s[64:67], s98 offen offset:0 sc1
  s_waitcnt vmcnt(0)
  v_bitop3_b32 v24, v64, v68, 1 bitop3:0x80
  v_cmp_eq_u32 vcc, 0, v24
  s_nop 1
  s_cbranch_vccnz L_Cr_96
L_Cg_228:
  buffer_load_dwordx4 v[72:75], v26, s[64:67], s98 offen offset:1024 sc1
  buffer_load_dwordx4 v[76:79], v27, s[64:67], s98 offen offset:1024 sc1
  buffer_load_dwordx4 v[80:83], v30, s[64:67], s98 offen offset:0 sc1
  buffer_load_dwordx4 v[84:87], v31, s[64:67], s98 offen offset:0 sc1
  buffer_load_dwordx4 v[88:91], v30, s[64:67], s98 offen offset:1024 sc1
  buffer_load_dwordx4 v[92:95], v31, s[64:67], s98 offen offset:1024 sc1
  buffer_load_dwordx4 v[96:99], v26, s[64:67], s99 offen offset:0 sc1
  buffer_load_dwordx4 v[100:103], v27, s[64:67], s99 offen offset:0 sc1
  buffer_load_dwordx4 v[104:107], v26, s[64:67], s99 offen offset:1024 sc1
  buffer_load_dwordx4 v[108:111], v27, s[64:67], s99 offen offset:1024 sc1
  buffer_load_dwordx4 v[112:115], v30, s[64:67], s99 offen offset:0 sc1
  buffer_load_dwordx4 v[116:119], v31, s[64:67], s99 offen offset:0 sc1
  s_branch L_Ck_97
L_Cr_99:
  s_sub_u32 s10, s10, 1
  s_cselect_b32 s10, 0, s10
  s_cbranch_scc1 L_Cg_229
  buffer_load_dwordx4 v[72:75], v26, s[64:67], s98 offen offset:1024 sc1
  buffer_load_dwordx4 v[76:79], v27, s[64:67], s98 offen offset:1024 sc1
  s_waitcnt vmcnt(0)
  v_bitop3_b32 v24, v72, v76, 1 bitop3:0x80
  v_cmp_eq_u32 vcc, 0, v24
  s_nop 1
  s_cbranch_vccnz L_Cr_99
L_Cg_229:
  buffer_load_dwordx4 v[80:83], v30, s[64:67], s98 offen offset:0 sc1
  buffer_load_dwordx4 v[84:87], v31, s[64:67], s98 offen offset:0 sc1
  buffer_load_dwordx4 v[88:91], v30, s[64:67], s98 offen offset:1024 sc1
  buffer_load_dwordx4 v[92:95], v31, s[64:67], s98 offen offset:1024 sc1
  buffer_load_dwordx4 v[96:99], v26, s[64:67], s99 offen offset:0 sc1
  buffer_load_dwordx4 v[100:103], v27, s[64:67], s99 offen offset:0 sc1
  buffer_load_dwordx4 v[104:107], v26, s[64:67], s99 offen offset:1024 sc1
  buffer_load_dwordx4 v[108:111], v27, s[64:67], s99 offen offset:1024 sc1
  buffer_load_dwordx4 v[112:115], v30, s[64:67], s99 offen offset:0 sc1
  buffer_load_dwordx4 v[116:119], v31, s[64:67], s99 offen offset:0 sc1
  buffer_load_dwordx4 v[120:123], v30, s[64:67], s99 offen offset:1024 sc1
  buffer_load_dwordx4 v[124:127], v31, s[64:67], s99 offen offset:1024 sc1
  s_branch L_Ck_100
L_Cr_102:
  s_sub_u32 s10, s10, 1
  s_cselect_b32 s10, 0, s10
  s_cbranch_scc1 L_Cg_230
  buffer_load_dwordx4 v[80:83], v30, s[64:67], s98 offen offset:0 sc1
  buffer_load_dwordx4 v[84:87], v31, s[64:67], s98 offen offset:0 sc1
  s_waitcnt vmcnt(0)
  v_bitop3_b32 v24, v80, v84, 1 bitop3:0x80
  v_cmp_eq_u32 vcc, 0, v24
  s_nop 1
  s_cbranch_vccnz L_Cr_102
L_Cg_230:
  buffer_load_dwordx4 v[88:91], v30, s[64:67], s98 offen offset:1024 sc1
  buffer_load_dwordx4 v[92:95], v31, s[64:67], s98 offen offset:1024 sc1
  buffer_load_dwordx4 v[96:99], v26, s[64:67], s99 offen offset:0 sc1
  buffer_load_dwordx4 v[100:103], v27, s[64:67], s99 offen offset:0 sc1
  buffer_load_dwordx4 v[104:107], v26, s[64:67], s99 offen offset:1024 sc1
  buffer_load_dwordx4 v[108:111], v27, s[64:67], s99 offen offset:1024 sc1
  buffer_load_dwordx4 v[112:115], v30, s[64:67], s99 offen offset:0 sc1
  buffer_load_dwordx4 v[116:119], v31, s[64:67], s99 offen offset:0 sc1
  buffer_load_dwordx4 v[120:123], v30, s[64:67], s99 offen offset:1024 sc1
  buffer_load_dwordx4 v[124:127], v31, s[64:67], s99 offen offset:1024 sc1
  s_waitcnt vmcnt(0)
  s_branch L_Ck_103
L_Cr_105:
  s_sub_u32 s10, s10, 1
  s_cselect_b32 s10, 0, s10
  s_cbranch_scc1 L_Cg_231
  buffer_load_dwordx4 v[88:91], v30, s[64:67], s98 offen offset:1024 sc1
  buffer_load_dwordx4 v[92:95], v31, s[64:67], s98 offen offset:1024 sc1
  s_waitcnt vmcnt(0)
  v_bitop3_b32 v24, v88, v92, 1 bitop3:0x80
  v_cmp_eq_u32 vcc, 0, v24
  s_nop 1
  s_cbranch_vccnz L_Cr_105
L_Cg_231:
  buffer_load_dwordx4 v[96:99], v26, s[64:67], s99 offen offset:0 sc1
  buffer_load_dwordx4 v[100:103], v27, s[64:67], s99 offen offset:0 sc1
  buffer_load_dwordx4 v[104:107], v26, s[64:67], s99 offen offset:1024 sc1
  buffer_load_dwordx4 v[108:111], v27, s[64:67], s99 offen offset:1024 sc1
  buffer_load_dwordx4 v[112:115], v30, s[64:67], s99 offen offset:0 sc1
  buffer_load_dwordx4 v[116:119], v31, s[64:67], s99 offen offset:0 sc1
  buffer_load_dwordx4 v[120:123], v30, s[64:67], s99 offen offset:1024 sc1
  buffer_load_dwordx4 v[124:127], v31, s[64:67], s99 offen offset:1024 sc1
  s_waitcnt vmcnt(0)
  s_branch L_Ck_106
L_Cr_108:
  s_sub_u32 s10, s10, 1
  s_cselect_b32 s10, 0, s10
  s_cbranch_scc1 L_Cg_232
  buffer_load_dwordx4 v[96:99], v26, s[64:67], s99 offen offset:0 sc1
  buffer_load_dwordx4 v[100:103], v27, s[64:67], s99 offen offset:0 sc1
  s_waitcnt vmcnt(0)
  v_bitop3_b32 v24, v96, v100, 1 bitop3:0x80
  v_cmp_eq_u32 vcc, 0, v24
  s_nop 1
  s_cbranch_vccnz L_Cr_108
L_Cg_232:
  buffer_load_dwordx4 v[104:107], v26, s[64:67], s99 offen offset:1024 sc1
  buffer_load_dwordx4 v[108:111], v27, s[64:67], s99 offen offset:1024 sc1
  buffer_load_dwordx4 v[112:115], v30, s[64:67], s99 offen offset:0 sc1
  buffer_load_dwordx4 v[116:119], v31, s[64:67], s99 offen offset:0 sc1
  buffer_load_dwordx4 v[120:123], v30, s[64:67], s99 offen offset:1024 sc1
  buffer_load_dwordx4 v[124:127], v31, s[64:67], s99 offen offset:1024 sc1
  s_waitcnt vmcnt(0)
  s_branch L_Ck_109
L_Cr_111:
  s_sub_u32 s10, s10, 1
  s_cselect_b32 s10, 0, s10
  s_cbranch_scc1 L_Cg_233
  buffer_load_dwordx4 v[104:107], v26, s[64:67], s99 offen offset:1024 sc1
  buffer_load_dwordx4 v[108:111], v27, s[64:67], s99 offen offset:1024 sc1
  s_waitcnt vmcnt(0)
  v_bitop3_b32 v24, v104, v108, 1 bitop3:0x80
  v_cmp_eq_u32 vcc, 0, v24
  s_nop 1
  s_cbranch_vccnz L_Cr_111
L_Cg_233:
  buffer_load_dwordx4 v[112:115], v30, s[64:67], s99 offen offset:0 sc1
  buffer_load_dwordx4 v[116:119], v31, s[64:67], s99 offen offset:0 sc1
  buffer_load_dwordx4 v[120:123], v30, s[64:67], s99 offen offset:1024 sc1
  buffer_load_dwordx4 v[124:127], v31, s[64:67], s99 offen offset:1024 sc1
  s_waitcnt vmcnt(0)
  s_branch L_Ck_112
L_Cr_114:
  s_sub_u32 s10, s10, 1
  s_cselect_b32 s10, 0, s10
  s_cbranch_scc1 L_Cg_234
  buffer_load_dwordx4 v[112:115], v30, s[64:67], s99 offen offset:0 sc1
  buffer_load_dwordx4 v[116:119], v31, s[64:67], s99 offen offset:0 sc1
  s_waitcnt vmcnt(0)
  v_bitop3_b32 v24, v112, v116, 1 bitop3:0x80
  v_cmp_eq_u32 vcc, 0, v24
  s_nop 1
  s_cbranch_vccnz L_Cr_114
L_Cg_234:
  buffer_load_dwordx4 v[120:123], v30, s[64:67], s99 offen offset:1024 sc1
  buffer_load_dwordx4 v[124:127], v31, s[64:67], s99 offen offset:1024 sc1
  s_waitcnt vmcnt(0)
  s_branch L_Ck_115
L_Cr_117:
  s_sub_u32 s10, s10, 1
  s_cselect_b32 s10, 0, s10
  s_cbranch_scc1 L_Cg_235
  buffer_load_dwordx4 v[120:123], v30, s[64:67], s99 offen offset:1024 sc1
  buffer_load_dwordx4 v[124:127], v31, s[64:67], s99 offen offset:1024 sc1
  s_waitcnt vmcnt(0)
  v_bitop3_b32 v24, v120, v124, 1 bitop3:0x80
  v_cmp_eq_u32 vcc, 0, v24
  s_nop 1
  s_cbranch_vccnz L_Cr_117
L_Cg_235:
  s_waitcnt vmcnt(0)
  s_branch L_Ck_118
L_skipC_22:
  s_waitcnt vmcnt(0) lgkmcnt(0)
  v_mov_b32 v35, v7
  s_lshl_b32 s100, s20, 6
  v_mul_u32_u24 v4, 512, v15
  v_bfe_u32 v28, v1, 2, 2
  v_lshl_add_u32 v4, v28, 7, v4
  v_bfe_u32 v28, v1, 3, 1
  v_lshlrev_b32 v28, 6, v28
  v_bfe_u32 v29, v1, 4, 1
  v_lshl_or_b32 v28, v29, 5, v28
  v_and_b32 v29, 3, v1
  v_lshl_or_b32 v28, v29, 3, v28
  v_xor_b32 v28, s100, v28
  v_add_u32 v4, v4, v28
  v_add_u32 v4, s11, v4
  v_xor_b32 v5, 64, v4
  v_add_u32 v6, 0x10000, v4
  v_add_u32 v7, 0x10000, v5
  s_lshl_b32 s100, s68, 13
  s_sub_u32 s100, 0x20000, s100
  v_add_u32 v28, s100, v4
  v_add_u32 v29, s100, v5
  s_lshl1_add_u32 s100, s81, s20
  s_lshl1_add_u32 s101, s78, s19
  s_lshl_b32 s84, s100, 15
  s_lshl_b32 s85, s101, 6
  s_add_u32 s84, s84, s85
  s_lshl_b32 s85, s100, 6
  s_lshl4_add_u32 s86, s100, s101
  s_lshl_b32 s86, s86, 11
  s_add_u32 s86, s86, 8388608
  v_and_b32 v14, 31, v1
  v_lshlrev_b32 v43, 1, v14
  v_lshlrev_b32 v13, 10, v14
  v_lshl_add_u32 v13, v15, 4, v13
  s_mul_i32 s100, s78, 229376
  s_mul_i32 s101, s68, 28672
  s_add_u32 s100, s100, s101
  s_add_u32 s17, s100, 6291456
  s_mul_i32 s101, s19, 114688
  s_add_u32 s100, s17, s101
  v_add_u32 v40, s100, v2
  s_sub_u32 s101, 114688, s101
  s_add_u32 s100, s17, s101
  v_add_u32 v41, s100, v2
  s_add_u32 s101, s22, 524288
  buffer_load_dword v33, v35, s[52:55], s101 offen
  s_add_u32 s101, s22, 557056
  buffer_load_dword v33, v35, s[52:55], s101 offen
L_iw_236:
  s_add_u32 m0, s11, 65536
  s_add_u32 s18, s16, 0
  buffer_load_dwordx4 v36, s[52:55], s18 offen lds
  buffer_load_dwordx4 v37, s[52:55], s18 offen offset:1024 lds
  buffer_load_dwordx4 v38, s[52:55], s18 offen offset:2048 lds
  buffer_load_dwordx4 v39, s[52:55], s18 offen offset:3072 lds
  s_add_u32 m0, s11, 69632
  s_add_u32 s18, s16, 131072
  buffer_load_dwordx4 v36, s[52:55], s18 offen lds
  buffer_load_dwordx4 v37, s[52:55], s18 offen offset:1024 lds
  buffer_load_dwordx4 v38, s[52:55], s18 offen offset:2048 lds
  buffer_load_dwordx4 v39, s[52:55], s18 offen offset:3072 lds
  s_add_u32 m0, s11, 73728
  s_add_u32 s18, s16, 262144
  buffer_load_dwordx4 v36, s[52:55], s18 offen lds
  buffer_load_dwordx4 v37, s[52:55], s18 offen offset:1024 lds
  buffer_load_dwordx4 v38, s[52:55], s18 offen offset:2048 lds
  buffer_load_dwordx4 v39, s[52:55], s18 offen offset:3072 lds
  s_add_u32 m0, s11, 77824
  s_add_u32 s18, s16, 393216
  buffer_load_dwordx4 v36, s[52:55], s18 offen lds
  buffer_load_dwordx4 v37, s[52:55], s18 offen offset:1024 lds
  buffer_load_dwordx4 v38, s[52:55], s18 offen offset:2048 lds
  buffer_load_dwordx4 v39, s[52:55], s18 offen offset:3072 lds
  s_add_u32 s101, s22, 786432
  buffer_load_dword v33, v35, s[52:55], s101 offen
  s_add_u32 s101, s22, 819200
  buffer_load_dword v33, v35, s[52:55], s101 offen
  s_add_u32 s101, s22, 1572864
  buffer_load_dword v33, v35, s[52:55], s101 offen
L_iw_237:
  s_and_b32 s101, s16, 0xfffffc00
  s_add_u32 s101, s101, 1048576
  buffer_load_dword v33, v34, s[52:55], s101 offen
  s_waitcnt vmcnt(0)
  ds_read_b64_tr_b16 a[128:129], v6 offset:0
  ds_read_b64_tr_b16 a[130:131], v6 offset:1024
  ds_read_b64_tr_b16 a[132:133], v7 offset:0
  ds_read_b64_tr_b16 a[134:135], v7 offset:1024
  ds_read_b64_tr_b16 a[136:137], v6 offset:2048
  ds_read_b64_tr_b16 a[138:139], v6 offset:3072
  ds_read_b64_tr_b16 a[140:141], v7 offset:2048
  ds_read_b64_tr_b16 a[142:143], v7 offset:3072
  ds_read_b64_tr_b16 a[144:145], v6 offset:4096
  ds_read_b64_tr_b16 a[146:147], v6 offset:5120
  ds_read_b64_tr_b16 a[148:149], v7 offset:4096
  ds_read_b64_tr_b16 a[150:151], v7 offset:5120
  ds_read_b64_tr_b16 a[152:153], v6 offset:6144
  ds_read_b64_tr_b16 a[154:155], v6 offset:7168
  ds_read_b64_tr_b16 a[156:157], v7 offset:6144
  ds_read_b64_tr_b16 a[158:159], v7 offset:7168
  ds_read_b64_tr_b16 a[160:161], v6 offset:8192
  ds_read_b64_tr_b16 a[162:163], v6 offset:9216
  ds_read_b64_tr_b16 a[164:165], v7 offset:8192
  ds_read_b64_tr_b16 a[166:167], v7 offset:9216
  ds_read_b64_tr_b16 a[168:169], v6 offset:10240
  ds_read_b64_tr_b16 a[170:171], v6 offset:11264
  ds_read_b64_tr_b16 a[172:173], v7 offset:10240
  ds_read_b64_tr_b16 a[174:175], v7 offset:11264
  ds_read_b64_tr_b16 a[176:177], v6 offset:12288
  ds_read_b64_tr_b16 a[178:179], v6 offset:13312
  ds_read_b64_tr_b16 a[180:181], v7 offset:12288
  ds_read_b64_tr_b16 a[182:183], v7 offset:13312
  ds_read_b64_tr_b16 a[184:185], v6 offset:14336
  ds_read_b64_tr_b16 a[186:187], v6 offset:15360
  ds_read_b64_tr_b16 a[188:189], v7 offset:14336
  ds_read_b64_tr_b16 a[190:191], v7 offset:15360
  s_waitcnt lgkmcnt(0)
  s_add_u32 m0, s11, 65536
  s_add_u32 s18, s16, 524288
  buffer_load_dwordx4 v36, s[52:55], s18 offen lds
  buffer_load_dwordx4 v37, s[52:55], s18 offen offset:1024 lds
  buffer_load_dwordx4 v38, s[52:55], s18 offen offset:2048 lds
  buffer_load_dwordx4 v39, s[52:55], s18 offen offset:3072 lds
  s_add_u32 m0, s11, 69632
  s_add_u32 s18, s16, 655360
  buffer_load_dwordx4 v36, s[52:55], s18 offen lds
  buffer_load_dwordx4 v37, s[52:55], s18 offen offset:1024 lds
  buffer_load_dwordx4 v38, s[52:55], s18 offen offset:2048 lds
  buffer_load_dwordx4 v39, s[52:55], s18 offen offset:3072 lds
  s_add_u32 m0, s11, 73728
  s_add_u32 s18, s16, 786432
  buffer_load_dwordx4 v36, s[52:55], s18 offen lds
  buffer_load_dwordx4 v37, s[52:55], s18 offen offset:1024 lds
  buffer_load_dwordx4 v38, s[52:55], s18 offen offset:2048 lds
  buffer_load_dwordx4 v39, s[52:55], s18 offen offset:3072 lds
  s_add_u32 m0, s11, 77824
  s_add_u32 s18, s16, 917504
  buffer_load_dwordx4 v36, s[52:55], s18 offen lds
  buffer_load_dwordx4 v37, s[52:55], s18 offen offset:1024 lds
  buffer_load_dwordx4 v38, s[52:55], s18 offen offset:2048 lds
  buffer_load_dwordx4 v39, s[52:55], s18 offen offset:3072 lds
  s_add_u32 m0, s11, 0
  s_add_u32 s18, s16, 1048576
  buffer_load_dwordx4 v36, s[52:55], s18 offen lds
  buffer_load_dwordx4 v37, s[52:55], s18 offen offset:1024 lds
  buffer_load_dwordx4 v38, s[52:55], s18 offen offset:2048 lds
  buffer_load_dwordx4 v39, s[52:55], s18 offen offset:3072 lds
  s_add_u32 m0, s11, 4096
  s_add_u32 s18, s16, 1179648
  buffer_load_dwordx4 v36, s[52:55], s18 offen lds
  buffer_load_dwordx4 v37, s[52:55], s18 offen offset:1024 lds
  buffer_load_dwordx4 v38, s[52:55], s18 offen offset:2048 lds
  buffer_load_dwordx4 v39, s[52:55], s18 offen offset:3072 lds
  s_add_u32 m0, s11, 8192
  s_add_u32 s18, s16, 1310720
  buffer_load_dwordx4 v36, s[52:55], s18 offen lds
  buffer_load_dwordx4 v37, s[52:55], s18 offen offset:1024 lds
  buffer_load_dwordx4 v38, s[52:55], s18 offen offset:2048 lds
  buffer_load_dwordx4 v39, s[52:55], s18 offen offset:3072 lds
  s_add_u32 m0, s11, 12288
  s_add_u32 s18, s16, 1441792
  buffer_load_dwordx4 v36, s[52:55], s18 offen lds
  buffer_load_dwordx4 v37, s[52:55], s18 offen offset:1024 lds
  buffer_load_dwordx4 v38, s[52:55], s18 offen offset:2048 lds
  buffer_load_dwordx4 v39, s[52:55], s18 offen offset:3072 lds
  s_waitcnt vmcnt(16)
  s_branch L_skipC2_119
L_Dr_121:
  s_sub_u32 s10, s10, 1
  s_cselect_b32 s10, 0, s10
  s_cbranch_scc1 L_Dg_238
  buffer_load_dwordx4 v[64:67], v40, s[64:67], s73 offen offset:0 sc1
  buffer_load_dwordx4 v[68:71], v41, s[64:67], s73 offen offset:0 sc1
  s_waitcnt vmcnt(0)
  v_bitop3_b32 v24, v64, v68, 1 bitop3:0x80
  v_cmp_eq_u32 vcc, 0, v24
  s_nop 1
  s_cbranch_vccnz L_Dr_121
L_Dg_238:
  buffer_load_dwordx4 v[72:75], v40, s[64:67], s73 offen offset:1024 sc1
  buffer_load_dwordx4 v[76:79], v41, s[64:67], s73 offen offset:1024 sc1
  buffer_load_dwordx4 v[80:83], v40, s[64:67], s73 offen offset:2048 sc1
  buffer_load_dwordx4 v[84:87], v41, s[64:67], s73 offen offset:2048 sc1
  buffer_load_dwordx4 v[88:91], v40, s[64:67], s73 offen offset:3072 sc1
  buffer_load_dwordx4 v[92:95], v41, s[64:67], s73 offen offset:3072 sc1
  buffer_load_dwordx4 v[96:99], v40, s[64:67], s74 offen offset:0 sc1
  buffer_load_dwordx4 v[100:103], v41, s[64:67], s74 offen offset:0 sc1
  buffer_load_dwordx4 v[104:107], v40, s[64:67], s74 offen offset:1024 sc1
  buffer_load_dwordx4 v[108:111], v41, s[64:67], s74 offen offset:1024 sc1
  buffer_load_dwordx4 v[112:115], v40, s[64:67], s74 offen offset:2048 sc1
  buffer_load_dwordx4 v[116:119], v41, s[64:67], s74 offen offset:2048 sc1
  s_branch L_Dk_122
L_Dr_124:
  s_sub_u32 s10, s10, 1
  s_cselect_b32 s10, 0, s10
  s_cbranch_scc1 L_Dg_239
  buffer_load_dwordx4 v[72:75], v40, s[64:67], s73 offen offset:1024 sc1
  buffer_load_dwordx4 v[76:79], v41, s[64:67], s73 offen offset:1024 sc1
  s_waitcnt vmcnt(0)
  v_bitop3_b32 v24, v72, v76, 1 bitop3:0x80
  v_cmp_eq_u32 vcc, 0, v24
  s_nop 1
  s_cbranch_vccnz L_Dr_124
L_Dg_239:
  buffer_load_dwordx4 v[80:83], v40, s[64:67], s73 offen offset:2048 sc1
  buffer_load_dwordx4 v[84:87], v41, s[64:67], s73 offen offset:2048 sc1
  buffer_load_dwordx4 v[88:91], v40, s[64:67], s73 offen offset:3072 sc1
  buffer_load_dwordx4 v[92:95], v41, s[64:67], s73 offen offset:3072 sc1
  buffer_load_dwordx4 v[96:99], v40, s[64:67], s74 offen offset:0 sc1
  buffer_load_dwordx4 v[100:103], v41, s[64:67], s74 offen offset:0 sc1
  buffer_load_dwordx4 v[104:107], v40, s[64:67], s74 offen offset:1024 sc1
  buffer_load_dwordx4 v[108:111], v41, s[64:67], s74 offen offset:1024 sc1
  buffer_load_dwordx4 v[112:115], v40, s[64:67], s74 offen offset:2048 sc1
  buffer_load_dwordx4 v[116:119], v41, s[64:67], s74 offen offset:2048 sc1
  buffer_load_dwordx4 v[120:123], v40, s[64:67], s74 offen offset:3072 sc1
  buffer_load_dwordx4 v[124:127], v41, s[64:67], s74 offen offset:3072 sc1
  s_waitcnt vmcnt(0)
  s_branch L_Dk_125
L_Dr_127:
  s_sub_u32 s10, s10, 1
  s_cselect_b32 s10, 0, s10
  s_cbranch_scc1 L_Dg_240
  buffer_load_dwordx4 v[80:83], v40, s[64:67], s73 offen offset:2048 sc1
  buffer_load_dwordx4 v[84:87], v41, s[64:67], s73 offen offset:2048 sc1
  s_waitcnt vmcnt(0)
  v_bitop3_b32 v24, v80, v84, 1 bitop3:0x80
  v_cmp_eq_u32 vcc, 0, v24
  s_nop 1
  s_cbranch_vccnz L_Dr_127
L_Dg_240:
  buffer_load_dwordx4 v[88:91], v40, s[64:67], s73 offen offset:3072 sc1
  buffer_load_dwordx4 v[92:95], v41, s[64:67], s73 offen offset:3072 sc1
  buffer_load_dwordx4 v[96:99], v40, s[64:67], s74 offen offset:0 sc1
  buffer_load_dwordx4 v[100:103], v41, s[64:67], s74 offen offset:0 sc1
  buffer_load_dwordx4 v[104:107], v40, s[64:67], s74 offen offset:1024 sc1
  buffer_load_dwordx4 v[108:111], v41, s[64:67], s74 offen offset:1024 sc1
  buffer_load_dwordx4 v[112:115], v40, s[64:67], s74 offen offset:2048 sc1
  buffer_load_dwordx4 v[116:119], v41, s[64:67], s74 offen offset:2048 sc1
  buffer_load_dwordx4 v[120:123], v40, s[64:67], s74 offen offset:3072 sc1
  buffer_load_dwordx4 v[124:127], v41, s[64:67], s74 offen offset:3072 sc1
  buffer_load_dwordx4 v[64:67], v40, s[64:67], s75 offen offset:0 sc1
  buffer_load_dwordx4 v[68:71], v41, s[64:67], s75 offen offset:0 sc1
  s_waitcnt vmcnt(0)
  s_branch L_Dk_128
L_Dr_130:
  s_sub_u32 s10, s10, 1
  s_cselect_b32 s10, 0, s10
  s_cbranch_scc1 L_Dg_241
  buffer_load_dwordx4 v[88:91], v40, s[64:67], s73 offen offset:3072 sc1
  buffer_load_dwordx4 v[92:95], v41, s[64:67], s73 offen offset:3072 sc1
  s_waitcnt vmcnt(0)
  v_bitop3_b32 v24, v88, v92, 1 bitop3:0x80
  v_cmp_eq_u32 vcc, 0, v24
  s_nop 1
  s_cbranch_vccnz L_Dr_130
L_Dg_241:
  buffer_load_dwordx4 v[96:99], v40, s[64:67], s74 offen offset:0 sc1
  buffer_load_dwordx4 v[100:103], v41, s[64:67], s74 offen offset:0 sc1
  buffer_load_dwordx4 v[104:107], v40, s[64:67], s74 offen offset:1024 sc1
  buffer_load_dwordx4 v[108:111], v41, s[64:67], s74 offen offset:1024 sc1
  buffer_load_dwordx4 v[112:115], v40, s[64:67], s74 offen offset:2048 sc1
  buffer_load_dwordx4 v[116:119], v41, s[64:67], s74 offen offset:2048 sc1
  buffer_load_dwordx4 v[120:123], v40, s[64:67], s74 offen offset:3072 sc1
  buffer_load_dwordx4 v[124:127], v41, s[64:67], s74 offen offset:3072 sc1
  buffer_load_dwordx4 v[64:67], v40, s[64:67], s75 offen offset:0 sc1
  buffer_load_dwordx4 v[68:71], v41, s[64:67], s75 offen offset:0 sc1
  buffer_load_dwordx4 v[72:75], v40, s[64:67], s75 offen offset:1024 sc1
  buffer_load_dwordx4 v[76:79], v41, s[64:67], s75 offen offset:1024 sc1
  s_waitcnt vmcnt(0)
  s_branch L_Dk_131
L_Dr_133:
  s_sub_u32 s10, s10, 1
  s_cselect_b32 s10, 0, s10
  s_cbranch_scc1 L_Dg_242
  buffer_load_dwordx4 v[96:99], v40, s[64:67], s74 offen offset:0 sc1
  buffer_load_dwordx4 v[100:103], v41, s[64:67], s74 offen offset:0 sc1
  s_waitcnt vmcnt(0)
  v_bitop3_b32 v24, v96, v100, 1 bitop3:0x80
  v_cmp_eq_u32 vcc, 0, v24
  s_nop 1
  s_cbranch_vccnz L_Dr_133
L_Dg_242:
  buffer_load_dwordx4 v[104:107], v40, s[64:67], s74 offen offset:1024 sc1
  buffer_load_dwordx4 v[108:111], v41, s[64:67], s74 offen offset:1024 sc1
  buffer_load_dwordx4 v[112:115], v40, s[64:67], s74 offen offset:2048 sc1
  buffer_load_dwordx4 v[116:119], v41, s[64:67], s74 offen offset:2048 sc1
  buffer_load_dwordx4 v[120:123], v40, s[64:67], s74 offen offset:3072 sc1
  buffer_load_dwordx4 v[124:127], v41, s[64:67], s74 offen offset:3072 sc1
  buffer_load_dwordx4 v[64:67], v40, s[64:67], s75 offen offset:0 sc1
  buffer_load_dwordx4 v[68:71], v41, s[64:67], s75 offen offset:0 sc1
  buffer_load_dwordx4 v[72:75], v40, s[64:67], s75 offen offset:1024 sc1
  buffer_load_dwordx4 v[76:79], v41, s[64:67], s75 offen offset:1024 sc1
  buffer_load_dwordx4 v[80:83], v40, s[64:67], s75 offen offset:2048 sc1
  buffer_load_dwordx4 v[84:87], v41, s[64:67], s75 offen offset:2048 sc1
  s_waitcnt vmcnt(0)
  s_branch L_Dk_134
L_Dr_136:
  s_sub_u32 s10, s10, 1
  s_cselect_b32 s10, 0, s10
  s_cbranch_scc1 L_Dg_243
  buffer_load_dwordx4 v[104:107], v40, s[64:67], s74 offen offset:1024 sc1
  buffer_load_dwordx4 v[108:111], v41, s[64:67], s74 offen offset:1024 sc1
  s_waitcnt vmcnt(0)
  v_bitop3_b32 v24, v104, v108, 1 bitop3:0x80
  v_cmp_eq_u32 vcc, 0, v24
  s_nop 1
  s_cbranch_vccnz L_Dr_136
L_Dg_243:
  buffer_load_dwordx4 v[112:115], v40, s[64:67], s74 offen offset:2048 sc1
  buffer_load_dwordx4 v[116:119], v41, s[64:67], s74 offen offset:2048 sc1
  buffer_load_dwordx4 v[120:123], v40, s[64:67], s74 offen offset:3072 sc1
  buffer_load_dwordx4 v[124:127], v41, s[64:67], s74 offen offset:3072 sc1
  buffer_load_dwordx4 v[64:67], v40, s[64:67], s75 offen offset:0 sc1
  buffer_load_dwordx4 v[68:71], v41, s[64:67], s75 offen offset:0 sc1
  buffer_load_dwordx4 v[72:75], v40, s[64:67], s75 offen offset:1024 sc1
  buffer_load_dwordx4 v[76:79], v41, s[64:67], s75 offen offset:1024 sc1
  buffer_load_dwordx4 v[80:83], v40, s[64:67], s75 offen offset:2048 sc1
  buffer_load_dwordx4 v[84:87], v41, s[64:67], s75 offen offset:2048 sc1
  buffer_load_dwordx4 v[88:91], v40, s[64:67], s75 offen offset:3072 sc1
  buffer_load_dwordx4 v[92:95], v41, s[64:67], s75 offen offset:3072 sc1
  s_waitcnt vmcnt(0)
  s_branch L_Dk_137
L_Dr_139:
  s_sub_u32 s10, s10, 1
  s_cselect_b32 s10, 0, s10
  s_cbranch_scc1 L_Dg_244
  buffer_load_dwordx4 v[112:115], v40, s[64:67], s74 offen offset:2048 sc1
  buffer_load_dwordx4 v[116:119], v41, s[64:67], s74 offen offset:2048 sc1
  s_waitcnt vmcnt(0)
  v_bitop3_b32 v24, v112, v116, 1 bitop3:0x80
  v_cmp_eq_u32 vcc, 0, v24
  s_nop 1
  s_cbranch_vccnz L_Dr_139
L_Dg_244:
  buffer_load_dwordx4 v[120:123], v40, s[64:67], s74 offen offset:3072 sc1
  buffer_load_dwordx4 v[124:127], v41, s[64:67], s74 offen offset:3072 sc1
  buffer_load_dwordx4 v[64:67], v40, s[64:67], s75 offen offset:0 sc1
  buffer_load_dwordx4 v[68:71], v41, s[64:67], s75 offen offset:0 sc1
  buffer_load_dwordx4 v[72:75], v40, s[64:67], s75 offen offset:1024 sc1
  buffer_load_dwordx4 v[76:79], v41, s[64:67], s75 offen offset:1024 sc1
  buffer_load_dwordx4 v[80:83], v40, s[64:67], s75 offen offset:2048 sc1
  buffer_load_dwordx4 v[84:87], v41, s[64:67], s75 offen offset:2048 sc1
  buffer_load_dwordx4 v[88:91], v40, s[64:67], s75 offen offset:3072 sc1
  buffer_load_dwordx4 v[92:95], v41, s[64:67], s75 offen offset:3072 sc1
  buffer_load_dwordx4 v[96:99], v40, s[64:67], s80 offen offset:0 sc1
  buffer_load_dwordx4 v[100:103], v41, s[64:67], s80 offen offset:0 sc1
  s_waitcnt vmcnt(0)
  s_branch L_Dk_140
L_Dr_142:
  s_sub_u32 s10, s10, 1
  s_cselect_b32 s10, 0, s10
  s_cbranch_scc1 L_Dg_245
  buffer_load_dwordx4 v[120:123], v40, s[64:67], s74 offen offset:3072 sc1
  buffer_load_dwordx4 v[124:127], v41, s[64:67], s74 offen offset:3072 sc1
  s_waitcnt vmcnt(0)
  v_bitop3_b32 v24, v120, v124, 1 bitop3:0x80
  v_cmp_eq_u32 vcc, 0, v24
  s_nop 1
  s_cbranch_vccnz L_Dr_142
L_Dg_245:
  buffer_load_dwordx4 v[64:67], v40, s[64:67], s75 offen offset:0 sc1
  buffer_load_dwordx4 v[68:71], v41, s[64:67], s75 offen offset:0 sc1
  buffer_load_dwordx4 v[72:75], v40, s[64:67], s75 offen offset:1024 sc1
  buffer_load_dwordx4 v[76:79], v41, s[64:67], s75 offen offset:1024 sc1
  buffer_load_dwordx4 v[80:83], v40, s[64:67], s75 offen offset:2048 sc1
  buffer_load_dwordx4 v[84:87], v41, s[64:67], s75 offen offset:2048 sc1
  buffer_load_dwordx4 v[88:91], v40, s[64:67], s75 offen offset:3072 sc1
  buffer_load_dwordx4 v[92:95], v41, s[64:67], s75 offen offset:3072 sc1
  buffer_load_dwordx4 v[96:99], v40, s[64:67], s80 offen offset:0 sc1
  buffer_load_dwordx4 v[100:103], v41, s[64:67], s80 offen offset:0 sc1
  buffer_load_dwordx4 v[104:107], v40, s[64:67], s80 offen offset:1024 sc1
  buffer_load_dwordx4 v[108:111], v41, s[64:67], s80 offen offset:1024 sc1
  s_waitcnt vmcnt(0)
  s_branch L_Dk_143
L_Dr_145:
  s_sub_u32 s10, s10, 1
  s_cselect_b32 s10, 0, s10
  s_cbranch_scc1 L_Dg_246
  buffer_load_dwordx4 v[64:67], v40, s[64:67], s75 offen offset:0 sc1
  buffer_load_dwordx4 v[68:71], v41, s[64:67], s75 offen offset:0 sc1
  s_waitcnt vmcnt(0)
  v_bitop3_b32 v24, v64, v68, 1 bitop3:0x80
  v_cmp_eq_u32 vcc, 0, v24
  s_nop 1
  s_cbranch_vccnz L_Dr_145
L_Dg_246:
  buffer_load_dwordx4 v[72:75], v40, s[64:67], s75 offen offset:1024 sc1
  buffer_load_dwordx4 v[76:79], v41, s[64:67], s75 offen offset:1024 sc1
  buffer_load_dwordx4 v[80:83], v40, s[64:67], s75 offen offset:2048 sc1
  buffer_load_dwordx4 v[84:87], v41, s[64:67], s75 offen offset:2048 sc1
  buffer_load_dwordx4 v[88:91], v40, s[64:67], s75 offen offset:3072 sc1
  buffer_load_dwordx4 v[92:95], v41, s[64:67], s75 offen offset:3072 sc1
  buffer_load_dwordx4 v[96:99], v40, s[64:67], s80 offen offset:0 sc1
  buffer_load_dwordx4 v[100:103], v41, s[64:67], s80 offen offset:0 sc1
  buffer_load_dwordx4 v[104:107], v40, s[64:67], s80 offen offset:1024 sc1
  buffer_load_dwordx4 v[108:111], v41, s[64:67], s80 offen offset:1024 sc1
  buffer_load_dwordx4 v[112:115], v40, s[64:67], s80 offen offset:2048 sc1
  buffer_load_dwordx4 v[116:119], v41, s[64:67], s80 offen offset:2048 sc1
  s_waitcnt vmcnt(0)
  s_branch L_Dk_146
L_Dr_148:
  s_sub_u32 s10, s10, 1
  s_cselect_b32 s10, 0, s10
  s_cbranch_scc1 L_Dg_247
  buffer_load_dwordx4 v[72:75], v40, s[64:67], s75 offen offset:1024 sc1
  buffer_load_dwordx4 v[76:79], v41, s[64:67], s75 offen offset:1024 sc1
  s_waitcnt vmcnt(0)
  v_bitop3_b32 v24, v72, v76, 1 bitop3:0x80
  v_cmp_eq_u32 vcc, 0, v24
  s_nop 1
  s_cbranch_vccnz L_Dr_148
L_Dg_247:
  buffer_load_dwordx4 v[80:83], v40, s[64:67], s75 offen offset:2048 sc1
  buffer_load_dwordx4 v[84:87], v41, s[64:67], s75 offen offset:2048 sc1
  buffer_load_dwordx4 v[88:91], v40, s[64:67], s75 offen offset:3072 sc1
  buffer_load_dwordx4 v[92:95], v41, s[64:67], s75 offen offset:3072 sc1
  buffer_load_dwordx4 v[96:99], v40, s[64:67], s80 offen offset:0 sc1
  buffer_load_dwordx4 v[100:103], v41, s[64:67], s80 offen offset:0 sc1
  buffer_load_dwordx4 v[104:107], v40, s[64:67], s80 offen offset:1024 sc1
  buffer_load_dwordx4 v[108:111], v41, s[64:67], s80 offen offset:1024 sc1
  buffer_load_dwordx4 v[112:115], v40, s[64:67], s80 offen offset:2048 sc1
  buffer_load_dwordx4 v[116:119], v41, s[64:67], s80 offen offset:2048 sc1
  buffer_load_dwordx4 v[120:123], v40, s[64:67], s80 offen offset:3072 sc1
  buffer_load_dwordx4 v[124:127], v41, s[64:67], s80 offen offset:3072 sc1
  s_branch L_Dk_149
L_Dr_151:
  s_sub_u32 s10, s10, 1
  s_cselect_b32 s10, 0, s10
  s_cbranch_scc1 L_Dg_248
  buffer_load_dwordx4 v[80:83], v40, s[64:67], s75 offen offset:2048 sc1
  buffer_load_dwordx4 v[84:87], v41, s[64:67], s75 offen offset:2048 sc1
  s_waitcnt vmcnt(0)
  v_bitop3_b32 v24, v80, v84, 1 bitop3:0x80
  v_cmp_eq_u32 vcc, 0, v24
  s_nop 1
  s_cbranch_vccnz L_Dr_151
L_Dg_248:
  buffer_load_dwordx4 v[88:91], v40, s[64:67], s75 offen offset:3072 sc1
  buffer_load_dwordx4 v[92:95], v41, s[64:67], s75 offen offset:3072 sc1
  buffer_load_dwordx4 v[96:99], v40, s[64:67], s80 offen offset:0 sc1
  buffer_load_dwordx4 v[100:103], v41, s[64:67], s80 offen offset:0 sc1
  buffer_load_dwordx4 v[104:107], v40, s[64:67], s80 offen offset:1024 sc1
  buffer_load_dwordx4 v[108:111], v41, s[64:67], s80 offen offset:1024 sc1
  buffer_load_dwordx4 v[112:115], v40, s[64:67], s80 offen offset:2048 sc1
  buffer_load_dwordx4 v[116:119], v41, s[64:67], s80 offen offset:2048 sc1
  buffer_load_dwordx4 v[120:123], v40, s[64:67], s80 offen offset:3072 sc1
  buffer_load_dwordx4 v[124:127], v41, s[64:67], s80 offen offset:3072 sc1
  buffer_load_dwordx4 v[64:67], v40, s[64:67], s82 offen offset:0 sc1
  buffer_load_dwordx4 v[68:71], v41, s[64:67], s82 offen offset:0 sc1
  s_branch L_Dk_152
L_Dr_154:
  s_sub_u32 s10, s10, 1
  s_cselect_b32 s10, 0, s10
  s_cbranch_scc1 L_Dg_249
  buffer_load_dwordx4 v[88:91], v40, s[64:67], s75 offen offset:3072 sc1
  buffer_load_dwordx4 v[92:95], v41, s[64:67], s75 offen offset:3072 sc1
  s_waitcnt vmcnt(0)
  v_bitop3_b32 v24, v88, v92, 1 bitop3:0x80
  v_cmp_eq_u32 vcc, 0, v24
  s_nop 1
  s_cbranch_vccnz L_Dr_154
L_Dg_249:
  buffer_load_dwordx4 v[96:99], v40, s[64:67], s80 offen offset:0 sc1
  buffer_load_dwordx4 v[100:103], v41, s[64:67], s80 offen offset:0 sc1
  buffer_load_dwordx4 v[104:107], v40, s[64:67], s80 offen offset:1024 sc1
  buffer_load_dwordx4 v[108:111], v41, s[64:67], s80 offen offset:1024 sc1
  buffer_load_dwordx4 v[112:115], v40, s[64:67], s80 offen offset:2048 sc1
  buffer_load_dwordx4 v[116:119], v41, s[64:67], s80 offen offset:2048 sc1
  buffer_load_dwordx4 v[120:123], v40, s[64:67], s80 offen offset:3072 sc1
  buffer_load_dwordx4 v[124:127], v41, s[64:67], s80 offen offset:3072 sc1
  buffer_load_dwordx4 v[64:67], v40, s[64:67], s82 offen offset:0 sc1
  buffer_load_dwordx4 v[68:71], v41, s[64:67], s82 offen offset:0 sc1
  buffer_load_dwordx4 v[72:75], v40, s[64:67], s82 offen offset:1024 sc1
  buffer_load_dwordx4 v[76:79], v41, s[64:67], s82 offen offset:1024 sc1
  s_branch L_Dk_155
L_Dr_157:
  s_sub_u32 s10, s10, 1
  s_cselect_b32 s10, 0, s10
  s_cbranch_scc1 L_Dg_250
  buffer_load_dwordx4 v[96:99], v40, s[64:67], s80 offen offset:0 sc1
  buffer_load_dwordx4 v[100:103], v41, s[64:67], s80 offen offset:0 sc1
  s_waitcnt vmcnt(0)
  v_bitop3_b32 v24, v96, v100, 1 bitop3:0x80
  v_cmp_eq_u32 vcc, 0, v24
  s_nop 1
  s_cbranch_vccnz L_Dr_157
L_Dg_250:
  buffer_load_dwordx4 v[104:107], v40, s[64:67], s80 offen offset:1024 sc1
  buffer_load_dwordx4 v[108:111], v41, s[64:67], s80 offen offset:1024 sc1
  buffer_load_dwordx4 v[112:115], v40, s[64:67], s80 offen offset:2048 sc1
  buffer_load_dwordx4 v[116:119], v41, s[64:67], s80 offen offset:2048 sc1
  buffer_load_dwordx4 v[120:123], v40, s[64:67], s80 offen offset:3072 sc1
  buffer_load_dwordx4 v[124:127], v41, s[64:67], s80 offen offset:3072 sc1
  buffer_load_dwordx4 v[64:67], v40, s[64:67], s82 offen offset:0 sc1
  buffer_load_dwordx4 v[68:71], v41, s[64:67], s82 offen offset:0 sc1
  buffer_load_dwordx4 v[72:75], v40, s[64:67], s82 offen offset:1024 sc1
  buffer_load_dwordx4 v[76:79], v41, s[64:67], s82 offen offset:1024 sc1
  buffer_load_dwordx4 v[80:83], v40, s[64:67], s82 offen offset:2048 sc1
  buffer_load_dwordx4 v[84:87], v41, s[64:67], s82 offen offset:2048 sc1
  s_branch L_Dk_158
L_Dr_160:
  s_sub_u32 s10, s10, 1
  s_cselect_b32 s10, 0, s10
  s_cbranch_scc1 L_Dg_251
  buffer_load_dwordx4 v[104:107], v40, s[64:67], s80 offen offset:1024 sc1
  buffer_load_dwordx4 v[108:111], v41, s[64:67], s80 offen offset:1024 sc1
  s_waitcnt vmcnt(0)
  v_bitop3_b32 v24, v104, v108, 1 bitop3:0x80
  v_cmp_eq_u32 vcc, 0, v24
  s_nop 1
  s_cbranch_vccnz L_Dr_160
L_Dg_251:
  buffer_load_dwordx4 v[112:115], v40, s[64:67], s80 offen offset:2048 sc1
  buffer_load_dwordx4 v[116:119], v41, s[64:67], s80 offen offset:2048 sc1
  buffer_load_dwordx4 v[120:123], v40, s[64:67], s80 offen offset:3072 sc1
  buffer_load_dwordx4 v[124:127], v41, s[64:67], s80 offen offset:3072 sc1
  buffer_load_dwordx4 v[64:67], v40, s[64:67], s82 offen offset:0 sc1
  buffer_load_dwordx4 v[68:71], v41, s[64:67], s82 offen offset:0 sc1
  buffer_load_dwordx4 v[72:75], v40, s[64:67], s82 offen offset:1024 sc1
  buffer_load_dwordx4 v[76:79], v41, s[64:67], s82 offen offset:1024 sc1
  buffer_load_dwordx4 v[80:83], v40, s[64:67], s82 offen offset:2048 sc1
  buffer_load_dwordx4 v[84:87], v41, s[64:67], s82 offen offset:2048 sc1
  buffer_load_dwordx4 v[88:91], v40, s[64:67], s82 offen offset:3072 sc1
  buffer_load_dwordx4 v[92:95], v41, s[64:67], s82 offen offset:3072 sc1
  s_branch L_Dk_161
L_Dr_163:
  s_sub_u32 s10, s10, 1
  s_cselect_b32 s10, 0, s10
  s_cbranch_scc1 L_Dg_252
  buffer_load_dwordx4 v[112:115], v40, s[64:67], s80 offen offset:2048 sc1
  buffer_load_dwordx4 v[116:119], v41, s[64:67], s80 offen offset:2048 sc1
  s_waitcnt vmcnt(0)
  v_bitop3_b32 v24, v112, v116, 1 bitop3:0x80
  v_cmp_eq_u32 vcc, 0, v24
  s_nop 1
  s_cbranch_vccnz L_Dr_163
L_Dg_252:
  buffer_load_dwordx4 v[120:123], v40, s[64:67], s80 offen offset:3072 sc1
  buffer_load_dwordx4 v[124:127], v41, s[64:67], s80 offen offset:3072 sc1
  buffer_load_dwordx4 v[64:67], v40, s[64:67], s82 offen offset:0 sc1
  buffer_load_dwordx4 v[68:71], v41, s[64:67], s82 offen offset:0 sc1
  buffer_load_dwordx4 v[72:75], v40, s[64:67], s82 offen offset:1024 sc1
  buffer_load_dwordx4 v[76:79], v41, s[64:67], s82 offen offset:1024 sc1
  buffer_load_dwordx4 v[80:83], v40, s[64:67], s82 offen offset:2048 sc1
  buffer_load_dwordx4 v[84:87], v41, s[64:67], s82 offen offset:2048 sc1
  buffer_load_dwordx4 v[88:91], v40, s[64:67], s82 offen offset:3072 sc1
  buffer_load_dwordx4 v[92:95], v41, s[64:67], s82 offen offset:3072 sc1
  buffer_load_dwordx4 v[96:99], v40, s[64:67], s70 offen offset:0 sc1
  buffer_load_dwordx4 v[100:103], v41, s[64:67], s70 offen offset:0 sc1
  s_waitcnt vmcnt(0)
  s_branch L_Dk_164
L_Dr_166:
  s_sub_u32 s10, s10, 1
  s_cselect_b32 s10, 0, s10
  s_cbranch_scc1 L_Dg_253
  buffer_load_dwordx4 v[120:123], v40, s[64:67], s80 offen offset:3072 sc1
  buffer_load_dwordx4 v[124:127], v41, s[64:67], s80 offen offset:3072 sc1
  s_waitcnt vmcnt(0)
  v_bitop3_b32 v24, v120, v124, 1 bitop3:0x80
  v_cmp_eq_u32 vcc, 0, v24
  s_nop 1
  s_cbranch_vccnz L_Dr_166
L_Dg_253:
  buffer_load_dwordx4 v[64:67], v40, s[64:67], s82 offen offset:0 sc1
  buffer_load_dwordx4 v[68:71], v41, s[64:67], s82 offen offset:0 sc1
  buffer_load_dwordx4 v[72:75], v40, s[64:67], s82 offen offset:1024 sc1
  buffer_load_dwordx4 v[76:79], v41, s[64:67], s82 offen offset:1024 sc1
  buffer_load_dwordx4 v[80:83], v40, s[64:67], s82 offen offset:2048 sc1
  buffer_load_dwordx4 v[84:87], v41, s[64:67], s82 offen offset:2048 sc1
  buffer_load_dwordx4 v[88:91], v40, s[64:67], s82 offen offset:3072 sc1
  buffer_load_dwordx4 v[92:95], v41, s[64:67], s82 offen offset:3072 sc1
  buffer_load_dwordx4 v[96:99], v40, s[64:67], s70 offen offset:0 sc1
  buffer_load_dwordx4 v[100:103], v41, s[64:67], s70 offen offset:0 sc1
  buffer_load_dwordx4 v[104:107], v40, s[64:67], s70 offen offset:1024 sc1
  buffer_load_dwordx4 v[108:111], v41, s[64:67], s70 offen offset:1024 sc1
  s_waitcnt vmcnt(0)
  s_branch L_Dk_167
L_Dr_169:
  s_sub_u32 s10, s10, 1
  s_cselect_b32 s10, 0, s10
  s_cbranch_scc1 L_Dg_254
  buffer_load_dwordx4 v[64:67], v40, s[64:67], s82 offen offset:0 sc1
  buffer_load_dwordx4 v[68:71], v41, s[64:67], s82 offen offset:0 sc1
  s_waitcnt vmcnt(0)
  v_bitop3_b32 v24, v64, v68, 1 bitop3:0x80
  v_cmp_eq_u32 vcc, 0, v24
  s_nop 1
  s_cbranch_vccnz L_Dr_169
L_Dg_254:
  buffer_load_dwordx4 v[72:75], v40, s[64:67], s82 offen offset:1024 sc1
  buffer_load_dwordx4 v[76:79], v41, s[64:67], s82 offen offset:1024 sc1
  buffer_load_dwordx4 v[80:83], v40, s[64:67], s82 offen offset:2048 sc1
  buffer_load_dwordx4 v[84:87], v41, s[64:67], s82 offen offset:2048 sc1
  buffer_load_dwordx4 v[88:91], v40, s[64:67], s82 offen offset:3072 sc1
  buffer_load_dwordx4 v[92:95], v41, s[64:67], s82 offen offset:3072 sc1
  buffer_load_dwordx4 v[96:99], v40, s[64:67], s70 offen offset:0 sc1
  buffer_load_dwordx4 v[100:103], v41, s[64:67], s70 offen offset:0 sc1
  buffer_load_dwordx4 v[104:107], v40, s[64:67], s70 offen offset:1024 sc1
  buffer_load_dwordx4 v[108:111], v41, s[64:67], s70 offen offset:1024 sc1
  buffer_load_dwordx4 v[112:115], v40, s[64:67], s70 offen offset:2048 sc1
  buffer_load_dwordx4 v[116:119], v41, s[64:67], s70 offen offset:2048 sc1
  s_waitcnt vmcnt(0)
  s_branch L_Dk_170
L_Dr_172:
  s_sub_u32 s10, s10, 1
  s_cselect_b32 s10, 0, s10
  s_cbranch_scc1 L_Dg_255
  buffer_load_dwordx4 v[72:75], v40, s[64:67], s82 offen offset:1024 sc1
  buffer_load_dwordx4 v[76:79], v41, s[64:67], s82 offen offset:1024 sc1
  s_waitcnt vmcnt(0)
  v_bitop3_b32 v24, v72, v76, 1 bitop3:0x80
  v_cmp_eq_u32 vcc, 0, v24
  s_nop 1
  s_cbranch_vccnz L_Dr_172
L_Dg_255:
  buffer_load_dwordx4 v[80:83], v40, s[64:67], s82 offen offset:2048 sc1
  buffer_load_dwordx4 v[84:87], v41, s[64:67], s82 offen offset:2048 sc1
  buffer_load_dwordx4 v[88:91], v40, s[64:67], s82 offen offset:3072 sc1
  buffer_load_dwordx4 v[92:95], v41, s[64:67], s82 offen offset:3072 sc1
  buffer_load_dwordx4 v[96:99], v40, s[64:67], s70 offen offset:0 sc1
  buffer_load_dwordx4 v[100:103], v41, s[64:67], s70 offen offset:0 sc1
  buffer_load_dwordx4 v[104:107], v40, s[64:67], s70 offen offset:1024 sc1
  buffer_load_dwordx4 v[108:111], v41, s[64:67], s70 offen offset:1024 sc1
  buffer_load_dwordx4 v[112:115], v40, s[64:67], s70 offen offset:2048 sc1
  buffer_load_dwordx4 v[116:119], v41, s[64:67], s70 offen offset:2048 sc1
  buffer_load_dwordx4 v[120:123], v40, s[64:67], s70 offen offset:3072 sc1
  buffer_load_dwordx4 v[124:127], v41, s[64:67], s70 offen offset:3072 sc1
  s_waitcnt vmcnt(0)
  s_branch L_Dk_173
L_Dr_175:
  s_sub_u32 s10, s10, 1
  s_cselect_b32 s10, 0, s10
  s_cbranch_scc1 L_Dg_256
  buffer_load_dwordx4 v[80:83], v40, s[64:67], s82 offen offset:2048 sc1
  buffer_load_dwordx4 v[84:87], v41, s[64:67], s82 offen offset:2048 sc1
  s_waitcnt vmcnt(0)
  v_bitop3_b32 v24, v80, v84, 1 bitop3:0x80
  v_cmp_eq_u32 vcc, 0, v24
  s_nop 1
  s_cbranch_vccnz L_Dr_175
L_Dg_256:
  buffer_load_dwordx4 v[88:91], v40, s[64:67], s82 offen offset:3072 sc1
  buffer_load_dwordx4 v[92:95], v41, s[64:67], s82 offen offset:3072 sc1
  buffer_load_dwordx4 v[96:99], v40, s[64:67], s70 offen offset:0 sc1
  buffer_load_dwordx4 v[100:103], v41, s[64:67], s70 offen offset:0 sc1
  buffer_load_dwordx4 v[104:107], v40, s[64:67], s70 offen offset:1024 sc1
  buffer_load_dwordx4 v[108:111], v41, s[64:67], s70 offen offset:1024 sc1
  buffer_load_dwordx4 v[112:115], v40, s[64:67], s70 offen offset:2048 sc1
  buffer_load_dwordx4 v[116:119], v41, s[64:67], s70 offen offset:2048 sc1
  buffer_load_dwordx4 v[120:123], v40, s[64:67], s70 offen offset:3072 sc1
  buffer_load_dwordx4 v[124:127], v41, s[64:67], s70 offen offset:3072 sc1
  buffer_load_dwordx4 v[64:67], v40, s[64:67], s26 offen offset:0 sc1
  buffer_load_dwordx4 v[68:71], v41, s[64:67], s26 offen offset:0 sc1
  s_waitcnt vmcnt(0)
  s_branch L_Dk_176
L_Dr_178:
  s_sub_u32 s10, s10, 1
  s_cselect_b32 s10, 0, s10
  s_cbranch_scc1 L_Dg_257
  buffer_load_dwordx4 v[88:91], v40, s[64:67], s82 offen offset:3072 sc1
  buffer_load_dwordx4 v[92:95], v41, s[64:67], s82 offen offset:3072 sc1
  s_waitcnt vmcnt(0)
  v_bitop3_b32 v24, v88, v92, 1 bitop3:0x80
  v_cmp_eq_u32 vcc, 0, v24
  s_nop 1
  s_cbranch_vccnz L_Dr_178
L_Dg_257:
  buffer_load_dwordx4 v[96:99], v40, s[64:67], s70 offen offset:0 sc1
  buffer_load_dwordx4 v[100:103], v41, s[64:67], s70 offen offset:0 sc1
  buffer_load_dwordx4 v[104:107], v40, s[64:67], s70 offen offset:1024 sc1
  buffer_load_dwordx4 v[108:111], v41, s[64:67], s70 offen offset:1024 sc1
  buffer_load_dwordx4 v[112:115], v40, s[64:67], s70 offen offset:2048 sc1
  buffer_load_dwordx4 v[116:119], v41, s[64:67], s70 offen offset:2048 sc1
  buffer_load_dwordx4 v[120:123], v40, s[64:67], s70 offen offset:3072 sc1
  buffer_load_dwordx4 v[124:127], v41, s[64:67], s70 offen offset:3072 sc1
  buffer_load_dwordx4 v[64:67], v40, s[64:67], s26 offen offset:0 sc1
  buffer_load_dwordx4 v[68:71], v41, s[64:67], s26 offen offset:0 sc1
  buffer_load_dwordx4 v[72:75], v40, s[64:67], s26 offen offset:1024 sc1
  buffer_load_dwordx4 v[76:79], v41, s[64:67], s26 offen offset:1024 sc1
  s_waitcnt vmcnt(0)
  s_branch L_Dk_179
L_Dr_181:
  s_sub_u32 s10, s10, 1
  s_cselect_b32 s10, 0, s10
  s_cbranch_scc1 L_Dg_258
  buffer_load_dwordx4 v[96:99], v40, s[64:67], s70 offen offset:0 sc1
  buffer_load_dwordx4 v[100:103], v41, s[64:67], s70 offen offset:0 sc1
  s_waitcnt vmcnt(0)
  v_bitop3_b32 v24, v96, v100, 1 bitop3:0x80
  v_cmp_eq_u32 vcc, 0, v24
  s_nop 1
  s_cbranch_vccnz L_Dr_181
L_Dg_258:
  buffer_load_dwordx4 v[104:107], v40, s[64:67], s70 offen offset:1024 sc1
  buffer_load_dwordx4 v[108:111], v41, s[64:67], s70 offen offset:1024 sc1
  buffer_load_dwordx4 v[112:115], v40, s[64:67], s70 offen offset:2048 sc1
  buffer_load_dwordx4 v[116:119], v41, s[64:67], s70 offen offset:2048 sc1
  buffer_load_dwordx4 v[120:123], v40, s[64:67], s70 offen offset:3072 sc1
  buffer_load_dwordx4 v[124:127], v41, s[64:67], s70 offen offset:3072 sc1
  buffer_load_dwordx4 v[64:67], v40, s[64:67], s26 offen offset:0 sc1
  buffer_load_dwordx4 v[68:71], v41, s[64:67], s26 offen offset:0 sc1
  buffer_load_dwordx4 v[72:75], v40, s[64:67], s26 offen offset:1024 sc1
  buffer_load_dwordx4 v[76:79], v41, s[64:67], s26 offen offset:1024 sc1
  buffer_load_dwordx4 v[80:83], v40, s[64:67], s26 offen offset:2048 sc1
  buffer_load_dwordx4 v[84:87], v41, s[64:67], s26 offen offset:2048 sc1
  s_waitcnt vmcnt(0)
  s_branch L_Dk_182
L_Dr_184:
  s_sub_u32 s10, s10, 1
  s_cselect_b32 s10, 0, s10
  s_cbranch_scc1 L_Dg_259
  buffer_load_dwordx4 v[104:107], v40, s[64:67], s70 offen offset:1024 sc1
  buffer_load_dwordx4 v[108:111], v41, s[64:67], s70 offen offset:1024 sc1
  s_waitcnt vmcnt(0)
  v_bitop3_b32 v24, v104, v108, 1 bitop3:0x80
  v_cmp_eq_u32 vcc, 0, v24
  s_nop 1
  s_cbranch_vccnz L_Dr_184
L_Dg_259:
  buffer_load_dwordx4 v[112:115], v40, s[64:67], s70 offen offset:2048 sc1
  buffer_load_dwordx4 v[116:119], v41, s[64:67], s70 offen offset:2048 sc1
  buffer_load_dwordx4 v[120:123], v40, s[64:67], s70 offen offset:3072 sc1
  buffer_load_dwordx4 v[124:127], v41, s[64:67], s70 offen offset:3072 sc1
  buffer_load_dwordx4 v[64:67], v40, s[64:67], s26 offen offset:0 sc1
  buffer_load_dwordx4 v[68:71], v41, s[64:67], s26 offen offset:0 sc1
  buffer_load_dwordx4 v[72:75], v40, s[64:67], s26 offen offset:1024 sc1
  buffer_load_dwordx4 v[76:79], v41, s[64:67], s26 offen offset:1024 sc1
  buffer_load_dwordx4 v[80:83], v40, s[64:67], s26 offen offset:2048 sc1
  buffer_load_dwordx4 v[84:87], v41, s[64:67], s26 offen offset:2048 sc1
  buffer_load_dwordx4 v[88:91], v40, s[64:67], s26 offen offset:3072 sc1
  buffer_load_dwordx4 v[92:95], v41, s[64:67], s26 offen offset:3072 sc1
  s_branch L_Dk_185
L_Dr_187:
  s_sub_u32 s10, s10, 1
  s_cselect_b32 s10, 0, s10
  s_cbranch_scc1 L_Dg_260
  buffer_load_dwordx4 v[112:115], v40, s[64:67], s70 offen offset:2048 sc1
  buffer_load_dwordx4 v[116:119], v41, s[64:67], s70 offen offset:2048 sc1
  s_waitcnt vmcnt(0)
  v_bitop3_b32 v24, v112, v116, 1 bitop3:0x80
  v_cmp_eq_u32 vcc, 0, v24
  s_nop 1
  s_cbranch_vccnz L_Dr_187
L_Dg_260:
  buffer_load_dwordx4 v[120:123], v40, s[64:67], s70 offen offset:3072 sc1
  buffer_load_dwordx4 v[124:127], v41, s[64:67], s70 offen offset:3072 sc1
  buffer_load_dwordx4 v[64:67], v40, s[64:67], s26 offen offset:0 sc1
  buffer_load_dwordx4 v[68:71], v41, s[64:67], s26 offen offset:0 sc1
  buffer_load_dwordx4 v[72:75], v40, s[64:67], s26 offen offset:1024 sc1
  buffer_load_dwordx4 v[76:79], v41, s[64:67], s26 offen offset:1024 sc1
  buffer_load_dwordx4 v[80:83], v40, s[64:67], s26 offen offset:2048 sc1
  buffer_load_dwordx4 v[84:87], v41, s[64:67], s26 offen offset:2048 sc1
  buffer_load_dwordx4 v[88:91], v40, s[64:67], s26 offen offset:3072 sc1
  buffer_load_dwordx4 v[92:95], v41, s[64:67], s26 offen offset:3072 sc1
  s_branch L_Dk_188
L_Dr_190:
  s_sub_u32 s10, s10, 1
  s_cselect_b32 s10, 0, s10
  s_cbranch_scc1 L_Dg_261
  buffer_load_dwordx4 v[120:123], v40, s[64:67], s70 offen offset:3072 sc1
  buffer_load_dwordx4 v[124:127], v41, s[64:67], s70 offen offset:3072 sc1
  s_waitcnt vmcnt(0)
  v_bitop3_b32 v24, v120, v124, 1 bitop3:0x80
  v_cmp_eq_u32 vcc, 0, v24
  s_nop 1
  s_cbranch_vccnz L_Dr_190
L_Dg_261:
  buffer_load_dwordx4 v[64:67], v40, s[64:67], s26 offen offset:0 sc1
  buffer_load_dwordx4 v[68:71], v41, s[64:67], s26 offen offset:0 sc1
  buffer_load_dwordx4 v[72:75], v40, s[64:67], s26 offen offset:1024 sc1
  buffer_load_dwordx4 v[76:79], v41, s[64:67], s26 offen offset:1024 sc1
  buffer_load_dwordx4 v[80:83], v40, s[64:67], s26 offen offset:2048 sc1
  buffer_load_dwordx4 v[84:87], v41, s[64:67], s26 offen offset:2048 sc1
  buffer_load_dwordx4 v[88:91], v40, s[64:67], s26 offen offset:3072 sc1
  buffer_load_dwordx4 v[92:95], v41, s[64:67], s26 offen offset:3072 sc1
  s_branch L_Dk_191
L_Dr_193:
  s_sub_u32 s10, s10, 1
  s_cselect_b32 s10, 0, s10
  s_cbranch_scc1 L_Dg_262
  buffer_load_dwordx4 v[64:67], v40, s[64:67], s26 offen offset:0 sc1
  buffer_load_dwordx4 v[68:71], v41, s[64:67], s26 offen offset:0 sc1
  s_waitcnt vmcnt(0)
  v_bitop3_b32 v24, v64, v68, 1 bitop3:0x80
  v_cmp_eq_u32 vcc, 0, v24
  s_nop 1
  s_cbranch_vccnz L_Dr_193
L_Dg_262:
  buffer_load_dwordx4 v[72:75], v40, s[64:67], s26 offen offset:1024 sc1
  buffer_load_dwordx4 v[76:79], v41, s[64:67], s26 offen offset:1024 sc1
  buffer_load_dwordx4 v[80:83], v40, s[64:67], s26 offen offset:2048 sc1
  buffer_load_dwordx4 v[84:87], v41, s[64:67], s26 offen offset:2048 sc1
  buffer_load_dwordx4 v[88:91], v40, s[64:67], s26 offen offset:3072 sc1
  buffer_load_dwordx4 v[92:95], v41, s[64:67], s26 offen offset:3072 sc1
  s_branch L_Dk_194
L_Dr_196:
  s_sub_u32 s10, s10, 1
  s_cselect_b32 s10, 0, s10
  s_cbranch_scc1 L_Dg_263
  buffer_load_dwordx4 v[72:75], v40, s[64:67], s26 offen offset:1024 sc1
  buffer_load_dwordx4 v[76:79], v41, s[64:67], s26 offen offset:1024 sc1
  s_waitcnt vmcnt(0)
  v_bitop3_b32 v24, v72, v76, 1 bitop3:0x80
  v_cmp_eq_u32 vcc, 0, v24
  s_nop 1
  s_cbranch_vccnz L_Dr_196
L_Dg_263:
  buffer_load_dwordx4 v[80:83], v40, s[64:67], s26 offen offset:2048 sc1
  buffer_load_dwordx4 v[84:87], v41, s[64:67], s26 offen offset:2048 sc1
  buffer_load_dwordx4 v[88:91], v40, s[64:67], s26 offen offset:3072 sc1
  buffer_load_dwordx4 v[92:95], v41, s[64:67], s26 offen offset:3072 sc1
  s_branch L_Dk_197
L_Dr_199:
  s_sub_u32 s10, s10, 1
  s_cselect_b32 s10, 0, s10
  s_cbranch_scc1 L_Dg_264
  buffer_load_dwordx4 v[80:83], v40, s[64:67], s26 offen offset:2048 sc1
  buffer_load_dwordx4 v[84:87], v41, s[64:67], s26 offen offset:2048 sc1
  s_waitcnt vmcnt(0)
  v_bitop3_b32 v24, v80, v84, 1 bitop3:0x80
  v_cmp_eq_u32 vcc, 0, v24
  s_nop 1
  s_cbranch_vccnz L_Dr_199
L_Dg_264:
  buffer_load_dwordx4 v[88:91], v40, s[64:67], s26 offen offset:3072 sc1
  buffer_load_dwordx4 v[92:95], v41, s[64:67], s26 offen offset:3072 sc1
  s_branch L_Dk_200
L_Dr_202:
  s_sub_u32 s10, s10, 1
  s_cselect_b32 s10, 0, s10
  s_cbranch_scc1 L_Dg_265
  buffer_load_dwordx4 v[88:91], v40, s[64:67], s26 offen offset:3072 sc1
  buffer_load_dwordx4 v[92:95], v41, s[64:67], s26 offen offset:3072 sc1
  s_waitcnt vmcnt(0)
  v_bitop3_b32 v24, v88, v92, 1 bitop3:0x80
  v_cmp_eq_u32 vcc, 0, v24
  s_nop 1
  s_cbranch_vccnz L_Dr_202
L_Dg_265:
  s_branch L_Dk_203
L_code_end:
.set CODE_BYTES, L_code_end - sequential_preLN__linear_kernel_hedgehog__mixer_token_mlp__prompt_kernel - 256
.section .rodata,"a"
.p2align 6
.amdhsa_kernel sequential_preLN__linear_kernel_hedgehog__mixer_token_mlp__prompt_kernel
  .amdhsa_next_free_vgpr 512
  .amdhsa_next_free_sgpr 102
  .amdhsa_accum_offset 256
  .amdhsa_group_segment_fixed_size 0
  .amdhsa_kernarg_size 96
  .amdhsa_user_sgpr_count 2
  .amdhsa_user_sgpr_kernarg_segment_ptr 1
  .amdhsa_system_sgpr_workgroup_id_x 1
.end_amdhsa_kernel
```
